```python
import torch

def _softmax(x, axis=-1):
    return torch.softmax(x, dim=axis)

def _gelu(x):
    return torch.nn.functional.gelu(x, approximate='tanh')

def _silu(x):
    return torch.nn.functional.silu(x)

def _sigmoid(x):
    return torch.sigmoid(x)

def _layernorm(x, axis=-1, eps=1e-05):
    m = x.mean(dim=axis, keepdim=True)
    v = x.var(dim=axis, keepdim=True, unbiased=False)
    return (x - m) / torch.sqrt(v + eps)

def _scatter_add(tgt, idx, src, axis=0):
    return tgt.clone().index_add_(axis, idx, src)

def _segment_sum(src, seg, n):
    out = torch.zeros((n,) + src.shape[1:], dtype=src.dtype)
    return out.index_add_(0, seg, src)

def _pad(x, pw):
    flat = tuple((v for pair in reversed(pw) for v in pair))
    return torch.nn.functional.pad(x, flat)
kernel_name = 'adaLN_cond__grouped_kv_mqa__glu_gated_geglu__prompt'

def setup_inputs():

    _w = lambda a: (lambda t: t.to(torch.bfloat16) if t.is_floating_point() else t)(torch.as_tensor(a))

    def _A_setup():
        B, S, D, H = (1, 2048, 640, 32)
        Dh = D // H
        return {'x': _w((lambda *s: torch.randn(*s, dtype=torch.bfloat16) * 0.05)(B, S, D)), 'wq': _w((lambda *s: torch.randn(*s, dtype=torch.bfloat16) * 0.05)(D, H * Dh)), 'wk': _w((lambda *s: torch.randn(*s, dtype=torch.bfloat16) * 0.05)(D, Dh)), 'wv': _w((lambda *s: torch.randn(*s, dtype=torch.bfloat16) * 0.05)(D, Dh)), 'wo': _w((lambda *s: torch.randn(*s, dtype=torch.bfloat16) * 0.05)(H * Dh, D))}
    _A_in = _A_setup()

    def _B_setup():
        B, S, Dm, Df = (1, 2048, 640, 1536)
        return {'x': _w((lambda *s: torch.randn(*s, dtype=torch.bfloat16) * 0.05)(B, S, Dm)), 'w_gate': _w((lambda *s: torch.randn(*s, dtype=torch.bfloat16) * 0.8)(Dm, Df) * Dm ** (-0.5)), 'w_up': _w((lambda *s: torch.randn(*s, dtype=torch.bfloat16) * 0.8)(Dm, Df) * Dm ** (-0.5)), 'w_down': _w((lambda *s: torch.randn(*s, dtype=torch.bfloat16) * 0.8)(Df, Dm) * Df ** (-0.5))}
    _B_in = _B_setup()
    return {'A_x': _A_in['x'], 'A_wq': _A_in['wq'], 'A_wk': _A_in['wk'], 'A_wv': _A_in['wv'], 'A_wo': _A_in['wo'], 'B_x': _B_in['x'], 'B_w_gate': _B_in['w_gate'], 'B_w_up': _B_in['w_up'], 'B_w_down': _B_in['w_down'], 'c': _w((lambda *s: torch.randn(*s, dtype=torch.bfloat16) * 0.1)(1, 640) * 8.0), 'w_mod': _w((lambda *s: torch.randn(*s, dtype=torch.bfloat16) * 0.1)(640, 6 * 640) * 640 ** (-0.5) * 8.0)}

def reference(A_x, A_wq, A_wk, A_wv, A_wo, B_x, B_w_gate, B_w_up, B_w_down, c, w_mod):

    def _A_ref(x, wq, wk, wv, wo):
        B, S, D = x.shape
        H = 32
        Dh = D // H
        q = (lambda x, *d: x.permute(*d))((x @ wq).reshape(B, S, H, Dh), 0, 2, 1, 3)
        k = x @ wk
        v = x @ wv
        scores = torch.einsum('bhqd,bkd->bhqk', q, k) * Dh ** (-0.5)
        p = _softmax(scores, axis=-1)
        o = torch.einsum('bhqk,bkd->bhqd', p, v)
        return (lambda x, *d: x.permute(*d))(o, 0, 2, 1, 3).reshape(B, S, H * Dh) @ wo

    def _B_ref(x, w_gate, w_up, w_down):
        g = torch.einsum('bsd,df->bsf', x, w_gate)
        u = torch.einsum('bsd,df->bsf', x, w_up)
        h = _gelu(g) * u
        return torch.einsum('bsf,fd->bsd', h, w_down)
    x = A_x
    mod = (_silu(c) @ w_mod).reshape(c.shape[0], 6, 1, -1)
    sa, ca, ga, sb, cb, gb = (mod[:, 0].clone(), mod[:, 1].clone(), mod[:, 2].clone(), mod[:, 3].clone(), mod[:, 4].clone(), mod[:, 5].clone())
    h = _layernorm(x, axis=-1) * (1 + ca) + sa
    x = x + ga * _A_ref(h, A_wq, A_wk, A_wv, A_wo)
    h = _layernorm(x, axis=-1) * (1 + cb) + sb
    x = x + gb * _B_ref(h, B_w_gate, B_w_up, B_w_down)
    return x
```

```asm
; @launch grid=(256,1,1) block=(512,1,1) lds=163840
.amdgcn_target "amdgcn-amd-amdhsa--gfx950"
.text
.globl adaLN_cond__grouped_kv_mqa__glu_gated_geglu__prompt_kernel
.p2align 8
.type adaLN_cond__grouped_kv_mqa__glu_gated_geglu__prompt_kernel,@function
adaLN_cond__grouped_kv_mqa__glu_gated_geglu__prompt_kernel:
s_cmp_ge_u32 s2, 256
s_cbranch_scc1 Lf_end
s_load_dwordx2 s[4:5], s[0:1], 104
s_load_dwordx2 s[12:13], s[0:1], 0
s_load_dwordx2 s[16:17], s[0:1], 80
s_load_dwordx2 s[48:49], s[0:1], 72
v_lshrrev_b32 v1, 6, v0
s_nop 0
v_readfirstlane_b32 s3, v1
v_and_b32 v1, 63, v0
v_lshlrev_b32 v2, 4, v1
s_sub_u32 s43, s3, 4
s_cmp_lg_u32 s3, 3
s_cbranch_scc1 Lnocpf_1
s_getpc_b64 s[28:29]
Lf_pc:
s_mov_b32 s31, Lf_end-Lf_pc
s_lshr_b32 s30, s2, 3
s_lshl_b32 s30, s30, 7
v_lshl_add_u32 v4, v1, 12, s30
v_min_u32 v4, s31, v4
s_mov_b64 exec, 0xffff
global_load_dword v11, v4, s[28:29]
s_mov_b64 exec, -1
Lnocpf_1:
s_and_b32 s20, s2, 7
s_lshl_b32 s20, s20, 2
s_lshr_b32 s21, s2, 6
s_add_u32 s20, s20, s21
s_bfe_u32 s21, s2, 0x30003
s_and_b32 s22, s20, 1
s_lshl_b32 s22, s22, 3
s_add_u32 s22, s22, s21
s_lshr_b32 s44, s2, 5
s_lshl_b32 s44, s44, 3
s_and_b32 s25, s2, 7
s_add_u32 s44, s44, s25
s_bfe_u32 s45, s2, 0x20003
s_lshl_b32 s46, s44, 2
s_add_u32 s46, s46, s45
s_waitcnt lgkmcnt(0)
s_add_u32 s6, s4, 24805376
s_addc_u32 s7, s5, 0
s_load_dword s23, s[6:7], 0
s_mov_b32 s8, s4
s_mov_b32 s9, s5
s_mov_b32 s10, 25075712
s_mov_b32 s11, 0x20000
s_mov_b32 s14, 2621440
s_mov_b32 s15, 0x20000
s_mov_b32 s18, 4915200
s_mov_b32 s19, 0x20000
s_mov_b32 s50, 1280
s_mov_b32 s51, 0x20000
v_mov_b32 v10, 0
v_mov_b32 v13, 0
v_mov_b32 v5, 0
s_lshr_b32 s26, s3, 1
s_lshr_b32 s28, s21, 1
s_xor_b32 s26, s26, s28
s_and_b32 s27, s3, 1
s_and_b32 s38, s21, 1
s_sub_u32 s39, s3, 1
s_cmp_eq_u32 s3, 0
s_cselect_b32 s39, 0, s39
s_cmp_eq_u32 s3, 1
s_cselect_b32 s39, 1, s39
s_mul_i32 s39, s39, 10240
s_cmp_eq_u32 s3, 2
s_cselect_b32 s39, 143360, s39
s_lshl_b32 s28, s20, 2
s_add_u32 s28, s28, s26
s_mul_i32 s28, s28, 20480
s_mul_i32 s29, s27, 640
s_add_u32 s28, s28, s29
s_cmp_lg_u32 s3, 3
s_cbranch_scc1 Lnohelp_8
s_lshr_b32 s29, s2, 3
s_cmp_lt_u32 s29, 12
s_cbranch_scc1 Lnohelp_8
s_sub_u32 s29, s29, 12
s_mul_i32 s29, s29, 245760
s_and_b32 s30, s2, 7
s_lshl_b32 s31, s30, 7
s_add_u32 s29, s29, s31
v_and_b32 v6, 31, v1
v_mul_u32_u24 v6, 7680, v6
v_lshrrev_b32 v7, 5, v1
v_lshl_add_u32 v6, v7, 10, v6
buffer_load_dword v12, v6, s[16:19], s29 offen
s_cmp_ge_u32 s30, 4
s_cbranch_scc1 Lnohelp_8
s_mov_b32 exec_lo, -1
s_mov_b32 exec_hi, 0
buffer_load_dword v12, v6, s[16:19], s29 offen offset:2048
s_mov_b64 exec, -1
Lnohelp_8:
s_cmp_lg_u32 s3, 2
s_cbranch_scc1 Lz_3
s_cmp_ge_u32 s44, 20
s_cbranch_scc1 Lnomod_2
buffer_load_dwordx4 v[56:59], v2, s[48:51], 0 offen
buffer_load_dwordx4 v[60:63], v2, s[48:51], 0 offen offset:1024
v_bfe_u32 v65, v1, 3, 2
v_lshlrev_b32 v65, 3, v65
v_lshrrev_b32 v66, 5, v1
v_lshl_add_u32 v65, v66, 2, v65
v_bfe_u32 v66, v1, 1, 2
v_add_u32 v65, v65, v66
v_mul_u32_u24 v65, 7680, v65
v_and_b32 v66, 1, v1
v_lshl_add_u32 v64, v66, 4, v65
s_lshl_b32 s25, s46, 5
s_mov_b32 m0, 143360
s_nop 0
buffer_load_dwordx4 v64, s[16:19], s25 offen lds
s_add_u32 s25, s25, 245760
s_mov_b32 m0, 144384
s_nop 0
buffer_load_dwordx4 v64, s[16:19], s25 offen lds
s_add_u32 s25, s25, 245760
s_mov_b32 m0, 145408
s_nop 0
buffer_load_dwordx4 v64, s[16:19], s25 offen lds
s_add_u32 s25, s25, 245760
s_mov_b32 m0, 146432
s_nop 0
buffer_load_dwordx4 v64, s[16:19], s25 offen lds
s_add_u32 s25, s25, 245760
s_mov_b32 m0, 147456
s_nop 0
buffer_load_dwordx4 v64, s[16:19], s25 offen lds
s_add_u32 s25, s25, 245760
s_mov_b32 m0, 148480
s_nop 0
buffer_load_dwordx4 v64, s[16:19], s25 offen lds
s_add_u32 s25, s25, 245760
s_mov_b32 m0, 149504
s_nop 0
buffer_load_dwordx4 v64, s[16:19], s25 offen lds
s_add_u32 s25, s25, 245760
s_mov_b32 m0, 150528
s_nop 0
buffer_load_dwordx4 v64, s[16:19], s25 offen lds
s_add_u32 s25, s25, 245760
s_mov_b32 m0, 151552
s_nop 0
buffer_load_dwordx4 v64, s[16:19], s25 offen lds
s_add_u32 s25, s25, 245760
s_mov_b32 m0, 152576
s_nop 0
buffer_load_dwordx4 v64, s[16:19], s25 offen lds
s_add_u32 s25, s25, 245760
s_mov_b32 m0, 153600
s_nop 0
buffer_load_dwordx4 v64, s[16:19], s25 offen lds
s_add_u32 s25, s25, 245760
s_mov_b32 m0, 154624
s_nop 0
buffer_load_dwordx4 v64, s[16:19], s25 offen lds
s_add_u32 s25, s25, 245760
s_mov_b32 m0, 155648
s_nop 0
buffer_load_dwordx4 v64, s[16:19], s25 offen lds
s_add_u32 s25, s25, 245760
s_mov_b32 m0, 156672
s_nop 0
buffer_load_dwordx4 v64, s[16:19], s25 offen lds
s_add_u32 s25, s25, 245760
s_mov_b32 m0, 157696
s_nop 0
buffer_load_dwordx4 v64, s[16:19], s25 offen lds
s_add_u32 s25, s25, 245760
s_mov_b32 m0, 158720
s_nop 0
buffer_load_dwordx4 v64, s[16:19], s25 offen lds
s_add_u32 s25, s25, 245760
s_mov_b32 m0, 159744
s_nop 0
buffer_load_dwordx4 v64, s[16:19], s25 offen lds
s_add_u32 s25, s25, 245760
s_mov_b32 m0, 160768
s_nop 0
buffer_load_dwordx4 v64, s[16:19], s25 offen lds
s_add_u32 s25, s25, 245760
s_mov_b32 m0, 161792
s_nop 0
buffer_load_dwordx4 v64, s[16:19], s25 offen lds
s_add_u32 s25, s25, 245760
s_mov_b32 m0, 162816
s_nop 0
buffer_load_dwordx4 v64, s[16:19], s25 offen lds
s_branch Lz_3
Lnomod_2:
buffer_load_dwordx4 v[56:59], v2, s[48:51], 0 offen
buffer_load_dwordx4 v[60:63], v2, s[48:51], 0 offen offset:1024
Lz_3:
s_barrier
s_cmp_lt_u32 s3, 2
s_cbranch_scc1 Lw01_7
s_waitcnt lgkmcnt(0)
s_mul_i32 s23, s23, 1664525
s_add_u32 s23, s23, 1013904223
s_getreg_b32 s42, hwreg(HW_REG_XCC_ID, 0, 4)
s_add_u32 s42, s42, s23
s_cmp_lg_u32 s3, 2
s_cbranch_scc1 Lw2ns_9
s_cmp_ge_u32 s44, 20
s_cbranch_scc1 Lw2ns_9
s_waitcnt vmcnt(20)
v_lshlrev_b32 v68, 16, v56
v_and_b32 v69, 0xffff0000, v56
v_lshlrev_b32 v70, 16, v57
v_and_b32 v71, 0xffff0000, v57
v_lshlrev_b32 v72, 16, v58
v_and_b32 v73, 0xffff0000, v58
v_lshlrev_b32 v74, 16, v59
v_and_b32 v75, 0xffff0000, v59
v_lshlrev_b32 v76, 16, v60
v_and_b32 v77, 0xffff0000, v60
v_lshlrev_b32 v78, 16, v61
v_and_b32 v79, 0xffff0000, v61
v_lshlrev_b32 v80, 16, v62
v_and_b32 v81, 0xffff0000, v62
v_lshlrev_b32 v82, 16, v63
v_and_b32 v83, 0xffff0000, v63
s_mov_b32 s25, 0xbfb8aa3b
v_mul_f32 v84, s25, v68
v_mul_f32 v85, s25, v69
v_mul_f32 v86, s25, v70
v_mul_f32 v87, s25, v71
v_mul_f32 v88, s25, v72
v_mul_f32 v89, s25, v73
v_mul_f32 v90, s25, v74
v_mul_f32 v91, s25, v75
v_mul_f32 v92, s25, v76
v_mul_f32 v93, s25, v77
v_mul_f32 v94, s25, v78
v_mul_f32 v95, s25, v79
v_mul_f32 v96, s25, v80
v_mul_f32 v97, s25, v81
v_mul_f32 v98, s25, v82
v_mul_f32 v99, s25, v83
v_exp_f32 v84, v84
v_exp_f32 v85, v85
v_exp_f32 v86, v86
v_exp_f32 v87, v87
v_exp_f32 v88, v88
v_exp_f32 v89, v89
v_exp_f32 v90, v90
v_exp_f32 v91, v91
v_exp_f32 v92, v92
v_exp_f32 v93, v93
v_exp_f32 v94, v94
v_exp_f32 v95, v95
v_exp_f32 v96, v96
v_exp_f32 v97, v97
v_exp_f32 v98, v98
v_exp_f32 v99, v99
v_add_f32 v84, 1.0, v84
v_add_f32 v85, 1.0, v85
v_add_f32 v86, 1.0, v86
v_add_f32 v87, 1.0, v87
v_add_f32 v88, 1.0, v88
v_add_f32 v89, 1.0, v89
v_add_f32 v90, 1.0, v90
v_add_f32 v91, 1.0, v91
v_add_f32 v92, 1.0, v92
v_add_f32 v93, 1.0, v93
v_add_f32 v94, 1.0, v94
v_add_f32 v95, 1.0, v95
v_add_f32 v96, 1.0, v96
v_add_f32 v97, 1.0, v97
v_add_f32 v98, 1.0, v98
v_add_f32 v99, 1.0, v99
v_rcp_f32 v84, v84
v_rcp_f32 v85, v85
v_rcp_f32 v86, v86
v_rcp_f32 v87, v87
v_rcp_f32 v88, v88
v_rcp_f32 v89, v89
v_rcp_f32 v90, v90
v_rcp_f32 v91, v91
v_rcp_f32 v92, v92
v_rcp_f32 v93, v93
v_rcp_f32 v94, v94
v_rcp_f32 v95, v95
v_rcp_f32 v96, v96
v_rcp_f32 v97, v97
v_rcp_f32 v98, v98
v_rcp_f32 v99, v99
v_mul_f32 v68, v68, v84
v_mul_f32 v69, v69, v85
v_mul_f32 v70, v70, v86
v_mul_f32 v71, v71, v87
v_mul_f32 v72, v72, v88
v_mul_f32 v73, v73, v89
v_mul_f32 v74, v74, v90
v_mul_f32 v75, v75, v91
v_mul_f32 v76, v76, v92
v_mul_f32 v77, v77, v93
v_mul_f32 v78, v78, v94
v_mul_f32 v79, v79, v95
v_mul_f32 v80, v80, v96
v_mul_f32 v81, v81, v97
v_mul_f32 v82, v82, v98
v_mul_f32 v83, v83, v99
v_cvt_pk_bf16_f32 v56, v68, v69
v_cvt_pk_bf16_f32 v57, v70, v71
v_cvt_pk_bf16_f32 v58, v72, v73
v_cvt_pk_bf16_f32 v59, v74, v75
v_cvt_pk_bf16_f32 v60, v76, v77
v_cvt_pk_bf16_f32 v61, v78, v79
v_cvt_pk_bf16_f32 v62, v80, v81
v_cvt_pk_bf16_f32 v63, v82, v83
v_add_u32 v64, 138240, v2
ds_write_b128 v64, v[56:59]
ds_write_b128 v64, v[60:63] offset:1024
v_lshrrev_b32 v65, 4, v1
v_lshlrev_b32 v65, 4, v65
v_add_u32 v65, 138240, v65
v_lshlrev_b32 v66, 3, v1
v_add_u32 v66, 143360, v66
s_waitcnt lgkmcnt(0)
ds_read_b128 v[68:71], v65 offset:0
ds_read_b128 v[72:75], v65 offset:64
ds_read_b128 v[76:79], v65 offset:128
ds_read_b128 v[80:83], v65 offset:192
ds_read_b128 v[84:87], v65 offset:256
s_waitcnt vmcnt(15)
ds_read_b64_tr_b16 v[108:109], v66 offset:0
ds_read_b64_tr_b16 v[110:111], v66 offset:512
ds_read_b64_tr_b16 v[112:113], v66 offset:1024
ds_read_b64_tr_b16 v[114:115], v66 offset:1536
ds_read_b64_tr_b16 v[116:117], v66 offset:2048
ds_read_b64_tr_b16 v[118:119], v66 offset:2560
ds_read_b64_tr_b16 v[120:121], v66 offset:3072
ds_read_b64_tr_b16 v[122:123], v66 offset:3584
ds_read_b64_tr_b16 v[124:125], v66 offset:4096
ds_read_b64_tr_b16 v[126:127], v66 offset:4608
ds_read_b128 v[88:91], v65 offset:320
ds_read_b128 v[92:95], v65 offset:384
ds_read_b128 v[96:99], v65 offset:448
ds_read_b128 v[100:103], v65 offset:512
ds_read_b128 v[104:107], v65 offset:576
s_waitcnt vmcnt(10)
ds_read_b64_tr_b16 v[128:129], v66 offset:5120
ds_read_b64_tr_b16 v[130:131], v66 offset:5632
ds_read_b64_tr_b16 v[132:133], v66 offset:6144
ds_read_b64_tr_b16 v[134:135], v66 offset:6656
ds_read_b64_tr_b16 v[136:137], v66 offset:7168
ds_read_b64_tr_b16 v[138:139], v66 offset:7680
ds_read_b64_tr_b16 v[140:141], v66 offset:8192
ds_read_b64_tr_b16 v[142:143], v66 offset:8704
ds_read_b64_tr_b16 v[144:145], v66 offset:9216
ds_read_b64_tr_b16 v[146:147], v66 offset:9728
s_waitcnt lgkmcnt(15)
v_mfma_f32_16x16x32_bf16 v[56:59], v[108:111], v[68:71], 0
v_mfma_f32_16x16x32_bf16 v[56:59], v[112:115], v[72:75], v[56:59]
v_mfma_f32_16x16x32_bf16 v[56:59], v[116:119], v[76:79], v[56:59]
v_mfma_f32_16x16x32_bf16 v[56:59], v[120:123], v[80:83], v[56:59]
v_mfma_f32_16x16x32_bf16 v[56:59], v[124:127], v[84:87], v[56:59]
ds_read_b128 v[68:71], v65 offset:640
ds_read_b128 v[72:75], v65 offset:704
ds_read_b128 v[76:79], v65 offset:768
ds_read_b128 v[80:83], v65 offset:832
ds_read_b128 v[84:87], v65 offset:896
s_waitcnt vmcnt(5)
ds_read_b64_tr_b16 v[108:109], v66 offset:10240
ds_read_b64_tr_b16 v[110:111], v66 offset:10752
ds_read_b64_tr_b16 v[112:113], v66 offset:11264
ds_read_b64_tr_b16 v[114:115], v66 offset:11776
ds_read_b64_tr_b16 v[116:117], v66 offset:12288
ds_read_b64_tr_b16 v[118:119], v66 offset:12800
ds_read_b64_tr_b16 v[120:121], v66 offset:13312
ds_read_b64_tr_b16 v[122:123], v66 offset:13824
ds_read_b64_tr_b16 v[124:125], v66 offset:14336
ds_read_b64_tr_b16 v[126:127], v66 offset:14848
s_waitcnt lgkmcnt(15)
v_mfma_f32_16x16x32_bf16 v[56:59], v[128:131], v[88:91], v[56:59]
v_mfma_f32_16x16x32_bf16 v[56:59], v[132:135], v[92:95], v[56:59]
v_mfma_f32_16x16x32_bf16 v[56:59], v[136:139], v[96:99], v[56:59]
v_mfma_f32_16x16x32_bf16 v[56:59], v[140:143], v[100:103], v[56:59]
v_mfma_f32_16x16x32_bf16 v[56:59], v[144:147], v[104:107], v[56:59]
ds_read_b128 v[88:91], v65 offset:960
ds_read_b128 v[92:95], v65 offset:1024
ds_read_b128 v[96:99], v65 offset:1088
ds_read_b128 v[100:103], v65 offset:1152
ds_read_b128 v[104:107], v65 offset:1216
s_waitcnt vmcnt(0)
ds_read_b64_tr_b16 v[128:129], v66 offset:15360
ds_read_b64_tr_b16 v[130:131], v66 offset:15872
ds_read_b64_tr_b16 v[132:133], v66 offset:16384
ds_read_b64_tr_b16 v[134:135], v66 offset:16896
ds_read_b64_tr_b16 v[136:137], v66 offset:17408
ds_read_b64_tr_b16 v[138:139], v66 offset:17920
ds_read_b64_tr_b16 v[140:141], v66 offset:18432
ds_read_b64_tr_b16 v[142:143], v66 offset:18944
ds_read_b64_tr_b16 v[144:145], v66 offset:19456
ds_read_b64_tr_b16 v[146:147], v66 offset:19968
s_waitcnt lgkmcnt(15)
v_mfma_f32_16x16x32_bf16 v[56:59], v[108:111], v[68:71], v[56:59]
v_mfma_f32_16x16x32_bf16 v[56:59], v[112:115], v[72:75], v[56:59]
v_mfma_f32_16x16x32_bf16 v[56:59], v[116:119], v[76:79], v[56:59]
v_mfma_f32_16x16x32_bf16 v[56:59], v[120:123], v[80:83], v[56:59]
v_mfma_f32_16x16x32_bf16 v[56:59], v[124:127], v[84:87], v[56:59]
s_waitcnt lgkmcnt(0)
v_mfma_f32_16x16x32_bf16 v[56:59], v[128:131], v[88:91], v[56:59]
v_mfma_f32_16x16x32_bf16 v[56:59], v[132:135], v[92:95], v[56:59]
v_mfma_f32_16x16x32_bf16 v[56:59], v[136:139], v[96:99], v[56:59]
v_mfma_f32_16x16x32_bf16 v[56:59], v[140:143], v[100:103], v[56:59]
v_mfma_f32_16x16x32_bf16 v[56:59], v[144:147], v[104:107], v[56:59]
s_nop 7
v_cvt_pk_bf16_f32 v60, v56, v57
v_cvt_pk_bf16_f32 v62, v58, v59
s_mul_i32 s30, s46, 1639
s_lshr_b32 s30, s30, 16
s_cmp_eq_u32 s30, 1
s_cselect_b32 s31, 1, 0
s_cmp_eq_u32 s30, 4
s_cselect_b32 s31, 1, s31
s_cmp_eq_u32 s31, 0
s_cbranch_scc1 Lnoone_11
v_lshlrev_b32 v56, 16, v60
v_and_b32 v57, 0xffff0000, v60
v_add_f32 v56, 1.0, v56
v_add_f32 v57, 1.0, v57
v_cvt_pk_bf16_f32 v60, v56, v57
v_lshlrev_b32 v56, 16, v62
v_and_b32 v57, 0xffff0000, v62
v_add_f32 v56, 1.0, v56
v_add_f32 v57, 1.0, v57
v_cvt_pk_bf16_f32 v62, v56, v57
Lnoone_11:
v_mov_b32 v61, s23
v_mov_b32 v63, s23
s_lshl_b32 s30, s46, 7
s_add_u32 s30, s30, 24875008
v_and_b32 v65, 48, v1
s_mov_b32 exec_lo, 0x10001
s_mov_b32 exec_hi, 0x10001
buffer_store_dwordx4 v[60:63], v65, s[8:11], s30 offen sc1
s_mov_b64 exec, -1
v_mov_b32 v5, v1
v_mul_u32_u24 v6, 1639, v5
v_lshrrev_b32 v6, 16, v6
v_mul_u32_u24 v7, 40, v6
v_sub_u32 v7, v5, v7
v_bfe_u32 v4, v6, 1, 3
v_xor_b32 v7, v7, v4
v_mul_u32_u24 v6, 1280, v6
v_lshl_add_u32 v4, v7, 4, v6
s_add_u32 m0, s39, 0
s_nop 0
buffer_load_dwordx4 v4, s[12:15], s28 offen lds
v_add_u32 v5, 64, v5
v_mul_u32_u24 v6, 1639, v5
v_lshrrev_b32 v6, 16, v6
v_mul_u32_u24 v7, 40, v6
v_sub_u32 v7, v5, v7
v_bfe_u32 v4, v6, 1, 3
v_xor_b32 v7, v7, v4
v_mul_u32_u24 v6, 1280, v6
v_lshl_add_u32 v4, v7, 4, v6
s_add_u32 m0, s39, 1024
s_nop 0
buffer_load_dwordx4 v4, s[12:15], s28 offen lds
v_add_u32 v5, 64, v5
v_mul_u32_u24 v6, 1639, v5
v_lshrrev_b32 v6, 16, v6
v_mul_u32_u24 v7, 40, v6
v_sub_u32 v7, v5, v7
v_bfe_u32 v4, v6, 1, 3
v_xor_b32 v7, v7, v4
v_mul_u32_u24 v6, 1280, v6
v_lshl_add_u32 v4, v7, 4, v6
s_add_u32 m0, s39, 2048
s_nop 0
buffer_load_dwordx4 v4, s[12:15], s28 offen lds
v_add_u32 v5, 64, v5
v_mul_u32_u24 v6, 1639, v5
v_lshrrev_b32 v6, 16, v6
v_mul_u32_u24 v7, 40, v6
v_sub_u32 v7, v5, v7
v_bfe_u32 v4, v6, 1, 3
v_xor_b32 v7, v7, v4
v_mul_u32_u24 v6, 1280, v6
v_lshl_add_u32 v4, v7, 4, v6
s_add_u32 m0, s39, 3072
s_nop 0
buffer_load_dwordx4 v4, s[12:15], s28 offen lds
v_add_u32 v5, 64, v5
v_mul_u32_u24 v6, 1639, v5
v_lshrrev_b32 v6, 16, v6
v_mul_u32_u24 v7, 40, v6
v_sub_u32 v7, v5, v7
v_bfe_u32 v4, v6, 1, 3
v_xor_b32 v7, v7, v4
v_mul_u32_u24 v6, 1280, v6
v_lshl_add_u32 v4, v7, 4, v6
s_add_u32 m0, s39, 4096
s_nop 0
buffer_load_dwordx4 v4, s[12:15], s28 offen lds
v_add_u32 v5, 64, v5
v_mul_u32_u24 v6, 1639, v5
v_lshrrev_b32 v6, 16, v6
v_mul_u32_u24 v7, 40, v6
v_sub_u32 v7, v5, v7
v_bfe_u32 v4, v6, 1, 3
v_xor_b32 v7, v7, v4
v_mul_u32_u24 v6, 1280, v6
v_lshl_add_u32 v4, v7, 4, v6
s_add_u32 m0, s39, 5120
s_nop 0
buffer_load_dwordx4 v4, s[12:15], s28 offen lds
v_add_u32 v5, 64, v5
v_mul_u32_u24 v6, 1639, v5
v_lshrrev_b32 v6, 16, v6
v_mul_u32_u24 v7, 40, v6
v_sub_u32 v7, v5, v7
v_bfe_u32 v4, v6, 1, 3
v_xor_b32 v7, v7, v4
v_mul_u32_u24 v6, 1280, v6
v_lshl_add_u32 v4, v7, 4, v6
s_add_u32 m0, s39, 6144
s_nop 0
buffer_load_dwordx4 v4, s[12:15], s28 offen lds
v_add_u32 v5, 64, v5
v_mul_u32_u24 v6, 1639, v5
v_lshrrev_b32 v6, 16, v6
v_mul_u32_u24 v7, 40, v6
v_sub_u32 v7, v5, v7
v_bfe_u32 v4, v6, 1, 3
v_xor_b32 v7, v7, v4
v_mul_u32_u24 v6, 1280, v6
v_lshl_add_u32 v4, v7, 4, v6
s_add_u32 m0, s39, 7168
s_nop 0
buffer_load_dwordx4 v4, s[12:15], s28 offen lds
v_add_u32 v5, 64, v5
v_mul_u32_u24 v6, 1639, v5
v_lshrrev_b32 v6, 16, v6
v_mul_u32_u24 v7, 40, v6
v_sub_u32 v7, v5, v7
v_bfe_u32 v4, v6, 1, 3
v_xor_b32 v7, v7, v4
v_mul_u32_u24 v6, 1280, v6
v_lshl_add_u32 v4, v7, 4, v6
s_add_u32 m0, s39, 8192
s_nop 0
buffer_load_dwordx4 v4, s[12:15], s28 offen lds
v_add_u32 v5, 64, v5
v_mul_u32_u24 v6, 1639, v5
v_lshrrev_b32 v6, 16, v6
v_mul_u32_u24 v7, 40, v6
v_sub_u32 v7, v5, v7
v_bfe_u32 v4, v6, 1, 3
v_xor_b32 v7, v7, v4
v_mul_u32_u24 v6, 1280, v6
v_lshl_add_u32 v4, v7, 4, v6
s_add_u32 m0, s39, 9216
s_nop 0
buffer_load_dwordx4 v4, s[12:15], s28 offen lds
s_waitcnt vmcnt(0)
s_branch Lstats_10
Lw2ns_9:
s_cmp_lt_u32 s3, 4
s_cbranch_scc1 Lnotouch_12
s_load_dwordx2 s[16:17], s[0:1], 8
s_mov_b32 s18, 819200
s_mov_b32 s19, 0x20000
s_lshr_b32 s29, s2, 3
s_mul_i32 s29, s29, 25600
s_mul_i32 s31, s43, 6400
s_add_u32 s29, s29, s31
s_mul_i32 s31, s20, 81920
s_mul_i32 s34, s21, 10240
s_add_u32 s31, s31, s34
s_mul_i32 s34, s43, 2560
s_add_u32 s31, s31, s34
v_lshlrev_b32 v5, 7, v1
s_waitcnt lgkmcnt(0)
Lnotouch_12:
v_mov_b32 v6, 136240
s_mov_b32 s25, 4194304
Llw_13:
ds_read_b32 v7, v6
s_waitcnt lgkmcnt(0)
v_readfirstlane_b32 s30, v7
s_nop 1
s_cmp_eq_u32 s30, s23
s_cbranch_scc1 Llwd_14
s_sleep 1
s_sub_u32 s25, s25, 1
s_cmp_lg_u32 s25, 0
s_cbranch_scc1 Llw_13
Llwd_14:
v_mov_b32 v6, 136244
s_mov_b32 s25, 4194304
Llw_15:
ds_read_b32 v7, v6
s_waitcnt lgkmcnt(0)
v_readfirstlane_b32 s30, v7
s_nop 1
s_cmp_eq_u32 s30, s23
s_cbranch_scc1 Llwd_16
s_sleep 1
s_sub_u32 s25, s25, 1
s_cmp_lg_u32 s25, 0
s_cbranch_scc1 Llw_15
Llwd_16:
v_mov_b32 v5, v1
v_mul_u32_u24 v6, 1639, v5
v_lshrrev_b32 v6, 16, v6
v_mul_u32_u24 v7, 40, v6
v_sub_u32 v7, v5, v7
v_bfe_u32 v4, v6, 1, 3
v_xor_b32 v7, v7, v4
v_mul_u32_u24 v6, 1280, v6
v_lshl_add_u32 v4, v7, 4, v6
s_add_u32 m0, s39, 0
s_nop 0
buffer_load_dwordx4 v4, s[12:15], s28 offen lds
v_add_u32 v5, 64, v5
v_mul_u32_u24 v6, 1639, v5
v_lshrrev_b32 v6, 16, v6
v_mul_u32_u24 v7, 40, v6
v_sub_u32 v7, v5, v7
v_bfe_u32 v4, v6, 1, 3
v_xor_b32 v7, v7, v4
v_mul_u32_u24 v6, 1280, v6
v_lshl_add_u32 v4, v7, 4, v6
s_add_u32 m0, s39, 1024
s_nop 0
buffer_load_dwordx4 v4, s[12:15], s28 offen lds
v_add_u32 v5, 64, v5
v_mul_u32_u24 v6, 1639, v5
v_lshrrev_b32 v6, 16, v6
v_mul_u32_u24 v7, 40, v6
v_sub_u32 v7, v5, v7
v_bfe_u32 v4, v6, 1, 3
v_xor_b32 v7, v7, v4
v_mul_u32_u24 v6, 1280, v6
v_lshl_add_u32 v4, v7, 4, v6
s_add_u32 m0, s39, 2048
s_nop 0
buffer_load_dwordx4 v4, s[12:15], s28 offen lds
v_add_u32 v5, 64, v5
v_mul_u32_u24 v6, 1639, v5
v_lshrrev_b32 v6, 16, v6
v_mul_u32_u24 v7, 40, v6
v_sub_u32 v7, v5, v7
v_bfe_u32 v4, v6, 1, 3
v_xor_b32 v7, v7, v4
v_mul_u32_u24 v6, 1280, v6
v_lshl_add_u32 v4, v7, 4, v6
s_add_u32 m0, s39, 3072
s_nop 0
buffer_load_dwordx4 v4, s[12:15], s28 offen lds
v_add_u32 v5, 64, v5
v_mul_u32_u24 v6, 1639, v5
v_lshrrev_b32 v6, 16, v6
v_mul_u32_u24 v7, 40, v6
v_sub_u32 v7, v5, v7
v_bfe_u32 v4, v6, 1, 3
v_xor_b32 v7, v7, v4
v_mul_u32_u24 v6, 1280, v6
v_lshl_add_u32 v4, v7, 4, v6
s_add_u32 m0, s39, 4096
s_nop 0
buffer_load_dwordx4 v4, s[12:15], s28 offen lds
v_add_u32 v5, 64, v5
v_mul_u32_u24 v6, 1639, v5
v_lshrrev_b32 v6, 16, v6
v_mul_u32_u24 v7, 40, v6
v_sub_u32 v7, v5, v7
v_bfe_u32 v4, v6, 1, 3
v_xor_b32 v7, v7, v4
v_mul_u32_u24 v6, 1280, v6
v_lshl_add_u32 v4, v7, 4, v6
s_add_u32 m0, s39, 5120
s_nop 0
buffer_load_dwordx4 v4, s[12:15], s28 offen lds
v_add_u32 v5, 64, v5
v_mul_u32_u24 v6, 1639, v5
v_lshrrev_b32 v6, 16, v6
v_mul_u32_u24 v7, 40, v6
v_sub_u32 v7, v5, v7
v_bfe_u32 v4, v6, 1, 3
v_xor_b32 v7, v7, v4
v_mul_u32_u24 v6, 1280, v6
v_lshl_add_u32 v4, v7, 4, v6
s_add_u32 m0, s39, 6144
s_nop 0
buffer_load_dwordx4 v4, s[12:15], s28 offen lds
v_add_u32 v5, 64, v5
v_mul_u32_u24 v6, 1639, v5
v_lshrrev_b32 v6, 16, v6
v_mul_u32_u24 v7, 40, v6
v_sub_u32 v7, v5, v7
v_bfe_u32 v4, v6, 1, 3
v_xor_b32 v7, v7, v4
v_mul_u32_u24 v6, 1280, v6
v_lshl_add_u32 v4, v7, 4, v6
s_add_u32 m0, s39, 7168
s_nop 0
buffer_load_dwordx4 v4, s[12:15], s28 offen lds
v_add_u32 v5, 64, v5
v_mul_u32_u24 v6, 1639, v5
v_lshrrev_b32 v6, 16, v6
v_mul_u32_u24 v7, 40, v6
v_sub_u32 v7, v5, v7
v_bfe_u32 v4, v6, 1, 3
v_xor_b32 v7, v7, v4
v_mul_u32_u24 v6, 1280, v6
v_lshl_add_u32 v4, v7, 4, v6
s_add_u32 m0, s39, 8192
s_nop 0
buffer_load_dwordx4 v4, s[12:15], s28 offen lds
v_add_u32 v5, 64, v5
v_mul_u32_u24 v6, 1639, v5
v_lshrrev_b32 v6, 16, v6
v_mul_u32_u24 v7, 40, v6
v_sub_u32 v7, v5, v7
v_bfe_u32 v4, v6, 1, 3
v_xor_b32 v7, v7, v4
v_mul_u32_u24 v6, 1280, v6
v_lshl_add_u32 v4, v7, 4, v6
s_add_u32 m0, s39, 9216
s_nop 0
buffer_load_dwordx4 v4, s[12:15], s28 offen lds
v_lshlrev_b32 v5, 7, v1
s_cmp_lt_u32 s3, 4
s_cbranch_scc1 Lnotouch_17
s_mov_b32 exec_lo, 0xffffffff
s_mov_b32 exec_hi, 0x3ffff
buffer_load_dword v15, v5, s[16:19], s29 offen
s_mov_b64 exec, -1
Lnotouch_17:
s_cmp_ge_u32 s3, 4
s_cbranch_scc1 Lw47_4
s_cmp_lg_u32 s3, 2
s_cbranch_scc1 Lxw_5
s_waitcnt vmcnt(10)
s_mov_b32 s29, 0xbfb8aa3b
v_lshlrev_b32 v68, 16, v56
v_and_b32 v69, 0xffff0000, v56
v_lshlrev_b32 v70, 16, v57
v_and_b32 v71, 0xffff0000, v57
v_lshlrev_b32 v72, 16, v58
v_and_b32 v73, 0xffff0000, v58
v_lshlrev_b32 v74, 16, v59
v_and_b32 v75, 0xffff0000, v59
v_mul_f32 v76, s29, v68
v_mul_f32 v77, s29, v69
v_mul_f32 v78, s29, v70
v_mul_f32 v79, s29, v71
v_mul_f32 v80, s29, v72
v_mul_f32 v81, s29, v73
v_mul_f32 v82, s29, v74
v_mul_f32 v83, s29, v75
v_exp_f32 v76, v76
v_exp_f32 v77, v77
v_exp_f32 v78, v78
v_exp_f32 v79, v79
v_exp_f32 v80, v80
v_exp_f32 v81, v81
v_exp_f32 v82, v82
v_exp_f32 v83, v83
v_add_f32 v76, 1.0, v76
v_add_f32 v77, 1.0, v77
v_add_f32 v78, 1.0, v78
v_add_f32 v79, 1.0, v79
v_add_f32 v80, 1.0, v80
v_add_f32 v81, 1.0, v81
v_add_f32 v82, 1.0, v82
v_add_f32 v83, 1.0, v83
v_rcp_f32 v76, v76
v_rcp_f32 v77, v77
v_rcp_f32 v78, v78
v_rcp_f32 v79, v79
v_rcp_f32 v80, v80
v_rcp_f32 v81, v81
v_rcp_f32 v82, v82
v_rcp_f32 v83, v83
v_mul_f32 v68, v68, v76
v_mul_f32 v69, v69, v77
v_mul_f32 v70, v70, v78
v_mul_f32 v71, v71, v79
v_mul_f32 v72, v72, v80
v_mul_f32 v73, v73, v81
v_mul_f32 v74, v74, v82
v_mul_f32 v75, v75, v83
v_cvt_pk_bf16_f32 v56, v68, v69
v_cvt_pk_bf16_f32 v57, v70, v71
v_cvt_pk_bf16_f32 v58, v72, v73
v_cvt_pk_bf16_f32 v59, v74, v75
v_lshlrev_b32 v68, 16, v60
v_and_b32 v69, 0xffff0000, v60
v_lshlrev_b32 v70, 16, v61
v_and_b32 v71, 0xffff0000, v61
v_lshlrev_b32 v72, 16, v62
v_and_b32 v73, 0xffff0000, v62
v_lshlrev_b32 v74, 16, v63
v_and_b32 v75, 0xffff0000, v63
v_mul_f32 v76, s29, v68
v_mul_f32 v77, s29, v69
v_mul_f32 v78, s29, v70
v_mul_f32 v79, s29, v71
v_mul_f32 v80, s29, v72
v_mul_f32 v81, s29, v73
v_mul_f32 v82, s29, v74
v_mul_f32 v83, s29, v75
v_exp_f32 v76, v76
v_exp_f32 v77, v77
v_exp_f32 v78, v78
v_exp_f32 v79, v79
v_exp_f32 v80, v80
v_exp_f32 v81, v81
v_exp_f32 v82, v82
v_exp_f32 v83, v83
v_add_f32 v76, 1.0, v76
v_add_f32 v77, 1.0, v77
v_add_f32 v78, 1.0, v78
v_add_f32 v79, 1.0, v79
v_add_f32 v80, 1.0, v80
v_add_f32 v81, 1.0, v81
v_add_f32 v82, 1.0, v82
v_add_f32 v83, 1.0, v83
v_rcp_f32 v76, v76
v_rcp_f32 v77, v77
v_rcp_f32 v78, v78
v_rcp_f32 v79, v79
v_rcp_f32 v80, v80
v_rcp_f32 v81, v81
v_rcp_f32 v82, v82
v_rcp_f32 v83, v83
v_mul_f32 v68, v68, v76
v_mul_f32 v69, v69, v77
v_mul_f32 v70, v70, v78
v_mul_f32 v71, v71, v79
v_mul_f32 v72, v72, v80
v_mul_f32 v73, v73, v81
v_mul_f32 v74, v74, v82
v_mul_f32 v75, v75, v83
v_cvt_pk_bf16_f32 v60, v68, v69
v_cvt_pk_bf16_f32 v61, v70, v71
v_cvt_pk_bf16_f32 v62, v72, v73
v_cvt_pk_bf16_f32 v63, v74, v75
v_add_u32 v64, 160768, v2
ds_write_b128 v64, v[56:59]
ds_write_b128 v64, v[60:63] offset:1024
s_branch Lxw_5
Lw01_7:
s_setprio 2
s_lshl_b32 s29, s38, 3
s_add_u32 s29, s29, 16
s_load_dwordx2 s[48:49], s[0:1], s29
s_mov_b32 s50, 25600
s_mov_b32 s51, 0x20000
v_mov_b32 v5, v1
v_mul_u32_u24 v6, 1639, v5
v_lshrrev_b32 v6, 16, v6
v_mul_u32_u24 v7, 40, v6
v_sub_u32 v7, v5, v7
v_bfe_u32 v4, v6, 1, 3
v_xor_b32 v7, v7, v4
v_mul_u32_u24 v6, 1280, v6
v_lshl_add_u32 v4, v7, 4, v6
s_add_u32 m0, s39, 0
s_nop 0
buffer_load_dwordx4 v4, s[12:15], s28 offen lds
v_add_u32 v5, 64, v5
v_mul_u32_u24 v6, 1639, v5
v_lshrrev_b32 v6, 16, v6
v_mul_u32_u24 v7, 40, v6
v_sub_u32 v7, v5, v7
v_bfe_u32 v4, v6, 1, 3
v_xor_b32 v7, v7, v4
v_mul_u32_u24 v6, 1280, v6
v_lshl_add_u32 v4, v7, 4, v6
s_add_u32 m0, s39, 1024
s_nop 0
buffer_load_dwordx4 v4, s[12:15], s28 offen lds
v_add_u32 v5, 64, v5
v_mul_u32_u24 v6, 1639, v5
v_lshrrev_b32 v6, 16, v6
v_mul_u32_u24 v7, 40, v6
v_sub_u32 v7, v5, v7
v_bfe_u32 v4, v6, 1, 3
v_xor_b32 v7, v7, v4
v_mul_u32_u24 v6, 1280, v6
v_lshl_add_u32 v4, v7, 4, v6
s_add_u32 m0, s39, 2048
s_nop 0
buffer_load_dwordx4 v4, s[12:15], s28 offen lds
v_add_u32 v5, 64, v5
v_mul_u32_u24 v6, 1639, v5
v_lshrrev_b32 v6, 16, v6
v_mul_u32_u24 v7, 40, v6
v_sub_u32 v7, v5, v7
v_bfe_u32 v4, v6, 1, 3
v_xor_b32 v7, v7, v4
v_mul_u32_u24 v6, 1280, v6
v_lshl_add_u32 v4, v7, 4, v6
s_add_u32 m0, s39, 3072
s_nop 0
buffer_load_dwordx4 v4, s[12:15], s28 offen lds
v_add_u32 v5, 64, v5
v_mul_u32_u24 v6, 1639, v5
v_lshrrev_b32 v6, 16, v6
v_mul_u32_u24 v7, 40, v6
v_sub_u32 v7, v5, v7
v_bfe_u32 v4, v6, 1, 3
v_xor_b32 v7, v7, v4
v_mul_u32_u24 v6, 1280, v6
v_lshl_add_u32 v4, v7, 4, v6
s_add_u32 m0, s39, 4096
s_nop 0
buffer_load_dwordx4 v4, s[12:15], s28 offen lds
v_add_u32 v5, 64, v5
v_mul_u32_u24 v6, 1639, v5
v_lshrrev_b32 v6, 16, v6
v_mul_u32_u24 v7, 40, v6
v_sub_u32 v7, v5, v7
v_bfe_u32 v4, v6, 1, 3
v_xor_b32 v7, v7, v4
v_mul_u32_u24 v6, 1280, v6
v_lshl_add_u32 v4, v7, 4, v6
s_add_u32 m0, s39, 5120
s_nop 0
buffer_load_dwordx4 v4, s[12:15], s28 offen lds
v_add_u32 v5, 64, v5
v_mul_u32_u24 v6, 1639, v5
v_lshrrev_b32 v6, 16, v6
v_mul_u32_u24 v7, 40, v6
v_sub_u32 v7, v5, v7
v_bfe_u32 v4, v6, 1, 3
v_xor_b32 v7, v7, v4
v_mul_u32_u24 v6, 1280, v6
v_lshl_add_u32 v4, v7, 4, v6
s_add_u32 m0, s39, 6144
s_nop 0
buffer_load_dwordx4 v4, s[12:15], s28 offen lds
v_add_u32 v5, 64, v5
v_mul_u32_u24 v6, 1639, v5
v_lshrrev_b32 v6, 16, v6
v_mul_u32_u24 v7, 40, v6
v_sub_u32 v7, v5, v7
v_bfe_u32 v4, v6, 1, 3
v_xor_b32 v7, v7, v4
v_mul_u32_u24 v6, 1280, v6
v_lshl_add_u32 v4, v7, 4, v6
s_add_u32 m0, s39, 7168
s_nop 0
buffer_load_dwordx4 v4, s[12:15], s28 offen lds
v_add_u32 v5, 64, v5
v_mul_u32_u24 v6, 1639, v5
v_lshrrev_b32 v6, 16, v6
v_mul_u32_u24 v7, 40, v6
v_sub_u32 v7, v5, v7
v_bfe_u32 v4, v6, 1, 3
v_xor_b32 v7, v7, v4
v_mul_u32_u24 v6, 1280, v6
v_lshl_add_u32 v4, v7, 4, v6
s_add_u32 m0, s39, 8192
s_nop 0
buffer_load_dwordx4 v4, s[12:15], s28 offen lds
v_add_u32 v5, 64, v5
v_mul_u32_u24 v6, 1639, v5
v_lshrrev_b32 v6, 16, v6
v_mul_u32_u24 v7, 40, v6
v_sub_u32 v7, v5, v7
v_bfe_u32 v4, v6, 1, 3
v_xor_b32 v7, v7, v4
v_mul_u32_u24 v6, 1280, v6
v_lshl_add_u32 v4, v7, 4, v6
s_add_u32 m0, s39, 9216
s_nop 0
buffer_load_dwordx4 v4, s[12:15], s28 offen lds
s_mul_i32 s29, s3, 12288
s_add_u32 s30, s29, 102400
s_waitcnt lgkmcnt(0)
s_add_u32 m0, s30, 0
s_nop 0
buffer_load_dwordx4 v2, s[48:51], s29 offen lds
buffer_load_dwordx4 v2, s[48:51], s29 offen offset:1024 lds
buffer_load_dwordx4 v2, s[48:51], s29 offen offset:2048 lds
buffer_load_dwordx4 v2, s[48:51], s29 offen offset:3072 lds
s_add_u32 s29, s29, 4096
s_add_u32 m0, s30, 4096
s_nop 0
buffer_load_dwordx4 v2, s[48:51], s29 offen lds
buffer_load_dwordx4 v2, s[48:51], s29 offen offset:1024 lds
buffer_load_dwordx4 v2, s[48:51], s29 offen offset:2048 lds
buffer_load_dwordx4 v2, s[48:51], s29 offen offset:3072 lds
s_add_u32 s29, s29, 4096
s_add_u32 m0, s30, 8192
s_nop 0
buffer_load_dwordx4 v2, s[48:51], s29 offen lds
buffer_load_dwordx4 v2, s[48:51], s29 offen offset:1024 lds
buffer_load_dwordx4 v2, s[48:51], s29 offen offset:2048 lds
buffer_load_dwordx4 v2, s[48:51], s29 offen offset:3072 lds
s_add_u32 s29, s29, 4096
s_add_u32 m0, s30, 12288
s_nop 0
buffer_load_dwordx4 v2, s[48:51], s29 offen lds
s_mul_i32 s23, s23, 1664525
s_add_u32 s23, s23, 1013904223
s_getreg_b32 s42, hwreg(HW_REG_XCC_ID, 0, 4)
s_add_u32 s42, s42, s23
s_lshl_b32 s29, s3, 2
s_add_u32 s29, s29, 136240
v_mov_b32 v6, s29
v_mov_b32 v7, s23
s_mov_b64 exec, 1
ds_write_b32 v6, v7
s_mov_b64 exec, -1
s_branch Lxw_5
Lw47_4:
v_bfe_u32 v11, v1, 3, 2
v_lshlrev_b32 v11, 3, v11
v_lshrrev_b32 v12, 5, v1
v_lshl_add_u32 v11, v12, 2, v11
v_bfe_u32 v12, v1, 1, 2
v_add_u32 v11, v11, v12
v_mul_u32_u24 v11, 1280, v11
v_and_b32 v12, 1, v1
v_lshl_add_u32 v10, v12, 4, v11
v_bfe_u32 v11, v1, 4, 1
v_lshlrev_b32 v13, 3, v11
v_lshrrev_b32 v12, 5, v1
v_lshl_add_u32 v13, v12, 2, v13
v_bfe_u32 v12, v1, 2, 2
v_add_u32 v13, v13, v12
v_mul_u32_u24 v13, 1280, v13
v_bfe_u32 v12, v1, 1, 1
v_xor_b32 v12, v12, v11
v_lshl_add_u32 v13, v12, 5, v13
v_and_b32 v12, 1, v1
v_lshl_add_u32 v13, v12, 4, v13
s_waitcnt lgkmcnt(0)
s_mul_i32 s31, s21, 160
s_lshl_b32 s29, s38, 5
s_add_u32 s34, s31, s29
s_xor_b32 s29, s38, 1
s_lshl_b32 s29, s29, 7
s_add_u32 s31, s31, s29
s_mul_i32 s29, s43, 1
s_add_u32 s29, s29, 16
s_mul_i32 s45, s29, 5120
s_mul_i32 s29, s29, 40960
s_add_u32 s35, s34, s29
s_add_u32 s36, s31, s29
s_add_u32 s29, s35, 0
s_add_u32 m0, s45, 0
s_nop 0
buffer_load_dwordx4 v13, s[16:19], s29 offen lds
s_add_u32 s29, s35, 20480
s_add_u32 m0, s45, 1024
s_nop 0
buffer_load_dwordx4 v13, s[16:19], s29 offen lds
s_add_u32 s29, s35, 64
s_add_u32 m0, s45, 2048
s_nop 0
buffer_load_dwordx4 v13, s[16:19], s29 offen lds
s_add_u32 s29, s35, 20544
s_add_u32 m0, s45, 3072
s_nop 0
buffer_load_dwordx4 v13, s[16:19], s29 offen lds
s_add_u32 s29, s36, 0
s_add_u32 m0, s45, 4096
s_nop 0
buffer_load_dwordx4 v10, s[16:19], s29 offen lds
s_waitcnt vmcnt(6)
s_branch Lstats_10
Lxw_5:
s_waitcnt vmcnt(0) lgkmcnt(0)
Lstats_10:
v_mov_b32 v244, 0x3f803f80
v_mov_b32 v245, 0x3f803f80
v_mov_b32 v246, 0x3f803f80
v_mov_b32 v247, 0x3f803f80
v_and_b32 v4, 15, v1
v_mul_u32_u24 v6, 640, v4
v_add_u32 v6, s39, v6
v_lshrrev_b32 v4, 1, v4
v_lshrrev_b32 v5, 4, v1
v_xor_b32 v4, v4, v5
v_lshl_add_u32 v5, v4, 4, v6
v_xor_b32 v4, 4, v4
v_lshl_add_u32 v6, v4, 4, v6
ds_read_b128 v[16:19], v5 offset:0
ds_read_b128 v[20:23], v6 offset:0
ds_read_b128 v[24:27], v5 offset:128
ds_read_b128 v[28:31], v6 offset:128
ds_read_b128 v[32:35], v5 offset:256
ds_read_b128 v[36:39], v6 offset:256
ds_read_b128 v[40:43], v5 offset:384
ds_read_b128 v[44:47], v6 offset:384
ds_read_b128 v[48:51], v5 offset:512
ds_read_b128 v[52:55], v6 offset:512
s_waitcnt lgkmcnt(9)
v_mfma_f32_16x16x32_bf16 v[248:251], v[244:247], v[16:19], 0
v_mfma_f32_16x16x32_bf16 v[252:255], v[16:19], v[16:19], 0
s_waitcnt lgkmcnt(8)
v_mfma_f32_16x16x32_bf16 v[248:251], v[244:247], v[20:23], v[248:251]
v_mfma_f32_16x16x32_bf16 v[252:255], v[20:23], v[20:23], v[252:255]
s_waitcnt lgkmcnt(7)
v_mfma_f32_16x16x32_bf16 v[248:251], v[244:247], v[24:27], v[248:251]
v_mfma_f32_16x16x32_bf16 v[252:255], v[24:27], v[24:27], v[252:255]
s_waitcnt lgkmcnt(6)
v_mfma_f32_16x16x32_bf16 v[248:251], v[244:247], v[28:31], v[248:251]
v_mfma_f32_16x16x32_bf16 v[252:255], v[28:31], v[28:31], v[252:255]
s_waitcnt lgkmcnt(5)
v_mfma_f32_16x16x32_bf16 v[248:251], v[244:247], v[32:35], v[248:251]
v_mfma_f32_16x16x32_bf16 v[252:255], v[32:35], v[32:35], v[252:255]
s_waitcnt lgkmcnt(4)
v_mfma_f32_16x16x32_bf16 v[248:251], v[244:247], v[36:39], v[248:251]
v_mfma_f32_16x16x32_bf16 v[252:255], v[36:39], v[36:39], v[252:255]
s_waitcnt lgkmcnt(3)
v_mfma_f32_16x16x32_bf16 v[248:251], v[244:247], v[40:43], v[248:251]
v_mfma_f32_16x16x32_bf16 v[252:255], v[40:43], v[40:43], v[252:255]
s_waitcnt lgkmcnt(2)
v_mfma_f32_16x16x32_bf16 v[248:251], v[244:247], v[44:47], v[248:251]
v_mfma_f32_16x16x32_bf16 v[252:255], v[44:47], v[44:47], v[252:255]
s_waitcnt lgkmcnt(1)
v_mfma_f32_16x16x32_bf16 v[248:251], v[244:247], v[48:51], v[248:251]
v_mfma_f32_16x16x32_bf16 v[252:255], v[48:51], v[48:51], v[252:255]
s_waitcnt lgkmcnt(0)
v_mfma_f32_16x16x32_bf16 v[248:251], v[244:247], v[52:55], v[248:251]
v_mfma_f32_16x16x32_bf16 v[252:255], v[52:55], v[52:55], v[252:255]
v_and_b32 v4, 3, v1
v_and_b32 v5, 15, v1
v_lshlrev_b32 v6, 3, v5
s_lshl_b32 s28, s3, 7
s_add_u32 s28, s28, 133120
v_add_u32 v7, s28, v6
s_xor_b32 s28, s28, 128
v_add_u32 v6, s28, v6
v_lshrrev_b32 v5, 2, v5
v_lshrrev_b32 v11, 4, v1
v_cmp_eq_u32 s[32:33], v11, v5
v_lshlrev_b32 v56, 16, v16
v_and_b32 v57, 0xffff0000, v16
v_lshlrev_b32 v58, 16, v17
v_and_b32 v59, 0xffff0000, v17
v_lshlrev_b32 v60, 16, v18
v_and_b32 v61, 0xffff0000, v18
v_lshlrev_b32 v62, 16, v19
v_and_b32 v63, 0xffff0000, v19
v_lshlrev_b32 v64, 16, v20
v_and_b32 v65, 0xffff0000, v20
v_lshlrev_b32 v66, 16, v21
v_and_b32 v67, 0xffff0000, v21
v_lshlrev_b32 v68, 16, v22
v_and_b32 v69, 0xffff0000, v22
v_lshlrev_b32 v70, 16, v23
v_and_b32 v71, 0xffff0000, v23
v_lshlrev_b32 v72, 16, v24
v_and_b32 v73, 0xffff0000, v24
v_lshlrev_b32 v74, 16, v25
v_and_b32 v75, 0xffff0000, v25
v_cmp_eq_u32 vcc, 1, v4
s_nop 1
v_cndmask_b32 v252, v252, v253, vcc
v_cmp_eq_u32 vcc, 2, v4
s_nop 1
v_cndmask_b32 v252, v252, v254, vcc
v_cmp_eq_u32 vcc, 3, v4
s_nop 1
v_cndmask_b32 v252, v252, v255, vcc
v_mov_b32 v249, v252
s_mov_b64 exec, s[32:33]
ds_write_b64 v7, v[248:249]
s_mov_b64 exec, -1
s_lshl_b32 s28, s3, 2
s_add_u32 s28, s28, 136192
v_mov_b32 v4, s28
v_mov_b32 v5, s23
s_mov_b64 exec, 1
ds_write_b32 v4, v5
s_mov_b64 exec, -1
v_lshlrev_b32 v76, 16, v26
v_and_b32 v77, 0xffff0000, v26
v_lshlrev_b32 v78, 16, v27
v_and_b32 v79, 0xffff0000, v27
v_lshlrev_b32 v80, 16, v28
v_and_b32 v81, 0xffff0000, v28
v_lshlrev_b32 v82, 16, v29
v_and_b32 v83, 0xffff0000, v29
v_lshlrev_b32 v84, 16, v30
v_and_b32 v85, 0xffff0000, v30
v_lshlrev_b32 v86, 16, v31
v_and_b32 v87, 0xffff0000, v31
v_lshlrev_b32 v88, 16, v32
v_and_b32 v89, 0xffff0000, v32
v_lshlrev_b32 v90, 16, v33
v_and_b32 v91, 0xffff0000, v33
v_lshlrev_b32 v92, 16, v34
v_and_b32 v93, 0xffff0000, v34
v_lshlrev_b32 v94, 16, v35
v_and_b32 v95, 0xffff0000, v35
v_lshlrev_b32 v96, 16, v36
v_and_b32 v97, 0xffff0000, v36
v_lshlrev_b32 v98, 16, v37
v_and_b32 v99, 0xffff0000, v37
v_lshlrev_b32 v100, 16, v38
v_and_b32 v101, 0xffff0000, v38
v_lshlrev_b32 v102, 16, v39
v_and_b32 v103, 0xffff0000, v39
v_lshlrev_b32 v104, 16, v40
v_and_b32 v105, 0xffff0000, v40
v_lshlrev_b32 v106, 16, v41
v_and_b32 v107, 0xffff0000, v41
v_lshlrev_b32 v108, 16, v42
v_and_b32 v109, 0xffff0000, v42
v_lshlrev_b32 v110, 16, v43
v_and_b32 v111, 0xffff0000, v43
v_lshlrev_b32 v112, 16, v44
v_and_b32 v113, 0xffff0000, v44
v_lshlrev_b32 v114, 16, v45
v_and_b32 v115, 0xffff0000, v45
v_lshlrev_b32 v116, 16, v46
v_and_b32 v117, 0xffff0000, v46
v_lshlrev_b32 v118, 16, v47
v_and_b32 v119, 0xffff0000, v47
v_lshlrev_b32 v120, 16, v48
v_and_b32 v121, 0xffff0000, v48
v_lshlrev_b32 v122, 16, v49
v_and_b32 v123, 0xffff0000, v49
v_lshlrev_b32 v124, 16, v50
v_and_b32 v125, 0xffff0000, v50
v_lshlrev_b32 v126, 16, v51
v_and_b32 v127, 0xffff0000, v51
v_lshlrev_b32 v128, 16, v52
v_and_b32 v129, 0xffff0000, v52
v_lshlrev_b32 v130, 16, v53
v_and_b32 v131, 0xffff0000, v53
v_lshlrev_b32 v132, 16, v54
v_and_b32 v133, 0xffff0000, v54
v_lshlrev_b32 v134, 16, v55
v_and_b32 v135, 0xffff0000, v55
s_xor_b32 s28, s28, 4
v_mov_b32 v4, s28
s_mov_b32 s25, 4194304
Llw_18:
ds_read_b32 v5, v4
s_waitcnt lgkmcnt(0)
v_readfirstlane_b32 s30, v5
s_nop 1
s_cmp_eq_u32 s30, s23
s_cbranch_scc1 Llwd_19
s_sleep 1
s_sub_u32 s25, s25, 1
s_cmp_lg_u32 s25, 0
s_cbranch_scc1 Llw_18
Llwd_19:
ds_read_b64 v[252:253], v6
ds_read_b64 v[248:249], v7
s_waitcnt lgkmcnt(0)
v_add_f32 v248, v248, v252
v_add_f32 v249, v249, v253
v_mul_f32 v248, 0xbacccccd, v248
v_mul_f32 v249, 0x3acccccd, v249
v_fma_f32 v249, -v248, v248, v249
v_max_f32 v249, 0, v249
v_add_f32 v249, 0x3727c5ac, v249
v_rsq_f32 v252, v249
s_nop 0
v_mul_f32 v254, v248, v252
v_mov_b32 v253, v252
v_mov_b32 v255, v254
s_cmp_ge_u32 s3, 2
s_cbranch_scc1 Lothers_20
v_lshrrev_b32 v4, 4, v1
v_lshlrev_b32 v4, 3, v4
v_bfe_u32 v5, v1, 2, 2
v_add_u32 v4, v4, v5
v_mul_u32_u24 v4, 40, v4
v_and_b32 v5, 3, v1
v_lshl_add_u32 v4, v5, 3, v4
s_mul_i32 s28, s27, 12800
s_add_u32 s28, s28, 102400
v_add_u32 v9, s28, v4
v_lshrrev_b32 v4, 2, v1
v_and_b32 v5, 3, v1
v_lshlrev_b32 v6, 7, v4
v_lshl_add_u32 v6, v5, 4, v6
v_add_u32 v7, 2560, v6
v_cmp_gt_u32 vcc, 4, v4
s_nop 1
v_cndmask_b32 v7, v7, v6, vcc
s_mul_i32 s28, s27, 2560
s_add_u32 s28, s28, 24875008
s_add_u32 s29, s28, 2048
s_add_u32 s31, s28, 6656
ds_read_b64_tr_b16 v[168:169], v9 offset:0
v_pk_fma_f32 v[56:57], v[56:57], v[252:253], v[254:255]
ds_read_b64_tr_b16 v[170:171], v9 offset:160
v_pk_fma_f32 v[58:59], v[58:59], v[252:253], v[254:255]
ds_read_b64_tr_b16 v[172:173], v9 offset:32
v_pk_fma_f32 v[60:61], v[60:61], v[252:253], v[254:255]
ds_read_b64_tr_b16 v[174:175], v9 offset:192
v_pk_fma_f32 v[62:63], v[62:63], v[252:253], v[254:255]
ds_read_b64_tr_b16 v[176:177], v9 offset:1280
v_pk_fma_f32 v[64:65], v[64:65], v[252:253], v[254:255]
ds_read_b64_tr_b16 v[178:179], v9 offset:1440
v_pk_fma_f32 v[66:67], v[66:67], v[252:253], v[254:255]
ds_read_b64_tr_b16 v[180:181], v9 offset:1312
v_pk_fma_f32 v[68:69], v[68:69], v[252:253], v[254:255]
ds_read_b64_tr_b16 v[182:183], v9 offset:1472
v_pk_fma_f32 v[70:71], v[70:71], v[252:253], v[254:255]
ds_read_b64_tr_b16 v[184:185], v9 offset:2560
v_pk_fma_f32 v[72:73], v[72:73], v[252:253], v[254:255]
ds_read_b64_tr_b16 v[186:187], v9 offset:2720
v_pk_fma_f32 v[74:75], v[74:75], v[252:253], v[254:255]
ds_read_b64_tr_b16 v[188:189], v9 offset:2592
v_pk_fma_f32 v[76:77], v[76:77], v[252:253], v[254:255]
ds_read_b64_tr_b16 v[190:191], v9 offset:2752
v_pk_fma_f32 v[78:79], v[78:79], v[252:253], v[254:255]
ds_read_b64_tr_b16 v[192:193], v9 offset:3840
v_pk_fma_f32 v[80:81], v[80:81], v[252:253], v[254:255]
ds_read_b64_tr_b16 v[194:195], v9 offset:4000
v_pk_fma_f32 v[82:83], v[82:83], v[252:253], v[254:255]
ds_read_b64_tr_b16 v[196:197], v9 offset:3872
v_pk_fma_f32 v[84:85], v[84:85], v[252:253], v[254:255]
ds_read_b64_tr_b16 v[198:199], v9 offset:4032
v_pk_fma_f32 v[86:87], v[86:87], v[252:253], v[254:255]
ds_read_b64_tr_b16 v[200:201], v9 offset:5120
v_pk_fma_f32 v[88:89], v[88:89], v[252:253], v[254:255]
ds_read_b64_tr_b16 v[202:203], v9 offset:5280
v_pk_fma_f32 v[90:91], v[90:91], v[252:253], v[254:255]
ds_read_b64_tr_b16 v[204:205], v9 offset:5152
v_pk_fma_f32 v[92:93], v[92:93], v[252:253], v[254:255]
ds_read_b64_tr_b16 v[206:207], v9 offset:5312
v_pk_fma_f32 v[94:95], v[94:95], v[252:253], v[254:255]
s_mov_b32 s25, 524288
buffer_load_dwordx4 v[136:139], v6, s[8:11], s28 offen offset:0 sc1
buffer_load_dwordx4 v[140:143], v7, s[8:11], s29 offen offset:0 sc1
s_mov_b32 exec_lo, 0xffffffff
s_mov_b32 exec_hi, 0x0
buffer_load_dwordx4 v[144:147], v6, s[8:11], s31 offen offset:0 sc1
s_mov_b64 exec, -1
ds_read_b64_tr_b16 v[208:209], v9 offset:6400
v_pk_fma_f32 v[96:97], v[96:97], v[252:253], v[254:255]
ds_read_b64_tr_b16 v[210:211], v9 offset:6560
v_pk_fma_f32 v[98:99], v[98:99], v[252:253], v[254:255]
ds_read_b64_tr_b16 v[212:213], v9 offset:6432
v_pk_fma_f32 v[100:101], v[100:101], v[252:253], v[254:255]
ds_read_b64_tr_b16 v[214:215], v9 offset:6592
v_pk_fma_f32 v[102:103], v[102:103], v[252:253], v[254:255]
ds_read_b64_tr_b16 v[216:217], v9 offset:7680
v_pk_fma_f32 v[104:105], v[104:105], v[252:253], v[254:255]
ds_read_b64_tr_b16 v[218:219], v9 offset:7840
v_pk_fma_f32 v[106:107], v[106:107], v[252:253], v[254:255]
ds_read_b64_tr_b16 v[220:221], v9 offset:7712
v_pk_fma_f32 v[108:109], v[108:109], v[252:253], v[254:255]
ds_read_b64_tr_b16 v[222:223], v9 offset:7872
v_pk_fma_f32 v[110:111], v[110:111], v[252:253], v[254:255]
ds_read_b64_tr_b16 v[224:225], v9 offset:8960
v_pk_fma_f32 v[112:113], v[112:113], v[252:253], v[254:255]
ds_read_b64_tr_b16 v[226:227], v9 offset:9120
v_pk_fma_f32 v[114:115], v[114:115], v[252:253], v[254:255]
ds_read_b64_tr_b16 v[228:229], v9 offset:8992
v_pk_fma_f32 v[116:117], v[116:117], v[252:253], v[254:255]
ds_read_b64_tr_b16 v[230:231], v9 offset:9152
v_pk_fma_f32 v[118:119], v[118:119], v[252:253], v[254:255]
ds_read_b64_tr_b16 v[232:233], v9 offset:10240
v_pk_fma_f32 v[120:121], v[120:121], v[252:253], v[254:255]
ds_read_b64_tr_b16 v[234:235], v9 offset:10400
v_pk_fma_f32 v[122:123], v[122:123], v[252:253], v[254:255]
ds_read_b64_tr_b16 v[236:237], v9 offset:10272
v_pk_fma_f32 v[124:125], v[124:125], v[252:253], v[254:255]
ds_read_b64_tr_b16 v[238:239], v9 offset:10432
v_pk_fma_f32 v[126:127], v[126:127], v[252:253], v[254:255]
ds_read_b64_tr_b16 v[240:241], v9 offset:11520
v_pk_fma_f32 v[128:129], v[128:129], v[252:253], v[254:255]
ds_read_b64_tr_b16 v[242:243], v9 offset:11680
v_pk_fma_f32 v[130:131], v[130:131], v[252:253], v[254:255]
v_pk_fma_f32 v[132:133], v[132:133], v[252:253], v[254:255]
v_pk_fma_f32 v[134:135], v[134:135], v[252:253], v[254:255]
ds_read_b64_tr_b16 v[244:245], v9 offset:11552
ds_read_b64_tr_b16 v[246:247], v9 offset:11712
s_branch Lgchk_24
Lgpoll_22:
buffer_load_dwordx4 v[136:139], v6, s[8:11], s28 offen offset:0 sc1
buffer_load_dwordx4 v[140:143], v7, s[8:11], s29 offen offset:0 sc1
s_mov_b32 exec_lo, 0xffffffff
s_mov_b32 exec_hi, 0x0
buffer_load_dwordx4 v[144:147], v6, s[8:11], s31 offen offset:0 sc1
s_mov_b64 exec, -1
Lgchk_24:
s_waitcnt vmcnt(0)
s_mov_b64 s[32:33], 0
v_cmp_ne_u32 vcc, s23, v137
s_nop 1
s_or_b64 s[32:33], s[32:33], vcc
v_cmp_ne_u32 vcc, s23, v139
s_nop 1
s_or_b64 s[32:33], s[32:33], vcc
v_cmp_ne_u32 vcc, s23, v141
s_nop 1
s_or_b64 s[32:33], s[32:33], vcc
v_cmp_ne_u32 vcc, s23, v143
s_nop 1
s_or_b64 s[32:33], s[32:33], vcc
s_mov_b32 exec_lo, 0xffffffff
s_mov_b32 exec_hi, 0x0
v_cmp_ne_u32 vcc, s23, v145
s_nop 1
s_or_b64 s[32:33], s[32:33], vcc
v_cmp_ne_u32 vcc, s23, v147
s_nop 1
s_or_b64 s[32:33], s[32:33], vcc
s_mov_b64 exec, -1
s_cmp_eq_u64 s[32:33], 0
s_cbranch_scc1 Lgdone_23
s_sleep 4
s_sub_u32 s25, s25, 1
s_cmp_lg_u32 s25, 0
s_cbranch_scc1 Lgpoll_22
Lgdone_23:
s_lshl_b32 s29, s27, 2
s_add_u32 s29, s29, 136248
v_mov_b32 v148, s29
v_mov_b32 v149, s23
s_mov_b64 exec, 1
ds_write_b32 v148, v149
s_mov_b64 exec, -1
s_mul_i32 s28, s27, 2560
s_add_u32 s28, s28, 128000
v_add_u32 v6, 0, v4
v_subrev_u32 v7, 20, v6
v_cmp_gt_u32 vcc, 20, v6
s_nop 1
v_cndmask_b32 v6, v7, v6, vcc
v_cndmask_b32 v7, 0, 8, vcc
v_lshlrev_b32 v6, 7, v6
v_lshl_add_u32 v6, v5, 5, v6
v_add3_u32 v6, v6, v7, s28
v_lshlrev_b32 v148, 16, v136
v_and_b32 v149, 0xffff0000, v136
v_lshlrev_b32 v150, 16, v138
v_and_b32 v151, 0xffff0000, v138
ds_write_b64 v6, v[148:149]
ds_write_b64 v6, v[150:151] offset:16
v_add_u32 v6, 16, v4
v_subrev_u32 v7, 20, v6
v_cmp_gt_u32 vcc, 20, v6
s_nop 1
v_cndmask_b32 v6, v7, v6, vcc
v_cndmask_b32 v7, 0, 8, vcc
v_lshlrev_b32 v6, 7, v6
v_lshl_add_u32 v6, v5, 5, v6
v_add3_u32 v6, v6, v7, s28
v_lshlrev_b32 v148, 16, v140
v_and_b32 v149, 0xffff0000, v140
v_lshlrev_b32 v150, 16, v142
v_and_b32 v151, 0xffff0000, v142
ds_write_b64 v6, v[148:149]
ds_write_b64 v6, v[150:151] offset:16
v_add_u32 v6, 32, v4
v_subrev_u32 v7, 20, v6
v_cmp_gt_u32 vcc, 20, v6
s_nop 1
v_cndmask_b32 v6, v7, v6, vcc
v_cndmask_b32 v7, 0, 8, vcc
v_lshlrev_b32 v6, 7, v6
v_lshl_add_u32 v6, v5, 5, v6
v_add3_u32 v6, v6, v7, s28
v_lshlrev_b32 v148, 16, v144
v_and_b32 v149, 0xffff0000, v144
v_lshlrev_b32 v150, 16, v146
v_and_b32 v151, 0xffff0000, v146
s_mov_b32 exec_lo, -1
s_mov_b32 exec_hi, 0
ds_write_b64 v6, v[148:149]
ds_write_b64 v6, v[150:151] offset:16
s_mov_b64 exec, -1
s_branch Lhgo_21
Lothers_20:
s_cmp_ge_u32 s3, 4
s_cbranch_scc1 Lldr_26
v_pk_fma_f32 v[56:57], v[56:57], v[252:253], v[254:255]
v_pk_fma_f32 v[58:59], v[58:59], v[252:253], v[254:255]
v_pk_fma_f32 v[60:61], v[60:61], v[252:253], v[254:255]
v_pk_fma_f32 v[62:63], v[62:63], v[252:253], v[254:255]
v_pk_fma_f32 v[64:65], v[64:65], v[252:253], v[254:255]
v_pk_fma_f32 v[66:67], v[66:67], v[252:253], v[254:255]
v_pk_fma_f32 v[68:69], v[68:69], v[252:253], v[254:255]
v_pk_fma_f32 v[70:71], v[70:71], v[252:253], v[254:255]
v_pk_fma_f32 v[72:73], v[72:73], v[252:253], v[254:255]
v_pk_fma_f32 v[74:75], v[74:75], v[252:253], v[254:255]
v_pk_fma_f32 v[76:77], v[76:77], v[252:253], v[254:255]
v_pk_fma_f32 v[78:79], v[78:79], v[252:253], v[254:255]
v_pk_fma_f32 v[80:81], v[80:81], v[252:253], v[254:255]
v_pk_fma_f32 v[82:83], v[82:83], v[252:253], v[254:255]
v_pk_fma_f32 v[84:85], v[84:85], v[252:253], v[254:255]
v_pk_fma_f32 v[86:87], v[86:87], v[252:253], v[254:255]
v_pk_fma_f32 v[88:89], v[88:89], v[252:253], v[254:255]
v_pk_fma_f32 v[90:91], v[90:91], v[252:253], v[254:255]
v_pk_fma_f32 v[92:93], v[92:93], v[252:253], v[254:255]
v_pk_fma_f32 v[94:95], v[94:95], v[252:253], v[254:255]
v_pk_fma_f32 v[96:97], v[96:97], v[252:253], v[254:255]
v_pk_fma_f32 v[98:99], v[98:99], v[252:253], v[254:255]
v_pk_fma_f32 v[100:101], v[100:101], v[252:253], v[254:255]
v_pk_fma_f32 v[102:103], v[102:103], v[252:253], v[254:255]
v_pk_fma_f32 v[104:105], v[104:105], v[252:253], v[254:255]
v_pk_fma_f32 v[106:107], v[106:107], v[252:253], v[254:255]
v_pk_fma_f32 v[108:109], v[108:109], v[252:253], v[254:255]
v_pk_fma_f32 v[110:111], v[110:111], v[252:253], v[254:255]
v_pk_fma_f32 v[112:113], v[112:113], v[252:253], v[254:255]
v_pk_fma_f32 v[114:115], v[114:115], v[252:253], v[254:255]
v_pk_fma_f32 v[116:117], v[116:117], v[252:253], v[254:255]
v_pk_fma_f32 v[118:119], v[118:119], v[252:253], v[254:255]
v_pk_fma_f32 v[120:121], v[120:121], v[252:253], v[254:255]
v_pk_fma_f32 v[122:123], v[122:123], v[252:253], v[254:255]
v_pk_fma_f32 v[124:125], v[124:125], v[252:253], v[254:255]
v_pk_fma_f32 v[126:127], v[126:127], v[252:253], v[254:255]
v_pk_fma_f32 v[128:129], v[128:129], v[252:253], v[254:255]
v_pk_fma_f32 v[130:131], v[130:131], v[252:253], v[254:255]
v_pk_fma_f32 v[132:133], v[132:133], v[252:253], v[254:255]
v_pk_fma_f32 v[134:135], v[134:135], v[252:253], v[254:255]
s_and_b32 s29, s26, 1
s_lshl_b32 s29, s29, 4
v_and_b32 v4, 15, v1
v_add_u32 v4, s29, v4
v_lshrrev_b32 v5, 4, v1
s_lshr_b32 s29, s26, 1
s_lshl_b32 s30, s29, 12
s_add_u32 s30, s30, 149504
s_lshl_b32 s29, s29, 10
s_add_u32 s29, s29, 157696
s_add_u32 s28, s38, 0
s_cmp_eq_u32 s28, 5
s_cselect_b32 s28, 0, s28
s_lshl_b32 s28, s28, 2
v_add_u32 v6, s28, v5
v_mul_u32_u24 v7, 13, v6
v_lshrrev_b32 v7, 6, v7
v_mul_u32_u24 v11, 5, v7
v_sub_u32 v6, v6, v11
v_lshlrev_b32 v11, 10, v7
v_lshrrev_b32 v12, 1, v6
v_lshl_add_u32 v11, v12, 9, v11
v_lshl_add_u32 v11, v4, 4, v11
v_and_b32 v12, 1, v6
v_lshl_add_u32 v11, v12, 3, v11
v_add_u32 v11, s30, v11
v_lshlrev_b32 v12, 8, v7
v_lshl_add_u32 v12, v4, 3, v12
v_add_u32 v12, s29, v12
v_cmp_eq_u32 vcc, 4, v6
s_nop 1
v_cndmask_b32 v236, v11, v12, vcc
s_add_u32 s28, s38, 1
s_cmp_eq_u32 s28, 5
s_cselect_b32 s28, 0, s28
s_lshl_b32 s28, s28, 2
v_add_u32 v6, s28, v5
v_mul_u32_u24 v7, 13, v6
v_lshrrev_b32 v7, 6, v7
v_mul_u32_u24 v11, 5, v7
v_sub_u32 v6, v6, v11
v_lshlrev_b32 v11, 10, v7
v_lshrrev_b32 v12, 1, v6
v_lshl_add_u32 v11, v12, 9, v11
v_lshl_add_u32 v11, v4, 4, v11
v_and_b32 v12, 1, v6
v_lshl_add_u32 v11, v12, 3, v11
v_add_u32 v11, s30, v11
v_lshlrev_b32 v12, 8, v7
v_lshl_add_u32 v12, v4, 3, v12
v_add_u32 v12, s29, v12
v_cmp_eq_u32 vcc, 4, v6
s_nop 1
v_cndmask_b32 v237, v11, v12, vcc
s_add_u32 s28, s38, 2
s_cmp_eq_u32 s28, 5
s_cselect_b32 s28, 0, s28
s_lshl_b32 s28, s28, 2
v_add_u32 v6, s28, v5
v_mul_u32_u24 v7, 13, v6
v_lshrrev_b32 v7, 6, v7
v_mul_u32_u24 v11, 5, v7
v_sub_u32 v6, v6, v11
v_lshlrev_b32 v11, 10, v7
v_lshrrev_b32 v12, 1, v6
v_lshl_add_u32 v11, v12, 9, v11
v_lshl_add_u32 v11, v4, 4, v11
v_and_b32 v12, 1, v6
v_lshl_add_u32 v11, v12, 3, v11
v_add_u32 v11, s30, v11
v_lshlrev_b32 v12, 8, v7
v_lshl_add_u32 v12, v4, 3, v12
v_add_u32 v12, s29, v12
v_cmp_eq_u32 vcc, 4, v6
s_nop 1
v_cndmask_b32 v238, v11, v12, vcc
s_add_u32 s28, s38, 3
s_cmp_eq_u32 s28, 5
s_cselect_b32 s28, 0, s28
s_lshl_b32 s28, s28, 2
v_add_u32 v6, s28, v5
v_mul_u32_u24 v7, 13, v6
v_lshrrev_b32 v7, 6, v7
v_mul_u32_u24 v11, 5, v7
v_sub_u32 v6, v6, v11
v_lshlrev_b32 v11, 10, v7
v_lshrrev_b32 v12, 1, v6
v_lshl_add_u32 v11, v12, 9, v11
v_lshl_add_u32 v11, v4, 4, v11
v_and_b32 v12, 1, v6
v_lshl_add_u32 v11, v12, 3, v11
v_add_u32 v11, s30, v11
v_lshlrev_b32 v12, 8, v7
v_lshl_add_u32 v12, v4, 3, v12
v_add_u32 v12, s29, v12
v_cmp_eq_u32 vcc, 4, v6
s_nop 1
v_cndmask_b32 v239, v11, v12, vcc
s_add_u32 s28, s38, 4
s_cmp_eq_u32 s28, 5
s_cselect_b32 s28, 0, s28
s_lshl_b32 s28, s28, 2
v_add_u32 v6, s28, v5
v_mul_u32_u24 v7, 13, v6
v_lshrrev_b32 v7, 6, v7
v_mul_u32_u24 v11, 5, v7
v_sub_u32 v6, v6, v11
v_lshlrev_b32 v11, 10, v7
v_lshrrev_b32 v12, 1, v6
v_lshl_add_u32 v11, v12, 9, v11
v_lshl_add_u32 v11, v4, 4, v11
v_and_b32 v12, 1, v6
v_lshl_add_u32 v11, v12, 3, v11
v_add_u32 v11, s30, v11
v_lshlrev_b32 v12, 8, v7
v_lshl_add_u32 v12, v4, 3, v12
v_add_u32 v12, s29, v12
v_cmp_eq_u32 vcc, 4, v6
s_nop 1
v_cndmask_b32 v240, v11, v12, vcc
s_branch Lnoload_25
Lldr_26:
s_cmp_lg_u32 s3, 4
s_cbranch_scc1 Lnoxid_27
s_lshr_b32 s28, s20, 1
s_lshl_b32 s28, s28, 6
s_add_u32 s28, s28, 24805632
s_lshl_b32 s29, s22, 2
s_add_u32 s28, s28, s29
s_mov_b64 exec, 1
v_mov_b32 v4, 0
v_mov_b32 v5, s42
buffer_store_dword v5, v4, s[8:11], s28 offen sc1
s_mov_b64 exec, -1
Lnoxid_27:
v_and_b32 v4, 7, v1
v_cmp_eq_u32 vcc, 2, v4
s_nop 1
v_cndmask_b32 v4, v4, 3, vcc
v_lshlrev_b32 v4, 2, v4
v_add_u32 v4, 136192, v4
s_mov_b32 s25, 4194304
Llw8_28:
ds_read_b32 v5, v4
s_waitcnt lgkmcnt(0)
v_cmp_ne_u32 vcc, s23, v5
s_nop 1
s_cbranch_vccz Llw8d_29
s_sleep 1
s_sub_u32 s25, s25, 1
s_cmp_lg_u32 s25, 0
s_cbranch_scc1 Llw8_28
Llw8d_29:
s_mul_i32 s29, s43, 4
s_add_u32 s29, s29, 0
s_mul_i32 s45, s29, 5120
s_mul_i32 s29, s29, 40960
s_add_u32 s35, s34, s29
s_add_u32 s36, s31, s29
s_add_u32 s29, s35, 0
s_add_u32 m0, s45, 0
s_nop 0
buffer_load_dwordx4 v13, s[16:19], s29 offen lds
v_pk_fma_f32 v[56:57], v[56:57], v[252:253], v[254:255]
v_pk_fma_f32 v[58:59], v[58:59], v[252:253], v[254:255]
v_pk_fma_f32 v[60:61], v[60:61], v[252:253], v[254:255]
v_pk_fma_f32 v[62:63], v[62:63], v[252:253], v[254:255]
s_add_u32 s29, s35, 20480
s_add_u32 m0, s45, 1024
s_nop 0
buffer_load_dwordx4 v13, s[16:19], s29 offen lds
v_pk_fma_f32 v[64:65], v[64:65], v[252:253], v[254:255]
v_pk_fma_f32 v[66:67], v[66:67], v[252:253], v[254:255]
v_pk_fma_f32 v[68:69], v[68:69], v[252:253], v[254:255]
v_pk_fma_f32 v[70:71], v[70:71], v[252:253], v[254:255]
s_add_u32 s29, s35, 64
s_add_u32 m0, s45, 2048
s_nop 0
buffer_load_dwordx4 v13, s[16:19], s29 offen lds
v_pk_fma_f32 v[72:73], v[72:73], v[252:253], v[254:255]
v_pk_fma_f32 v[74:75], v[74:75], v[252:253], v[254:255]
v_pk_fma_f32 v[76:77], v[76:77], v[252:253], v[254:255]
v_pk_fma_f32 v[78:79], v[78:79], v[252:253], v[254:255]
s_add_u32 s29, s35, 20544
s_add_u32 m0, s45, 3072
s_nop 0
buffer_load_dwordx4 v13, s[16:19], s29 offen lds
v_pk_fma_f32 v[80:81], v[80:81], v[252:253], v[254:255]
v_pk_fma_f32 v[82:83], v[82:83], v[252:253], v[254:255]
v_pk_fma_f32 v[84:85], v[84:85], v[252:253], v[254:255]
v_pk_fma_f32 v[86:87], v[86:87], v[252:253], v[254:255]
s_add_u32 s29, s36, 0
s_add_u32 m0, s45, 4096
s_nop 0
buffer_load_dwordx4 v10, s[16:19], s29 offen lds
v_pk_fma_f32 v[88:89], v[88:89], v[252:253], v[254:255]
v_pk_fma_f32 v[90:91], v[90:91], v[252:253], v[254:255]
v_pk_fma_f32 v[92:93], v[92:93], v[252:253], v[254:255]
v_pk_fma_f32 v[94:95], v[94:95], v[252:253], v[254:255]
s_add_u32 s29, s35, 40960
s_add_u32 m0, s45, 5120
s_nop 0
buffer_load_dwordx4 v13, s[16:19], s29 offen lds
v_pk_fma_f32 v[96:97], v[96:97], v[252:253], v[254:255]
v_pk_fma_f32 v[98:99], v[98:99], v[252:253], v[254:255]
v_pk_fma_f32 v[100:101], v[100:101], v[252:253], v[254:255]
v_pk_fma_f32 v[102:103], v[102:103], v[252:253], v[254:255]
s_add_u32 s29, s35, 61440
s_add_u32 m0, s45, 6144
s_nop 0
buffer_load_dwordx4 v13, s[16:19], s29 offen lds
v_pk_fma_f32 v[104:105], v[104:105], v[252:253], v[254:255]
v_pk_fma_f32 v[106:107], v[106:107], v[252:253], v[254:255]
v_pk_fma_f32 v[108:109], v[108:109], v[252:253], v[254:255]
v_pk_fma_f32 v[110:111], v[110:111], v[252:253], v[254:255]
s_add_u32 s29, s35, 41024
s_add_u32 m0, s45, 7168
s_nop 0
buffer_load_dwordx4 v13, s[16:19], s29 offen lds
v_pk_fma_f32 v[112:113], v[112:113], v[252:253], v[254:255]
v_pk_fma_f32 v[114:115], v[114:115], v[252:253], v[254:255]
v_pk_fma_f32 v[116:117], v[116:117], v[252:253], v[254:255]
v_pk_fma_f32 v[118:119], v[118:119], v[252:253], v[254:255]
s_add_u32 s29, s35, 61504
s_add_u32 m0, s45, 8192
s_nop 0
buffer_load_dwordx4 v13, s[16:19], s29 offen lds
v_pk_fma_f32 v[120:121], v[120:121], v[252:253], v[254:255]
v_pk_fma_f32 v[122:123], v[122:123], v[252:253], v[254:255]
v_pk_fma_f32 v[124:125], v[124:125], v[252:253], v[254:255]
v_pk_fma_f32 v[126:127], v[126:127], v[252:253], v[254:255]
s_add_u32 s29, s36, 40960
s_add_u32 m0, s45, 9216
s_nop 0
buffer_load_dwordx4 v10, s[16:19], s29 offen lds
v_pk_fma_f32 v[128:129], v[128:129], v[252:253], v[254:255]
v_pk_fma_f32 v[130:131], v[130:131], v[252:253], v[254:255]
v_pk_fma_f32 v[132:133], v[132:133], v[252:253], v[254:255]
v_pk_fma_f32 v[134:135], v[134:135], v[252:253], v[254:255]
s_and_b32 s29, s26, 1
s_lshl_b32 s29, s29, 4
v_and_b32 v4, 15, v1
v_add_u32 v4, s29, v4
v_lshrrev_b32 v5, 4, v1
s_lshr_b32 s29, s26, 1
s_lshl_b32 s30, s29, 12
s_add_u32 s30, s30, 149504
s_lshl_b32 s29, s29, 10
s_add_u32 s29, s29, 157696
s_add_u32 s28, s38, 0
s_cmp_eq_u32 s28, 5
s_cselect_b32 s28, 0, s28
s_lshl_b32 s28, s28, 2
v_add_u32 v6, s28, v5
v_mul_u32_u24 v7, 13, v6
v_lshrrev_b32 v7, 6, v7
v_mul_u32_u24 v11, 5, v7
v_sub_u32 v6, v6, v11
v_lshlrev_b32 v11, 10, v7
v_lshrrev_b32 v12, 1, v6
v_lshl_add_u32 v11, v12, 9, v11
v_lshl_add_u32 v11, v4, 4, v11
v_and_b32 v12, 1, v6
v_lshl_add_u32 v11, v12, 3, v11
v_add_u32 v11, s30, v11
v_lshlrev_b32 v12, 8, v7
v_lshl_add_u32 v12, v4, 3, v12
v_add_u32 v12, s29, v12
v_cmp_eq_u32 vcc, 4, v6
s_nop 1
v_cndmask_b32 v236, v11, v12, vcc
s_add_u32 s28, s38, 1
s_cmp_eq_u32 s28, 5
s_cselect_b32 s28, 0, s28
s_lshl_b32 s28, s28, 2
v_add_u32 v6, s28, v5
v_mul_u32_u24 v7, 13, v6
v_lshrrev_b32 v7, 6, v7
v_mul_u32_u24 v11, 5, v7
v_sub_u32 v6, v6, v11
v_lshlrev_b32 v11, 10, v7
v_lshrrev_b32 v12, 1, v6
v_lshl_add_u32 v11, v12, 9, v11
v_lshl_add_u32 v11, v4, 4, v11
v_and_b32 v12, 1, v6
v_lshl_add_u32 v11, v12, 3, v11
v_add_u32 v11, s30, v11
v_lshlrev_b32 v12, 8, v7
v_lshl_add_u32 v12, v4, 3, v12
v_add_u32 v12, s29, v12
v_cmp_eq_u32 vcc, 4, v6
s_nop 1
v_cndmask_b32 v237, v11, v12, vcc
s_add_u32 s28, s38, 2
s_cmp_eq_u32 s28, 5
s_cselect_b32 s28, 0, s28
s_lshl_b32 s28, s28, 2
v_add_u32 v6, s28, v5
v_mul_u32_u24 v7, 13, v6
v_lshrrev_b32 v7, 6, v7
v_mul_u32_u24 v11, 5, v7
v_sub_u32 v6, v6, v11
v_lshlrev_b32 v11, 10, v7
v_lshrrev_b32 v12, 1, v6
v_lshl_add_u32 v11, v12, 9, v11
v_lshl_add_u32 v11, v4, 4, v11
v_and_b32 v12, 1, v6
v_lshl_add_u32 v11, v12, 3, v11
v_add_u32 v11, s30, v11
v_lshlrev_b32 v12, 8, v7
v_lshl_add_u32 v12, v4, 3, v12
v_add_u32 v12, s29, v12
v_cmp_eq_u32 vcc, 4, v6
s_nop 1
v_cndmask_b32 v238, v11, v12, vcc
s_add_u32 s28, s38, 3
s_cmp_eq_u32 s28, 5
s_cselect_b32 s28, 0, s28
s_lshl_b32 s28, s28, 2
v_add_u32 v6, s28, v5
v_mul_u32_u24 v7, 13, v6
v_lshrrev_b32 v7, 6, v7
v_mul_u32_u24 v11, 5, v7
v_sub_u32 v6, v6, v11
v_lshlrev_b32 v11, 10, v7
v_lshrrev_b32 v12, 1, v6
v_lshl_add_u32 v11, v12, 9, v11
v_lshl_add_u32 v11, v4, 4, v11
v_and_b32 v12, 1, v6
v_lshl_add_u32 v11, v12, 3, v11
v_add_u32 v11, s30, v11
v_lshlrev_b32 v12, 8, v7
v_lshl_add_u32 v12, v4, 3, v12
v_add_u32 v12, s29, v12
v_cmp_eq_u32 vcc, 4, v6
s_nop 1
v_cndmask_b32 v239, v11, v12, vcc
s_add_u32 s28, s38, 4
s_cmp_eq_u32 s28, 5
s_cselect_b32 s28, 0, s28
s_lshl_b32 s28, s28, 2
v_add_u32 v6, s28, v5
v_mul_u32_u24 v7, 13, v6
v_lshrrev_b32 v7, 6, v7
v_mul_u32_u24 v11, 5, v7
v_sub_u32 v6, v6, v11
v_lshlrev_b32 v11, 10, v7
v_lshrrev_b32 v12, 1, v6
v_lshl_add_u32 v11, v12, 9, v11
v_lshl_add_u32 v11, v4, 4, v11
v_and_b32 v12, 1, v6
v_lshl_add_u32 v11, v12, 3, v11
v_add_u32 v11, s30, v11
v_lshlrev_b32 v12, 8, v7
v_lshl_add_u32 v12, v4, 3, v12
v_add_u32 v12, s29, v12
v_cmp_eq_u32 vcc, 4, v6
s_nop 1
v_cndmask_b32 v240, v11, v12, vcc
Lnoload_25:
s_lshl_b32 s28, s27, 2
s_add_u32 s28, s28, 136224
v_mov_b32 v4, s28
s_mov_b32 s25, 4194304
Llw_30:
ds_read_b32 v5, v4
s_waitcnt lgkmcnt(0)
v_readfirstlane_b32 s30, v5
s_nop 1
s_cmp_eq_u32 s30, s23
s_cbranch_scc1 Llwd_31
s_sleep 1
s_sub_u32 s25, s25, 1
s_cmp_lg_u32 s25, 0
s_cbranch_scc1 Llw_30
Llwd_31:
Lhgo_21:
v_lshrrev_b32 v4, 4, v1
v_lshlrev_b32 v7, 6, v4
s_mul_i32 s28, s27, 2560
s_add_u32 s28, s28, 128000
v_add_u32 v7, s28, v7
s_waitcnt lgkmcnt(0)
s_cmp_ge_u32 s3, 2
s_cbranch_scc1 Lh2_32
ds_read_b128 v[136:139], v7 offset:0
ds_read_b128 v[140:143], v7 offset:16
ds_read_b128 v[144:147], v7 offset:32
ds_read_b128 v[148:151], v7 offset:48
ds_read_b128 v[152:155], v7 offset:256
ds_read_b128 v[156:159], v7 offset:272
ds_read_b128 v[160:163], v7 offset:288
ds_read_b128 v[164:167], v7 offset:304
s_waitcnt lgkmcnt(6)
v_pk_fma_f32 v[56:57], v[56:57], v[136:137], v[138:139]
v_pk_fma_f32 v[58:59], v[58:59], v[140:141], v[142:143]
ds_read_b128 v[136:139], v7 offset:512
ds_read_b128 v[140:143], v7 offset:528
s_waitcnt lgkmcnt(6)
v_pk_fma_f32 v[60:61], v[60:61], v[144:145], v[146:147]
v_pk_fma_f32 v[62:63], v[62:63], v[148:149], v[150:151]
v_cvt_pk_bf16_f32 v16, v56, v57
v_cvt_pk_bf16_f32 v17, v58, v59
ds_read_b128 v[144:147], v7 offset:544
ds_read_b128 v[148:151], v7 offset:560
s_waitcnt lgkmcnt(6)
v_pk_fma_f32 v[64:65], v[64:65], v[152:153], v[154:155]
v_pk_fma_f32 v[66:67], v[66:67], v[156:157], v[158:159]
v_cvt_pk_bf16_f32 v18, v60, v61
v_cvt_pk_bf16_f32 v19, v62, v63
ds_read_b128 v[152:155], v7 offset:768
ds_read_b128 v[156:159], v7 offset:784
s_waitcnt lgkmcnt(6)
v_pk_fma_f32 v[68:69], v[68:69], v[160:161], v[162:163]
v_pk_fma_f32 v[70:71], v[70:71], v[164:165], v[166:167]
v_cvt_pk_bf16_f32 v20, v64, v65
v_cvt_pk_bf16_f32 v21, v66, v67
ds_read_b128 v[160:163], v7 offset:800
ds_read_b128 v[164:167], v7 offset:816
s_waitcnt lgkmcnt(6)
v_pk_fma_f32 v[72:73], v[72:73], v[136:137], v[138:139]
v_pk_fma_f32 v[74:75], v[74:75], v[140:141], v[142:143]
v_cvt_pk_bf16_f32 v22, v68, v69
v_cvt_pk_bf16_f32 v23, v70, v71
ds_read_b128 v[136:139], v7 offset:1024
ds_read_b128 v[140:143], v7 offset:1040
s_waitcnt lgkmcnt(6)
v_pk_fma_f32 v[76:77], v[76:77], v[144:145], v[146:147]
v_pk_fma_f32 v[78:79], v[78:79], v[148:149], v[150:151]
v_cvt_pk_bf16_f32 v24, v72, v73
v_cvt_pk_bf16_f32 v25, v74, v75
ds_read_b128 v[144:147], v7 offset:1056
ds_read_b128 v[148:151], v7 offset:1072
s_waitcnt lgkmcnt(6)
v_pk_fma_f32 v[80:81], v[80:81], v[152:153], v[154:155]
v_pk_fma_f32 v[82:83], v[82:83], v[156:157], v[158:159]
v_cvt_pk_bf16_f32 v26, v76, v77
v_cvt_pk_bf16_f32 v27, v78, v79
ds_read_b128 v[152:155], v7 offset:1280
ds_read_b128 v[156:159], v7 offset:1296
s_waitcnt lgkmcnt(6)
v_pk_fma_f32 v[84:85], v[84:85], v[160:161], v[162:163]
v_pk_fma_f32 v[86:87], v[86:87], v[164:165], v[166:167]
v_cvt_pk_bf16_f32 v28, v80, v81
v_cvt_pk_bf16_f32 v29, v82, v83
ds_read_b128 v[160:163], v7 offset:1312
ds_read_b128 v[164:167], v7 offset:1328
s_waitcnt lgkmcnt(6)
v_pk_fma_f32 v[88:89], v[88:89], v[136:137], v[138:139]
v_pk_fma_f32 v[90:91], v[90:91], v[140:141], v[142:143]
v_cvt_pk_bf16_f32 v30, v84, v85
v_cvt_pk_bf16_f32 v31, v86, v87
ds_read_b128 v[136:139], v7 offset:1536
ds_read_b128 v[140:143], v7 offset:1552
s_waitcnt lgkmcnt(6)
v_pk_fma_f32 v[92:93], v[92:93], v[144:145], v[146:147]
v_pk_fma_f32 v[94:95], v[94:95], v[148:149], v[150:151]
v_cvt_pk_bf16_f32 v32, v88, v89
v_cvt_pk_bf16_f32 v33, v90, v91
ds_read_b128 v[144:147], v7 offset:1568
ds_read_b128 v[148:151], v7 offset:1584
s_waitcnt lgkmcnt(6)
v_pk_fma_f32 v[96:97], v[96:97], v[152:153], v[154:155]
v_pk_fma_f32 v[98:99], v[98:99], v[156:157], v[158:159]
v_cvt_pk_bf16_f32 v34, v92, v93
v_cvt_pk_bf16_f32 v35, v94, v95
ds_read_b128 v[152:155], v7 offset:1792
ds_read_b128 v[156:159], v7 offset:1808
s_waitcnt lgkmcnt(6)
v_pk_fma_f32 v[100:101], v[100:101], v[160:161], v[162:163]
v_pk_fma_f32 v[102:103], v[102:103], v[164:165], v[166:167]
v_cvt_pk_bf16_f32 v36, v96, v97
v_cvt_pk_bf16_f32 v37, v98, v99
ds_read_b128 v[160:163], v7 offset:1824
ds_read_b128 v[164:167], v7 offset:1840
s_lshl_b32 s28, s27, 2
s_add_u32 s28, s28, 136224
v_mov_b32 v4, s28
v_mov_b32 v5, s23
s_mov_b64 exec, 1
ds_write_b32 v4, v5
s_mov_b64 exec, -1
s_waitcnt lgkmcnt(7)
v_pk_fma_f32 v[104:105], v[104:105], v[136:137], v[138:139]
v_pk_fma_f32 v[106:107], v[106:107], v[140:141], v[142:143]
v_cvt_pk_bf16_f32 v38, v100, v101
v_cvt_pk_bf16_f32 v39, v102, v103
ds_read_b128 v[136:139], v7 offset:2048
ds_read_b128 v[140:143], v7 offset:2064
s_waitcnt lgkmcnt(6)
v_pk_fma_f32 v[108:109], v[108:109], v[144:145], v[146:147]
v_pk_fma_f32 v[110:111], v[110:111], v[148:149], v[150:151]
v_cvt_pk_bf16_f32 v40, v104, v105
v_cvt_pk_bf16_f32 v41, v106, v107
ds_read_b128 v[144:147], v7 offset:2080
ds_read_b128 v[148:151], v7 offset:2096
s_waitcnt lgkmcnt(6)
v_pk_fma_f32 v[112:113], v[112:113], v[152:153], v[154:155]
v_pk_fma_f32 v[114:115], v[114:115], v[156:157], v[158:159]
v_cvt_pk_bf16_f32 v42, v108, v109
v_cvt_pk_bf16_f32 v43, v110, v111
ds_read_b128 v[152:155], v7 offset:2304
ds_read_b128 v[156:159], v7 offset:2320
s_waitcnt lgkmcnt(6)
v_pk_fma_f32 v[116:117], v[116:117], v[160:161], v[162:163]
v_pk_fma_f32 v[118:119], v[118:119], v[164:165], v[166:167]
v_cvt_pk_bf16_f32 v44, v112, v113
v_cvt_pk_bf16_f32 v45, v114, v115
ds_read_b128 v[160:163], v7 offset:2336
ds_read_b128 v[164:167], v7 offset:2352
s_waitcnt lgkmcnt(6)
v_pk_fma_f32 v[120:121], v[120:121], v[136:137], v[138:139]
v_pk_fma_f32 v[122:123], v[122:123], v[140:141], v[142:143]
v_cvt_pk_bf16_f32 v46, v116, v117
v_cvt_pk_bf16_f32 v47, v118, v119
s_waitcnt lgkmcnt(4)
v_pk_fma_f32 v[124:125], v[124:125], v[144:145], v[146:147]
v_pk_fma_f32 v[126:127], v[126:127], v[148:149], v[150:151]
v_cvt_pk_bf16_f32 v48, v120, v121
v_cvt_pk_bf16_f32 v49, v122, v123
s_waitcnt lgkmcnt(2)
v_pk_fma_f32 v[128:129], v[128:129], v[152:153], v[154:155]
v_pk_fma_f32 v[130:131], v[130:131], v[156:157], v[158:159]
v_cvt_pk_bf16_f32 v50, v124, v125
v_cvt_pk_bf16_f32 v51, v126, v127
s_waitcnt lgkmcnt(0)
v_pk_fma_f32 v[132:133], v[132:133], v[160:161], v[162:163]
v_pk_fma_f32 v[134:135], v[134:135], v[164:165], v[166:167]
v_cvt_pk_bf16_f32 v52, v128, v129
v_cvt_pk_bf16_f32 v53, v130, v131
v_cvt_pk_bf16_f32 v54, v132, v133
v_cvt_pk_bf16_f32 v55, v134, v135
s_branch Lhd_34
Lh2_32:
s_cmp_ge_u32 s3, 4
s_cbranch_scc1 Lh3_33
ds_read_b128 v[136:139], v7 offset:0
ds_read_b128 v[140:143], v7 offset:16
ds_read_b128 v[144:147], v7 offset:32
ds_read_b128 v[148:151], v7 offset:48
ds_read_b128 v[152:155], v7 offset:256
ds_read_b128 v[156:159], v7 offset:272
ds_read_b128 v[160:163], v7 offset:288
ds_read_b128 v[164:167], v7 offset:304
s_waitcnt lgkmcnt(6)
v_pk_fma_f32 v[56:57], v[56:57], v[136:137], v[138:139]
v_pk_fma_f32 v[58:59], v[58:59], v[140:141], v[142:143]
ds_read_b128 v[136:139], v7 offset:512
ds_read_b128 v[140:143], v7 offset:528
s_waitcnt lgkmcnt(6)
v_pk_fma_f32 v[60:61], v[60:61], v[144:145], v[146:147]
v_pk_fma_f32 v[62:63], v[62:63], v[148:149], v[150:151]
v_cvt_pk_bf16_f32 v16, v56, v57
v_cvt_pk_bf16_f32 v17, v58, v59
ds_read_b128 v[144:147], v7 offset:544
ds_read_b128 v[148:151], v7 offset:560
s_waitcnt lgkmcnt(6)
v_pk_fma_f32 v[64:65], v[64:65], v[152:153], v[154:155]
v_pk_fma_f32 v[66:67], v[66:67], v[156:157], v[158:159]
v_cvt_pk_bf16_f32 v18, v60, v61
v_cvt_pk_bf16_f32 v19, v62, v63
ds_read_b128 v[152:155], v7 offset:768
ds_read_b128 v[156:159], v7 offset:784
s_waitcnt lgkmcnt(6)
v_pk_fma_f32 v[68:69], v[68:69], v[160:161], v[162:163]
v_pk_fma_f32 v[70:71], v[70:71], v[164:165], v[166:167]
v_cvt_pk_bf16_f32 v20, v64, v65
v_cvt_pk_bf16_f32 v21, v66, v67
ds_read_b128 v[160:163], v7 offset:800
ds_read_b128 v[164:167], v7 offset:816
s_waitcnt lgkmcnt(6)
v_pk_fma_f32 v[72:73], v[72:73], v[136:137], v[138:139]
v_pk_fma_f32 v[74:75], v[74:75], v[140:141], v[142:143]
v_cvt_pk_bf16_f32 v22, v68, v69
v_cvt_pk_bf16_f32 v23, v70, v71
ds_read_b128 v[136:139], v7 offset:1024
ds_read_b128 v[140:143], v7 offset:1040
s_waitcnt lgkmcnt(6)
v_pk_fma_f32 v[76:77], v[76:77], v[144:145], v[146:147]
v_pk_fma_f32 v[78:79], v[78:79], v[148:149], v[150:151]
v_cvt_pk_bf16_f32 v24, v72, v73
v_cvt_pk_bf16_f32 v25, v74, v75
ds_read_b128 v[144:147], v7 offset:1056
ds_read_b128 v[148:151], v7 offset:1072
s_waitcnt lgkmcnt(6)
v_pk_fma_f32 v[80:81], v[80:81], v[152:153], v[154:155]
v_pk_fma_f32 v[82:83], v[82:83], v[156:157], v[158:159]
v_cvt_pk_bf16_f32 v26, v76, v77
v_cvt_pk_bf16_f32 v27, v78, v79
ds_read_b128 v[152:155], v7 offset:1280
ds_read_b128 v[156:159], v7 offset:1296
s_waitcnt lgkmcnt(6)
v_pk_fma_f32 v[84:85], v[84:85], v[160:161], v[162:163]
v_pk_fma_f32 v[86:87], v[86:87], v[164:165], v[166:167]
v_cvt_pk_bf16_f32 v28, v80, v81
v_cvt_pk_bf16_f32 v29, v82, v83
ds_read_b128 v[160:163], v7 offset:1312
ds_read_b128 v[164:167], v7 offset:1328
s_waitcnt lgkmcnt(6)
v_pk_fma_f32 v[88:89], v[88:89], v[136:137], v[138:139]
v_pk_fma_f32 v[90:91], v[90:91], v[140:141], v[142:143]
v_cvt_pk_bf16_f32 v30, v84, v85
v_cvt_pk_bf16_f32 v31, v86, v87
ds_read_b128 v[136:139], v7 offset:1536
ds_read_b128 v[140:143], v7 offset:1552
s_waitcnt lgkmcnt(6)
v_pk_fma_f32 v[92:93], v[92:93], v[144:145], v[146:147]
v_pk_fma_f32 v[94:95], v[94:95], v[148:149], v[150:151]
v_cvt_pk_bf16_f32 v32, v88, v89
v_cvt_pk_bf16_f32 v33, v90, v91
ds_read_b128 v[144:147], v7 offset:1568
ds_read_b128 v[148:151], v7 offset:1584
s_waitcnt lgkmcnt(6)
v_pk_fma_f32 v[96:97], v[96:97], v[152:153], v[154:155]
v_pk_fma_f32 v[98:99], v[98:99], v[156:157], v[158:159]
v_cvt_pk_bf16_f32 v34, v92, v93
v_cvt_pk_bf16_f32 v35, v94, v95
ds_read_b128 v[152:155], v7 offset:1792
ds_read_b128 v[156:159], v7 offset:1808
s_waitcnt lgkmcnt(6)
v_pk_fma_f32 v[100:101], v[100:101], v[160:161], v[162:163]
v_pk_fma_f32 v[102:103], v[102:103], v[164:165], v[166:167]
v_cvt_pk_bf16_f32 v36, v96, v97
v_cvt_pk_bf16_f32 v37, v98, v99
ds_read_b128 v[160:163], v7 offset:1824
ds_read_b128 v[164:167], v7 offset:1840
s_waitcnt lgkmcnt(6)
v_pk_fma_f32 v[104:105], v[104:105], v[136:137], v[138:139]
v_pk_fma_f32 v[106:107], v[106:107], v[140:141], v[142:143]
v_cvt_pk_bf16_f32 v38, v100, v101
v_cvt_pk_bf16_f32 v39, v102, v103
ds_read_b128 v[136:139], v7 offset:2048
ds_read_b128 v[140:143], v7 offset:2064
s_waitcnt lgkmcnt(6)
v_pk_fma_f32 v[108:109], v[108:109], v[144:145], v[146:147]
v_pk_fma_f32 v[110:111], v[110:111], v[148:149], v[150:151]
v_cvt_pk_bf16_f32 v40, v104, v105
v_cvt_pk_bf16_f32 v41, v106, v107
ds_read_b128 v[144:147], v7 offset:2080
ds_read_b128 v[148:151], v7 offset:2096
s_waitcnt lgkmcnt(6)
v_pk_fma_f32 v[112:113], v[112:113], v[152:153], v[154:155]
v_pk_fma_f32 v[114:115], v[114:115], v[156:157], v[158:159]
v_cvt_pk_bf16_f32 v42, v108, v109
v_cvt_pk_bf16_f32 v43, v110, v111
ds_read_b128 v[152:155], v7 offset:2304
ds_read_b128 v[156:159], v7 offset:2320
s_waitcnt lgkmcnt(6)
v_pk_fma_f32 v[116:117], v[116:117], v[160:161], v[162:163]
v_pk_fma_f32 v[118:119], v[118:119], v[164:165], v[166:167]
v_cvt_pk_bf16_f32 v44, v112, v113
v_cvt_pk_bf16_f32 v45, v114, v115
ds_read_b128 v[160:163], v7 offset:2336
ds_read_b128 v[164:167], v7 offset:2352
s_waitcnt lgkmcnt(6)
v_pk_fma_f32 v[120:121], v[120:121], v[136:137], v[138:139]
v_pk_fma_f32 v[122:123], v[122:123], v[140:141], v[142:143]
v_cvt_pk_bf16_f32 v46, v116, v117
v_cvt_pk_bf16_f32 v47, v118, v119
s_waitcnt lgkmcnt(4)
v_pk_fma_f32 v[124:125], v[124:125], v[144:145], v[146:147]
v_pk_fma_f32 v[126:127], v[126:127], v[148:149], v[150:151]
v_cvt_pk_bf16_f32 v48, v120, v121
v_cvt_pk_bf16_f32 v49, v122, v123
s_waitcnt lgkmcnt(2)
v_pk_fma_f32 v[128:129], v[128:129], v[152:153], v[154:155]
v_pk_fma_f32 v[130:131], v[130:131], v[156:157], v[158:159]
v_cvt_pk_bf16_f32 v50, v124, v125
v_cvt_pk_bf16_f32 v51, v126, v127
s_waitcnt lgkmcnt(0)
v_pk_fma_f32 v[132:133], v[132:133], v[160:161], v[162:163]
v_pk_fma_f32 v[134:135], v[134:135], v[164:165], v[166:167]
v_cvt_pk_bf16_f32 v52, v128, v129
v_cvt_pk_bf16_f32 v53, v130, v131
v_cvt_pk_bf16_f32 v54, v132, v133
v_cvt_pk_bf16_f32 v55, v134, v135
s_branch Lhd_34
Lh3_33:
ds_read_b128 v[136:139], v7 offset:0
ds_read_b128 v[140:143], v7 offset:16
ds_read_b128 v[144:147], v7 offset:32
ds_read_b128 v[148:151], v7 offset:48
ds_read_b128 v[152:155], v7 offset:256
ds_read_b128 v[156:159], v7 offset:272
ds_read_b128 v[160:163], v7 offset:288
ds_read_b128 v[164:167], v7 offset:304
s_waitcnt lgkmcnt(6)
v_pk_fma_f32 v[56:57], v[56:57], v[136:137], v[138:139]
v_pk_fma_f32 v[58:59], v[58:59], v[140:141], v[142:143]
s_add_u32 s29, s35, 81920
s_add_u32 m0, s45, 10240
s_nop 0
buffer_load_dwordx4 v13, s[16:19], s29 offen lds
ds_read_b128 v[136:139], v7 offset:512
ds_read_b128 v[140:143], v7 offset:528
s_waitcnt lgkmcnt(6)
v_pk_fma_f32 v[60:61], v[60:61], v[144:145], v[146:147]
v_pk_fma_f32 v[62:63], v[62:63], v[148:149], v[150:151]
v_cvt_pk_bf16_f32 v16, v56, v57
v_cvt_pk_bf16_f32 v17, v58, v59
s_add_u32 s29, s35, 102400
s_add_u32 m0, s45, 11264
s_nop 0
buffer_load_dwordx4 v13, s[16:19], s29 offen lds
ds_read_b128 v[144:147], v7 offset:544
ds_read_b128 v[148:151], v7 offset:560
s_waitcnt lgkmcnt(6)
v_pk_fma_f32 v[64:65], v[64:65], v[152:153], v[154:155]
v_pk_fma_f32 v[66:67], v[66:67], v[156:157], v[158:159]
v_cvt_pk_bf16_f32 v18, v60, v61
v_cvt_pk_bf16_f32 v19, v62, v63
s_add_u32 s29, s35, 81984
s_add_u32 m0, s45, 12288
s_nop 0
buffer_load_dwordx4 v13, s[16:19], s29 offen lds
ds_read_b128 v[152:155], v7 offset:768
ds_read_b128 v[156:159], v7 offset:784
s_waitcnt lgkmcnt(6)
v_pk_fma_f32 v[68:69], v[68:69], v[160:161], v[162:163]
v_pk_fma_f32 v[70:71], v[70:71], v[164:165], v[166:167]
v_cvt_pk_bf16_f32 v20, v64, v65
v_cvt_pk_bf16_f32 v21, v66, v67
s_add_u32 s29, s35, 102464
s_add_u32 m0, s45, 13312
s_nop 0
buffer_load_dwordx4 v13, s[16:19], s29 offen lds
ds_read_b128 v[160:163], v7 offset:800
ds_read_b128 v[164:167], v7 offset:816
s_waitcnt lgkmcnt(6)
v_pk_fma_f32 v[72:73], v[72:73], v[136:137], v[138:139]
v_pk_fma_f32 v[74:75], v[74:75], v[140:141], v[142:143]
v_cvt_pk_bf16_f32 v22, v68, v69
v_cvt_pk_bf16_f32 v23, v70, v71
s_add_u32 s29, s36, 81920
s_add_u32 m0, s45, 14336
s_nop 0
buffer_load_dwordx4 v10, s[16:19], s29 offen lds
ds_read_b128 v[136:139], v7 offset:1024
ds_read_b128 v[140:143], v7 offset:1040
s_waitcnt lgkmcnt(6)
v_pk_fma_f32 v[76:77], v[76:77], v[144:145], v[146:147]
v_pk_fma_f32 v[78:79], v[78:79], v[148:149], v[150:151]
v_cvt_pk_bf16_f32 v24, v72, v73
v_cvt_pk_bf16_f32 v25, v74, v75
s_add_u32 s29, s35, 122880
s_add_u32 m0, s45, 15360
s_nop 0
buffer_load_dwordx4 v13, s[16:19], s29 offen lds
ds_read_b128 v[144:147], v7 offset:1056
ds_read_b128 v[148:151], v7 offset:1072
s_waitcnt lgkmcnt(6)
v_pk_fma_f32 v[80:81], v[80:81], v[152:153], v[154:155]
v_pk_fma_f32 v[82:83], v[82:83], v[156:157], v[158:159]
v_cvt_pk_bf16_f32 v26, v76, v77
v_cvt_pk_bf16_f32 v27, v78, v79
s_add_u32 s29, s35, 143360
s_add_u32 m0, s45, 16384
s_nop 0
buffer_load_dwordx4 v13, s[16:19], s29 offen lds
ds_read_b128 v[152:155], v7 offset:1280
ds_read_b128 v[156:159], v7 offset:1296
s_waitcnt lgkmcnt(6)
v_pk_fma_f32 v[84:85], v[84:85], v[160:161], v[162:163]
v_pk_fma_f32 v[86:87], v[86:87], v[164:165], v[166:167]
v_cvt_pk_bf16_f32 v28, v80, v81
v_cvt_pk_bf16_f32 v29, v82, v83
s_add_u32 s29, s35, 122944
s_add_u32 m0, s45, 17408
s_nop 0
buffer_load_dwordx4 v13, s[16:19], s29 offen lds
ds_read_b128 v[160:163], v7 offset:1312
ds_read_b128 v[164:167], v7 offset:1328
s_waitcnt lgkmcnt(6)
v_pk_fma_f32 v[88:89], v[88:89], v[136:137], v[138:139]
v_pk_fma_f32 v[90:91], v[90:91], v[140:141], v[142:143]
v_cvt_pk_bf16_f32 v30, v84, v85
v_cvt_pk_bf16_f32 v31, v86, v87
s_add_u32 s29, s35, 143424
s_add_u32 m0, s45, 18432
s_nop 0
buffer_load_dwordx4 v13, s[16:19], s29 offen lds
ds_read_b128 v[136:139], v7 offset:1536
ds_read_b128 v[140:143], v7 offset:1552
s_waitcnt lgkmcnt(6)
v_pk_fma_f32 v[92:93], v[92:93], v[144:145], v[146:147]
v_pk_fma_f32 v[94:95], v[94:95], v[148:149], v[150:151]
v_cvt_pk_bf16_f32 v32, v88, v89
v_cvt_pk_bf16_f32 v33, v90, v91
s_add_u32 s29, s36, 122880
s_add_u32 m0, s45, 19456
s_nop 0
buffer_load_dwordx4 v10, s[16:19], s29 offen lds
ds_read_b128 v[144:147], v7 offset:1568
ds_read_b128 v[148:151], v7 offset:1584
s_waitcnt lgkmcnt(6)
v_pk_fma_f32 v[96:97], v[96:97], v[152:153], v[154:155]
v_pk_fma_f32 v[98:99], v[98:99], v[156:157], v[158:159]
v_cvt_pk_bf16_f32 v34, v92, v93
v_cvt_pk_bf16_f32 v35, v94, v95
ds_read_b128 v[152:155], v7 offset:1792
ds_read_b128 v[156:159], v7 offset:1808
s_waitcnt lgkmcnt(6)
v_pk_fma_f32 v[100:101], v[100:101], v[160:161], v[162:163]
v_pk_fma_f32 v[102:103], v[102:103], v[164:165], v[166:167]
v_cvt_pk_bf16_f32 v36, v96, v97
v_cvt_pk_bf16_f32 v37, v98, v99
ds_read_b128 v[160:163], v7 offset:1824
ds_read_b128 v[164:167], v7 offset:1840
s_waitcnt lgkmcnt(6)
v_pk_fma_f32 v[104:105], v[104:105], v[136:137], v[138:139]
v_pk_fma_f32 v[106:107], v[106:107], v[140:141], v[142:143]
v_cvt_pk_bf16_f32 v38, v100, v101
v_cvt_pk_bf16_f32 v39, v102, v103
ds_read_b128 v[136:139], v7 offset:2048
ds_read_b128 v[140:143], v7 offset:2064
s_waitcnt lgkmcnt(6)
v_pk_fma_f32 v[108:109], v[108:109], v[144:145], v[146:147]
v_pk_fma_f32 v[110:111], v[110:111], v[148:149], v[150:151]
v_cvt_pk_bf16_f32 v40, v104, v105
v_cvt_pk_bf16_f32 v41, v106, v107
ds_read_b128 v[144:147], v7 offset:2080
ds_read_b128 v[148:151], v7 offset:2096
s_waitcnt lgkmcnt(6)
v_pk_fma_f32 v[112:113], v[112:113], v[152:153], v[154:155]
v_pk_fma_f32 v[114:115], v[114:115], v[156:157], v[158:159]
v_cvt_pk_bf16_f32 v42, v108, v109
v_cvt_pk_bf16_f32 v43, v110, v111
ds_read_b128 v[152:155], v7 offset:2304
ds_read_b128 v[156:159], v7 offset:2320
s_waitcnt lgkmcnt(6)
v_pk_fma_f32 v[116:117], v[116:117], v[160:161], v[162:163]
v_pk_fma_f32 v[118:119], v[118:119], v[164:165], v[166:167]
v_cvt_pk_bf16_f32 v44, v112, v113
v_cvt_pk_bf16_f32 v45, v114, v115
ds_read_b128 v[160:163], v7 offset:2336
ds_read_b128 v[164:167], v7 offset:2352
s_waitcnt lgkmcnt(6)
v_pk_fma_f32 v[120:121], v[120:121], v[136:137], v[138:139]
v_pk_fma_f32 v[122:123], v[122:123], v[140:141], v[142:143]
v_cvt_pk_bf16_f32 v46, v116, v117
v_cvt_pk_bf16_f32 v47, v118, v119
s_waitcnt lgkmcnt(4)
v_pk_fma_f32 v[124:125], v[124:125], v[144:145], v[146:147]
v_pk_fma_f32 v[126:127], v[126:127], v[148:149], v[150:151]
v_cvt_pk_bf16_f32 v48, v120, v121
v_cvt_pk_bf16_f32 v49, v122, v123
s_waitcnt lgkmcnt(2)
v_pk_fma_f32 v[128:129], v[128:129], v[152:153], v[154:155]
v_pk_fma_f32 v[130:131], v[130:131], v[156:157], v[158:159]
v_cvt_pk_bf16_f32 v50, v124, v125
v_cvt_pk_bf16_f32 v51, v126, v127
s_waitcnt lgkmcnt(0)
v_pk_fma_f32 v[132:133], v[132:133], v[160:161], v[162:163]
v_pk_fma_f32 v[134:135], v[134:135], v[164:165], v[166:167]
v_cvt_pk_bf16_f32 v52, v128, v129
v_cvt_pk_bf16_f32 v53, v130, v131
v_cvt_pk_bf16_f32 v54, v132, v133
v_cvt_pk_bf16_f32 v55, v134, v135
Lhd_34:
s_cmp_ge_u32 s3, 2
s_cbranch_scc1 Lnokv_35
s_cmp_lg_u32 s38, 0
s_cbranch_scc1 Lvproj_36
v_mfma_f32_16x16x32_bf16 v[248:251], v[168:171], v[16:19], 0
v_mfma_f32_16x16x32_bf16 v[252:255], v[172:175], v[16:19], 0
v_mfma_f32_16x16x32_bf16 v[248:251], v[176:179], v[20:23], v[248:251]
v_mfma_f32_16x16x32_bf16 v[252:255], v[180:183], v[20:23], v[252:255]
v_mfma_f32_16x16x32_bf16 v[248:251], v[184:187], v[24:27], v[248:251]
v_mfma_f32_16x16x32_bf16 v[252:255], v[188:191], v[24:27], v[252:255]
v_mfma_f32_16x16x32_bf16 v[248:251], v[192:195], v[28:31], v[248:251]
v_mfma_f32_16x16x32_bf16 v[252:255], v[196:199], v[28:31], v[252:255]
v_mfma_f32_16x16x32_bf16 v[248:251], v[200:203], v[32:35], v[248:251]
v_mfma_f32_16x16x32_bf16 v[252:255], v[204:207], v[32:35], v[252:255]
v_mfma_f32_16x16x32_bf16 v[248:251], v[208:211], v[36:39], v[248:251]
v_mfma_f32_16x16x32_bf16 v[252:255], v[212:215], v[36:39], v[252:255]
v_mfma_f32_16x16x32_bf16 v[248:251], v[216:219], v[40:43], v[248:251]
v_mfma_f32_16x16x32_bf16 v[252:255], v[220:223], v[40:43], v[252:255]
v_mfma_f32_16x16x32_bf16 v[248:251], v[224:227], v[44:47], v[248:251]
v_mfma_f32_16x16x32_bf16 v[252:255], v[228:231], v[44:47], v[252:255]
v_mfma_f32_16x16x32_bf16 v[248:251], v[232:235], v[48:51], v[248:251]
v_mfma_f32_16x16x32_bf16 v[252:255], v[236:239], v[48:51], v[252:255]
v_mfma_f32_16x16x32_bf16 v[248:251], v[240:243], v[52:55], v[248:251]
v_mfma_f32_16x16x32_bf16 v[252:255], v[244:247], v[52:55], v[252:255]
s_branch Lkvw_37
Lvproj_36:
v_mfma_f32_16x16x32_bf16 v[248:251], v[16:19], v[168:171], 0
v_mfma_f32_16x16x32_bf16 v[252:255], v[16:19], v[172:175], 0
v_mfma_f32_16x16x32_bf16 v[248:251], v[20:23], v[176:179], v[248:251]
v_mfma_f32_16x16x32_bf16 v[252:255], v[20:23], v[180:183], v[252:255]
v_mfma_f32_16x16x32_bf16 v[248:251], v[24:27], v[184:187], v[248:251]
v_mfma_f32_16x16x32_bf16 v[252:255], v[24:27], v[188:191], v[252:255]
v_mfma_f32_16x16x32_bf16 v[248:251], v[28:31], v[192:195], v[248:251]
v_mfma_f32_16x16x32_bf16 v[252:255], v[28:31], v[196:199], v[252:255]
v_mfma_f32_16x16x32_bf16 v[248:251], v[32:35], v[200:203], v[248:251]
v_mfma_f32_16x16x32_bf16 v[252:255], v[32:35], v[204:207], v[252:255]
v_mfma_f32_16x16x32_bf16 v[248:251], v[36:39], v[208:211], v[248:251]
v_mfma_f32_16x16x32_bf16 v[252:255], v[36:39], v[212:215], v[252:255]
v_mfma_f32_16x16x32_bf16 v[248:251], v[40:43], v[216:219], v[248:251]
v_mfma_f32_16x16x32_bf16 v[252:255], v[40:43], v[220:223], v[252:255]
v_mfma_f32_16x16x32_bf16 v[248:251], v[44:47], v[224:227], v[248:251]
v_mfma_f32_16x16x32_bf16 v[252:255], v[44:47], v[228:231], v[252:255]
v_mfma_f32_16x16x32_bf16 v[248:251], v[48:51], v[232:235], v[248:251]
v_mfma_f32_16x16x32_bf16 v[252:255], v[48:51], v[236:239], v[252:255]
v_mfma_f32_16x16x32_bf16 v[248:251], v[52:55], v[240:243], v[248:251]
v_mfma_f32_16x16x32_bf16 v[252:255], v[52:55], v[244:247], v[252:255]
Lkvw_37:
v_add_u32 v6, 134144, v2
s_cmp_eq_u32 s3, 0
s_cbranch_scc1 Lkvw0_38
s_nop 3
ds_write_b128 v6, v[248:251]
ds_write_b128 v6, v[252:255] offset:1024
v_mov_b32 v4, 136232
v_mov_b32 v5, s23
s_mov_b64 exec, 1
ds_write_b32 v4, v5
s_mov_b64 exec, -1
s_branch Lnokv_35
Lkvw0_38:
s_lshl_b32 s28, s20, 1
s_lshr_b32 s29, s26, 1
s_add_u32 s28, s28, s29
s_mul_i32 s28, s28, 2560
s_add_u32 s28, s28, 24911872
s_and_b32 s29, s26, 1
v_mov_b32 v4, 136232
s_mov_b32 s25, 4194304
Llw_41:
ds_read_b32 v5, v4
s_waitcnt lgkmcnt(0)
v_readfirstlane_b32 s30, v5
s_nop 1
s_cmp_eq_u32 s30, s23
s_cbranch_scc1 Llwd_42
s_sleep 1
s_sub_u32 s25, s25, 1
s_cmp_lg_u32 s25, 0
s_cbranch_scc1 Llw_41
Llwd_42:
ds_read_b128 v[136:139], v6
ds_read_b128 v[140:143], v6 offset:1024
v_lshrrev_b32 v4, 4, v1
v_and_b32 v5, 15, v1
s_waitcnt lgkmcnt(0)
v_add_f32 v248, v248, v136
v_add_f32 v249, v249, v137
v_add_f32 v250, v250, v138
v_add_f32 v251, v251, v139
v_add_f32 v252, v252, v140
v_add_f32 v253, v253, v141
v_add_f32 v254, v254, v142
v_add_f32 v255, v255, v143
v_cvt_pk_bf16_f32 v136, v248, v249
v_cvt_pk_bf16_f32 v137, v250, v251
v_cvt_pk_bf16_f32 v138, v252, v253
v_cvt_pk_bf16_f32 v139, v254, v255
s_cmp_lg_u32 s38, 0
s_cbranch_scc1 Lvstore_39
s_lshl_b32 s29, s29, 4
v_bfe_u32 v6, v5, 2, 1
v_lshl_add_u32 v6, v6, 3, s29
v_lshrrev_b32 v7, 3, v5
v_lshl_add_u32 v6, v7, 2, v6
v_and_b32 v5, 3, v5
v_add_u32 v5, v5, v6
v_lshlrev_b32 v7, 3, v5
v_lshlrev_b32 v6, 4, v5
v_lshrrev_b32 v5, 1, v4
v_lshl_add_u32 v6, v5, 9, v6
v_and_b32 v4, 1, v4
v_lshl_add_u32 v6, v4, 3, v6
buffer_store_dwordx2 v[136:137], v6, s[8:11], s28 offen sc1
s_mov_b64 exec, 0xffff
buffer_store_dwordx2 v[138:139], v7, s[8:11], s28 offen offset:1024 sc1
s_mov_b64 exec, -1
s_branch Lkvdone_40
Lvstore_39:
s_mul_i32 s29, s29, 640
v_lshrrev_b32 v6, 1, v4
v_mul_u32_u24 v6, 320, v6
v_lshl_add_u32 v6, v5, 4, v6
v_and_b32 v4, 1, v4
v_lshl_add_u32 v6, v4, 3, v6
v_add_u32 v6, s29, v6
buffer_store_dwordx2 v[136:137], v6, s[8:11], s28 offen offset:1280 sc1
s_mov_b32 exec_lo, 0xf000f
s_mov_b32 exec_hi, 0xf000f
buffer_store_dwordx2 v[138:139], v6, s[8:11], s28 offen offset:1536 sc1
s_mov_b64 exec, -1
Lkvdone_40:
s_and_b32 s29, s26, 1
s_lshl_b32 s29, s29, 4
v_and_b32 v4, 15, v1
v_add_u32 v4, s29, v4
v_lshrrev_b32 v5, 4, v1
s_lshr_b32 s29, s26, 1
s_lshl_b32 s30, s29, 12
s_add_u32 s30, s30, 149504
s_lshl_b32 s29, s29, 10
s_add_u32 s29, s29, 157696
s_add_u32 s28, s38, 0
s_cmp_eq_u32 s28, 5
s_cselect_b32 s28, 0, s28
s_lshl_b32 s28, s28, 2
v_add_u32 v6, s28, v5
v_mul_u32_u24 v7, 13, v6
v_lshrrev_b32 v7, 6, v7
v_mul_u32_u24 v11, 5, v7
v_sub_u32 v6, v6, v11
v_lshlrev_b32 v11, 10, v7
v_lshrrev_b32 v12, 1, v6
v_lshl_add_u32 v11, v12, 9, v11
v_lshl_add_u32 v11, v4, 4, v11
v_and_b32 v12, 1, v6
v_lshl_add_u32 v11, v12, 3, v11
v_add_u32 v11, s30, v11
v_lshlrev_b32 v12, 8, v7
v_lshl_add_u32 v12, v4, 3, v12
v_add_u32 v12, s29, v12
v_cmp_eq_u32 vcc, 4, v6
s_nop 1
v_cndmask_b32 v236, v11, v12, vcc
s_add_u32 s28, s38, 1
s_cmp_eq_u32 s28, 5
s_cselect_b32 s28, 0, s28
s_lshl_b32 s28, s28, 2
v_add_u32 v6, s28, v5
v_mul_u32_u24 v7, 13, v6
v_lshrrev_b32 v7, 6, v7
v_mul_u32_u24 v11, 5, v7
v_sub_u32 v6, v6, v11
v_lshlrev_b32 v11, 10, v7
v_lshrrev_b32 v12, 1, v6
v_lshl_add_u32 v11, v12, 9, v11
v_lshl_add_u32 v11, v4, 4, v11
v_and_b32 v12, 1, v6
v_lshl_add_u32 v11, v12, 3, v11
v_add_u32 v11, s30, v11
v_lshlrev_b32 v12, 8, v7
v_lshl_add_u32 v12, v4, 3, v12
v_add_u32 v12, s29, v12
v_cmp_eq_u32 vcc, 4, v6
s_nop 1
v_cndmask_b32 v237, v11, v12, vcc
s_add_u32 s28, s38, 2
s_cmp_eq_u32 s28, 5
s_cselect_b32 s28, 0, s28
s_lshl_b32 s28, s28, 2
v_add_u32 v6, s28, v5
v_mul_u32_u24 v7, 13, v6
v_lshrrev_b32 v7, 6, v7
v_mul_u32_u24 v11, 5, v7
v_sub_u32 v6, v6, v11
v_lshlrev_b32 v11, 10, v7
v_lshrrev_b32 v12, 1, v6
v_lshl_add_u32 v11, v12, 9, v11
v_lshl_add_u32 v11, v4, 4, v11
v_and_b32 v12, 1, v6
v_lshl_add_u32 v11, v12, 3, v11
v_add_u32 v11, s30, v11
v_lshlrev_b32 v12, 8, v7
v_lshl_add_u32 v12, v4, 3, v12
v_add_u32 v12, s29, v12
v_cmp_eq_u32 vcc, 4, v6
s_nop 1
v_cndmask_b32 v238, v11, v12, vcc
s_add_u32 s28, s38, 3
s_cmp_eq_u32 s28, 5
s_cselect_b32 s28, 0, s28
s_lshl_b32 s28, s28, 2
v_add_u32 v6, s28, v5
v_mul_u32_u24 v7, 13, v6
v_lshrrev_b32 v7, 6, v7
v_mul_u32_u24 v11, 5, v7
v_sub_u32 v6, v6, v11
v_lshlrev_b32 v11, 10, v7
v_lshrrev_b32 v12, 1, v6
v_lshl_add_u32 v11, v12, 9, v11
v_lshl_add_u32 v11, v4, 4, v11
v_and_b32 v12, 1, v6
v_lshl_add_u32 v11, v12, 3, v11
v_add_u32 v11, s30, v11
v_lshlrev_b32 v12, 8, v7
v_lshl_add_u32 v12, v4, 3, v12
v_add_u32 v12, s29, v12
v_cmp_eq_u32 vcc, 4, v6
s_nop 1
v_cndmask_b32 v239, v11, v12, vcc
s_add_u32 s28, s38, 4
s_cmp_eq_u32 s28, 5
s_cselect_b32 s28, 0, s28
s_lshl_b32 s28, s28, 2
v_add_u32 v6, s28, v5
v_mul_u32_u24 v7, 13, v6
v_lshrrev_b32 v7, 6, v7
v_mul_u32_u24 v11, 5, v7
v_sub_u32 v6, v6, v11
v_lshlrev_b32 v11, 10, v7
v_lshrrev_b32 v12, 1, v6
v_lshl_add_u32 v11, v12, 9, v11
v_lshl_add_u32 v11, v4, 4, v11
v_and_b32 v12, 1, v6
v_lshl_add_u32 v11, v12, 3, v11
v_add_u32 v11, s30, v11
v_lshlrev_b32 v12, 8, v7
v_lshl_add_u32 v12, v4, 3, v12
v_add_u32 v12, s29, v12
v_cmp_eq_u32 vcc, 4, v6
s_nop 1
v_cndmask_b32 v240, v11, v12, vcc
s_lshl_b32 s28, s20, 3
s_add_u32 s28, s28, s21
s_lshl_b32 s28, s28, 7
s_add_u32 s28, s28, 24842240
s_waitcnt vmcnt(0)
s_mov_b64 exec, 1
v_mov_b32 v4, 0
v_mov_b32 v5, s23
buffer_store_dword v5, v4, s[8:11], s28 offen sc1
s_mov_b64 exec, -1
Lnokv_35:
s_setprio 0
s_mul_i32 s28, s27, 51200
v_lshl_add_u32 v8, v1, 3, s28
v_lshrrev_b32 v4, 5, v1
v_lshlrev_b32 v9, 10, v4
v_bfe_u32 v4, v1, 4, 1
v_mul_u32_u24 v5, 288, v4
v_add_u32 v9, v9, v5
v_bfe_u32 v5, v1, 2, 2
v_lshl_add_u32 v9, v5, 6, v9
v_and_b32 v5, 3, v1
v_lshl_add_u32 v9, v5, 3, v9
v_add_u32 v9, s28, v9
v_xor_b32 v14, 32, v9
s_cmp_lt_u32 s3, 4
s_cbranch_scc1 Lbarc_43
s_waitcnt vmcnt(0)
Lbarc_43:
s_waitcnt lgkmcnt(0)
s_barrier
v_lshrrev_b32 v6, 3, v1
v_lshlrev_b32 v6, 5, v6
v_and_b32 v7, 7, v1
v_add_lshl_u32 v6, v6, v7, 7
s_lshr_b32 s29, s3, 1
s_lshl_b32 s31, s29, 10
s_add_u32 s31, s31, 24842240
s_mul_i32 s32, s29, 5120
s_add_u32 s33, s32, 24911872
ds_read_b64_tr_b16 v[56:57], v9 offset:0
ds_read_b64_tr_b16 v[58:59], v9 offset:512
ds_read_b64_tr_b16 v[60:61], v14 offset:0
ds_read_b64_tr_b16 v[62:63], v14 offset:512
ds_read_b64_tr_b16 v[64:65], v9 offset:2048
ds_read_b64_tr_b16 v[66:67], v9 offset:2560
ds_read_b64_tr_b16 v[68:69], v14 offset:2048
ds_read_b64_tr_b16 v[70:71], v14 offset:2560
ds_read_b64_tr_b16 v[72:73], v8 offset:4096
ds_read_b64_tr_b16 v[74:75], v8 offset:4608
ds_read_b64_tr_b16 v[76:77], v9 offset:5120
ds_read_b64_tr_b16 v[78:79], v9 offset:5632
ds_read_b64_tr_b16 v[80:81], v14 offset:5120
ds_read_b64_tr_b16 v[82:83], v14 offset:5632
s_waitcnt lgkmcnt(10)
v_mfma_f32_16x16x32_bf16 v[216:219], v[56:59], v[16:19], 0
ds_read_b64_tr_b16 v[84:85], v9 offset:7168
ds_read_b64_tr_b16 v[86:87], v9 offset:7680
v_mfma_f32_16x16x32_bf16 v[220:223], v[60:63], v[16:19], 0
ds_read_b64_tr_b16 v[56:57], v14 offset:7168
ds_read_b64_tr_b16 v[58:59], v14 offset:7680
s_waitcnt lgkmcnt(10)
v_mfma_f32_16x16x32_bf16 v[224:227], v[64:67], v[16:19], 0
ds_read_b64_tr_b16 v[60:61], v8 offset:9216
ds_read_b64_tr_b16 v[62:63], v8 offset:9728
v_mfma_f32_16x16x32_bf16 v[228:231], v[68:71], v[16:19], 0
ds_read_b64_tr_b16 v[64:65], v9 offset:10240
ds_read_b64_tr_b16 v[66:67], v9 offset:10752
s_waitcnt lgkmcnt(10)
v_mfma_f32_16x16x32_bf16 v[232:235], v[72:75], v[16:19], 0
ds_read_b64_tr_b16 v[68:69], v14 offset:10240
ds_read_b64_tr_b16 v[70:71], v14 offset:10752
v_mfma_f32_16x16x32_bf16 v[216:219], v[76:79], v[20:23], v[216:219]
ds_read_b64_tr_b16 v[72:73], v9 offset:12288
ds_read_b64_tr_b16 v[74:75], v9 offset:12800
s_waitcnt lgkmcnt(10)
v_mfma_f32_16x16x32_bf16 v[220:223], v[80:83], v[20:23], v[220:223]
ds_read_b64_tr_b16 v[76:77], v14 offset:12288
ds_read_b64_tr_b16 v[78:79], v14 offset:12800
v_mfma_f32_16x16x32_bf16 v[224:227], v[84:87], v[20:23], v[224:227]
ds_read_b64_tr_b16 v[80:81], v8 offset:14336
ds_read_b64_tr_b16 v[82:83], v8 offset:14848
s_waitcnt lgkmcnt(10)
v_mfma_f32_16x16x32_bf16 v[228:231], v[56:59], v[20:23], v[228:231]
ds_read_b64_tr_b16 v[84:85], v9 offset:15360
ds_read_b64_tr_b16 v[86:87], v9 offset:15872
v_mfma_f32_16x16x32_bf16 v[232:235], v[60:63], v[20:23], v[232:235]
ds_read_b64_tr_b16 v[56:57], v14 offset:15360
ds_read_b64_tr_b16 v[58:59], v14 offset:15872
s_waitcnt lgkmcnt(10)
v_mfma_f32_16x16x32_bf16 v[216:219], v[64:67], v[24:27], v[216:219]
ds_read_b64_tr_b16 v[60:61], v9 offset:17408
ds_read_b64_tr_b16 v[62:63], v9 offset:17920
v_mfma_f32_16x16x32_bf16 v[220:223], v[68:71], v[24:27], v[220:223]
ds_read_b64_tr_b16 v[64:65], v14 offset:17408
ds_read_b64_tr_b16 v[66:67], v14 offset:17920
s_waitcnt lgkmcnt(10)
v_mfma_f32_16x16x32_bf16 v[224:227], v[72:75], v[24:27], v[224:227]
ds_read_b64_tr_b16 v[68:69], v8 offset:19456
ds_read_b64_tr_b16 v[70:71], v8 offset:19968
v_mfma_f32_16x16x32_bf16 v[228:231], v[76:79], v[24:27], v[228:231]
ds_read_b64_tr_b16 v[72:73], v9 offset:20480
ds_read_b64_tr_b16 v[74:75], v9 offset:20992
s_waitcnt lgkmcnt(10)
v_mfma_f32_16x16x32_bf16 v[232:235], v[80:83], v[24:27], v[232:235]
ds_read_b64_tr_b16 v[76:77], v14 offset:20480
ds_read_b64_tr_b16 v[78:79], v14 offset:20992
v_mfma_f32_16x16x32_bf16 v[216:219], v[84:87], v[28:31], v[216:219]
ds_read_b64_tr_b16 v[80:81], v9 offset:22528
ds_read_b64_tr_b16 v[82:83], v9 offset:23040
s_waitcnt lgkmcnt(10)
v_mfma_f32_16x16x32_bf16 v[220:223], v[56:59], v[28:31], v[220:223]
ds_read_b64_tr_b16 v[84:85], v14 offset:22528
ds_read_b64_tr_b16 v[86:87], v14 offset:23040
v_mfma_f32_16x16x32_bf16 v[224:227], v[60:63], v[28:31], v[224:227]
ds_read_b64_tr_b16 v[56:57], v8 offset:24576
ds_read_b64_tr_b16 v[58:59], v8 offset:25088
s_waitcnt lgkmcnt(10)
v_mfma_f32_16x16x32_bf16 v[228:231], v[64:67], v[28:31], v[228:231]
ds_read_b64_tr_b16 v[60:61], v9 offset:25600
ds_read_b64_tr_b16 v[62:63], v9 offset:26112
v_mfma_f32_16x16x32_bf16 v[232:235], v[68:71], v[28:31], v[232:235]
ds_read_b64_tr_b16 v[64:65], v14 offset:25600
ds_read_b64_tr_b16 v[66:67], v14 offset:26112
s_waitcnt lgkmcnt(10)
v_mfma_f32_16x16x32_bf16 v[216:219], v[72:75], v[32:35], v[216:219]
ds_read_b64_tr_b16 v[68:69], v9 offset:27648
ds_read_b64_tr_b16 v[70:71], v9 offset:28160
v_mfma_f32_16x16x32_bf16 v[220:223], v[76:79], v[32:35], v[220:223]
ds_read_b64_tr_b16 v[72:73], v14 offset:27648
ds_read_b64_tr_b16 v[74:75], v14 offset:28160
s_waitcnt lgkmcnt(10)
v_mfma_f32_16x16x32_bf16 v[224:227], v[80:83], v[32:35], v[224:227]
ds_read_b64_tr_b16 v[76:77], v8 offset:29696
ds_read_b64_tr_b16 v[78:79], v8 offset:30208
v_mfma_f32_16x16x32_bf16 v[228:231], v[84:87], v[32:35], v[228:231]
ds_read_b64_tr_b16 v[80:81], v9 offset:30720
ds_read_b64_tr_b16 v[82:83], v9 offset:31232
s_waitcnt lgkmcnt(10)
v_mfma_f32_16x16x32_bf16 v[232:235], v[56:59], v[32:35], v[232:235]
ds_read_b64_tr_b16 v[84:85], v14 offset:30720
ds_read_b64_tr_b16 v[86:87], v14 offset:31232
v_mfma_f32_16x16x32_bf16 v[216:219], v[60:63], v[36:39], v[216:219]
ds_read_b64_tr_b16 v[56:57], v9 offset:32768
ds_read_b64_tr_b16 v[58:59], v9 offset:33280
s_waitcnt lgkmcnt(10)
v_mfma_f32_16x16x32_bf16 v[220:223], v[64:67], v[36:39], v[220:223]
ds_read_b64_tr_b16 v[60:61], v14 offset:32768
ds_read_b64_tr_b16 v[62:63], v14 offset:33280
v_mfma_f32_16x16x32_bf16 v[224:227], v[68:71], v[36:39], v[224:227]
ds_read_b64_tr_b16 v[64:65], v8 offset:34816
ds_read_b64_tr_b16 v[66:67], v8 offset:35328
s_waitcnt lgkmcnt(10)
v_mfma_f32_16x16x32_bf16 v[228:231], v[72:75], v[36:39], v[228:231]
ds_read_b64_tr_b16 v[68:69], v9 offset:35840
ds_read_b64_tr_b16 v[70:71], v9 offset:36352
v_mfma_f32_16x16x32_bf16 v[232:235], v[76:79], v[36:39], v[232:235]
ds_read_b64_tr_b16 v[72:73], v14 offset:35840
ds_read_b64_tr_b16 v[74:75], v14 offset:36352
s_waitcnt lgkmcnt(10)
v_mfma_f32_16x16x32_bf16 v[216:219], v[80:83], v[40:43], v[216:219]
ds_read_b64_tr_b16 v[76:77], v9 offset:37888
ds_read_b64_tr_b16 v[78:79], v9 offset:38400
v_mfma_f32_16x16x32_bf16 v[220:223], v[84:87], v[40:43], v[220:223]
ds_read_b64_tr_b16 v[80:81], v14 offset:37888
ds_read_b64_tr_b16 v[82:83], v14 offset:38400
s_waitcnt lgkmcnt(10)
v_mfma_f32_16x16x32_bf16 v[224:227], v[56:59], v[40:43], v[224:227]
ds_read_b64_tr_b16 v[84:85], v8 offset:39936
ds_read_b64_tr_b16 v[86:87], v8 offset:40448
v_mfma_f32_16x16x32_bf16 v[228:231], v[60:63], v[40:43], v[228:231]
ds_read_b64_tr_b16 v[56:57], v9 offset:40960
ds_read_b64_tr_b16 v[58:59], v9 offset:41472
s_waitcnt lgkmcnt(10)
v_mfma_f32_16x16x32_bf16 v[232:235], v[64:67], v[40:43], v[232:235]
ds_read_b64_tr_b16 v[60:61], v14 offset:40960
ds_read_b64_tr_b16 v[62:63], v14 offset:41472
s_cmp_eq_u32 s27, 0
s_cbranch_scc1 Lnofl1r_44
buffer_load_dword v7, v6, s[8:11], s31 offen sc1
Lnofl1r_44:
v_mfma_f32_16x16x32_bf16 v[216:219], v[68:71], v[44:47], v[216:219]
ds_read_b64_tr_b16 v[64:65], v9 offset:43008
ds_read_b64_tr_b16 v[66:67], v9 offset:43520
s_waitcnt lgkmcnt(10)
v_mfma_f32_16x16x32_bf16 v[220:223], v[72:75], v[44:47], v[220:223]
ds_read_b64_tr_b16 v[68:69], v14 offset:43008
ds_read_b64_tr_b16 v[70:71], v14 offset:43520
v_mfma_f32_16x16x32_bf16 v[224:227], v[76:79], v[44:47], v[224:227]
ds_read_b64_tr_b16 v[72:73], v8 offset:45056
ds_read_b64_tr_b16 v[74:75], v8 offset:45568
s_waitcnt lgkmcnt(10)
v_mfma_f32_16x16x32_bf16 v[228:231], v[80:83], v[44:47], v[228:231]
ds_read_b64_tr_b16 v[76:77], v9 offset:46080
ds_read_b64_tr_b16 v[78:79], v9 offset:46592
v_mfma_f32_16x16x32_bf16 v[232:235], v[84:87], v[44:47], v[232:235]
ds_read_b64_tr_b16 v[80:81], v14 offset:46080
ds_read_b64_tr_b16 v[82:83], v14 offset:46592
s_waitcnt lgkmcnt(10)
v_mfma_f32_16x16x32_bf16 v[216:219], v[56:59], v[48:51], v[216:219]
ds_read_b64_tr_b16 v[84:85], v9 offset:48128
ds_read_b64_tr_b16 v[86:87], v9 offset:48640
v_mfma_f32_16x16x32_bf16 v[220:223], v[60:63], v[48:51], v[220:223]
ds_read_b64_tr_b16 v[56:57], v14 offset:48128
ds_read_b64_tr_b16 v[58:59], v14 offset:48640
s_waitcnt lgkmcnt(10)
v_mfma_f32_16x16x32_bf16 v[224:227], v[64:67], v[48:51], v[224:227]
ds_read_b64_tr_b16 v[60:61], v8 offset:50176
ds_read_b64_tr_b16 v[62:63], v8 offset:50688
v_mfma_f32_16x16x32_bf16 v[228:231], v[68:71], v[48:51], v[228:231]
s_waitcnt lgkmcnt(8)
v_mfma_f32_16x16x32_bf16 v[232:235], v[72:75], v[48:51], v[232:235]
s_cmp_eq_u32 s27, 0
s_cbranch_scc1 Lnotry_45
s_waitcnt vmcnt(0)
v_cmp_ne_u32 vcc, s23, v7
s_nop 1
s_cbranch_vccnz Lnotry_45
s_add_u32 m0, s32, 122880
s_nop 0
buffer_load_dwordx4 v2, s[8:11], s33 offen sc1 lds
buffer_load_dwordx4 v2, s[8:11], s33 offen offset:1024 sc1 lds
buffer_load_dwordx4 v2, s[8:11], s33 offen offset:2048 sc1 lds
buffer_load_dwordx4 v2, s[8:11], s33 offen offset:3072 sc1 lds
s_add_u32 s28, s33, 4096
s_add_u32 m0, s32, 126976
s_nop 0
buffer_load_dwordx4 v2, s[8:11], s28 offen sc1 lds
s_add_u32 s33, s33, 20480
s_mov_b32 s38, 2
Lnotry_45:
v_mfma_f32_16x16x32_bf16 v[216:219], v[76:79], v[52:55], v[216:219]
s_waitcnt lgkmcnt(4)
v_mfma_f32_16x16x32_bf16 v[220:223], v[80:83], v[52:55], v[220:223]
v_mfma_f32_16x16x32_bf16 v[224:227], v[84:87], v[52:55], v[224:227]
s_waitcnt lgkmcnt(0)
v_mfma_f32_16x16x32_bf16 v[228:231], v[56:59], v[52:55], v[228:231]
v_mfma_f32_16x16x32_bf16 v[232:235], v[60:63], v[52:55], v[232:235]
s_mul_i32 s28, s26, 5120
s_add_u32 s28, s28, 102400
v_add_u32 v4, s28, v2
s_cmp_eq_u32 s27, 0
s_cbranch_scc1 Lqlo_46
ds_write_b128 v4, v[216:219] offset:0
ds_write_b128 v4, v[220:223] offset:1024
ds_write_b128 v4, v[224:227] offset:2048
ds_write_b128 v4, v[228:231] offset:3072
ds_write_b128 v4, v[232:235] offset:4096
s_waitcnt lgkmcnt(0)
s_barrier
v_mov_b32 v4, 159744
v_mov_b32 v5, 0
ds_write_b32 v4, v5
ds_write_b32 v4, v5 offset:16
v_lshrrev_b32 v4, 1, v1
v_and_b32 v168, 1, v4
v_mul_u32_u24 v168, 640, v168
v_lshrrev_b32 v4, 1, v4
v_mul_u32_u24 v4, 2560, v4
v_add_u32 v4, v4, v168
v_and_b32 v168, 1, v1
v_lshl_add_u32 v4, v168, 4, v4
v_add_u32 v4, 143360, v4
v_cmp_eq_u32 vcc, 0, v168
v_mov_b32 v169, 0x3f803f80
s_nop 0
v_cndmask_b32 v168, 0, v169, vcc
v_mov_b32 v169, v168
v_mov_b32 v170, v168
v_mov_b32 v171, v168
s_mov_b64 exec, 0xff
ds_write_b128 v4, v[168:171]
s_mov_b64 exec, -1
s_cmp_eq_u32 s38, 2
s_cbranch_scc1 Lhavekv_48
s_mov_b32 s29, 524288
Lpoll_49:
buffer_load_dword v7, v6, s[8:11], s31 offen sc1
Lpollchk_51:
s_waitcnt vmcnt(0)
v_cmp_ne_u32 vcc, s23, v7
s_nop 1
s_cbranch_vccz Lpolled_50
s_sleep 1
s_sub_u32 s29, s29, 1
s_cmp_lg_u32 s29, 0
s_cbranch_scc1 Lpoll_49
Lpolled_50:
s_add_u32 m0, s32, 122880
s_nop 0
buffer_load_dwordx4 v2, s[8:11], s33 offen sc1 lds
buffer_load_dwordx4 v2, s[8:11], s33 offen offset:1024 sc1 lds
buffer_load_dwordx4 v2, s[8:11], s33 offen offset:2048 sc1 lds
buffer_load_dwordx4 v2, s[8:11], s33 offen offset:3072 sc1 lds
s_add_u32 s28, s33, 4096
s_add_u32 m0, s32, 126976
s_nop 0
buffer_load_dwordx4 v2, s[8:11], s28 offen sc1 lds
s_add_u32 s33, s33, 20480
Lhavekv_48:
s_and_b32 s28, s3, 3
s_mul_i32 s28, s28, 5120
s_add_u32 s28, s28, 122880
v_and_b32 v5, 31, v1
v_lshlrev_b32 v217, 3, v5
v_add_u32 v216, s28, v2
s_add_u32 s29, s28, 1024
v_add_u32 v3, s29, v217
v_lshrrev_b32 v6, 5, v1
v_mul_u32_u24 v6, 320, v6
v_lshl_add_u32 v4, v5, 4, v6
s_add_u32 s29, s28, 1280
v_add_u32 v4, s29, v4
v_cmp_eq_u32 vcc, 20, v5
v_mov_b32 v6, 143376
v_mov_b32 v7, 143360
v_cndmask_b32 v6, v6, v7, vcc
v_cmp_gt_u32 vcc, 20, v5
s_nop 1
v_cndmask_b32 v4, v6, v4, vcc
v_cndmask_b32 v218, 0, 1, vcc
s_mov_b32 s36, 20480
s_mov_b32 s26, 4294844416
s_cmp_lt_u32 s3, 4
s_cselect_b32 s34, 0x20, -1
s_waitcnt vmcnt(0) lgkmcnt(0)
s_branch Lqe_47
Lqlo_46:
s_barrier
ds_read_b128 v[168:171], v4 offset:0
ds_read_b128 v[172:175], v4 offset:1024
ds_read_b128 v[176:179], v4 offset:2048
ds_read_b128 v[180:183], v4 offset:3072
ds_read_b128 v[184:187], v4 offset:4096
s_waitcnt lgkmcnt(4)
v_add_f32 v216, v216, v168
v_add_f32 v217, v217, v169
v_add_f32 v218, v218, v170
v_add_f32 v219, v219, v171
s_waitcnt lgkmcnt(3)
v_add_f32 v220, v220, v172
v_add_f32 v221, v221, v173
v_add_f32 v222, v222, v174
v_add_f32 v223, v223, v175
s_waitcnt lgkmcnt(2)
v_add_f32 v224, v224, v176
v_add_f32 v225, v225, v177
v_add_f32 v226, v226, v178
v_add_f32 v227, v227, v179
s_waitcnt lgkmcnt(1)
v_add_f32 v228, v228, v180
v_add_f32 v229, v229, v181
v_add_f32 v230, v230, v182
v_add_f32 v231, v231, v183
s_waitcnt lgkmcnt(0)
v_add_f32 v232, v232, v184
v_add_f32 v233, v233, v185
v_add_f32 v234, v234, v186
v_add_f32 v235, v235, v187
s_mov_b32 s29, 0x3ea52b5c
v_mul_f32 v216, s29, v216
v_mul_f32 v217, s29, v217
v_mul_f32 v218, s29, v218
v_mul_f32 v219, s29, v219
v_mul_f32 v220, s29, v220
v_mul_f32 v221, s29, v221
v_mul_f32 v222, s29, v222
v_mul_f32 v223, s29, v223
v_mul_f32 v224, s29, v224
v_mul_f32 v225, s29, v225
v_mul_f32 v226, s29, v226
v_mul_f32 v227, s29, v227
v_mul_f32 v228, s29, v228
v_mul_f32 v229, s29, v229
v_mul_f32 v230, s29, v230
v_mul_f32 v231, s29, v231
v_mul_f32 v232, s29, v232
v_mul_f32 v233, s29, v233
v_mul_f32 v234, s29, v234
v_mul_f32 v235, s29, v235
v_cvt_pk_bf16_f32 v168, v216, v217
v_cvt_pk_bf16_f32 v169, v218, v219
ds_write_b64 v236, v[168:169]
v_cvt_pk_bf16_f32 v170, v220, v221
v_cvt_pk_bf16_f32 v171, v222, v223
ds_write_b64 v237, v[170:171]
v_cvt_pk_bf16_f32 v172, v224, v225
v_cvt_pk_bf16_f32 v173, v226, v227
ds_write_b64 v238, v[172:173]
v_cvt_pk_bf16_f32 v174, v228, v229
v_cvt_pk_bf16_f32 v175, v230, v231
ds_write_b64 v239, v[174:175]
v_cvt_pk_bf16_f32 v176, v232, v233
v_cvt_pk_bf16_f32 v177, v234, v235
ds_write_b64 v240, v[176:177]
s_and_b32 s28, s3, 3
s_mul_i32 s28, s28, 5120
s_add_u32 s28, s28, 122880
v_and_b32 v5, 31, v1
v_lshlrev_b32 v217, 3, v5
v_add_u32 v216, s28, v2
s_add_u32 s29, s28, 1024
v_add_u32 v3, s29, v217
v_lshrrev_b32 v6, 5, v1
v_mul_u32_u24 v6, 320, v6
v_lshl_add_u32 v4, v5, 4, v6
s_add_u32 s29, s28, 1280
v_add_u32 v4, s29, v4
v_cmp_eq_u32 vcc, 20, v5
v_mov_b32 v6, 143376
v_mov_b32 v7, 143360
v_cndmask_b32 v6, v6, v7, vcc
v_cmp_gt_u32 vcc, 20, v5
s_nop 1
v_cndmask_b32 v4, v6, v4, vcc
v_cndmask_b32 v218, 0, 1, vcc
s_mov_b32 s36, 20480
s_mov_b32 s26, 4294844416
s_cmp_lt_u32 s3, 4
s_cselect_b32 s34, 0x20, -1
s_waitcnt lgkmcnt(0)
Lqe_47:
s_mov_b32 s37, 0
s_cmp_lt_u32 s3, 4
s_cbranch_scc1 Lk2_go
s_setprio 1
Lk2_go:
s_barrier
v_lshrrev_b32 v5, 2, v0
v_and_b32 v5, 64, v5
v_lshlrev_b32 v6, 6, v5
v_add_u32 v6, v6, v2
v_lshlrev_b32 v7, 4, v5
v_lshl_add_u32 v7, v1, 3, v7
v_add_u32 v6, 149504, v6
v_add_u32 v7, 157696, v7
ds_read_b128 v[8:11], v6 offset:0
ds_read_b128 v[12:15], v6 offset:1024
ds_read_b128 v[16:19], v6 offset:2048
ds_read_b128 v[20:23], v6 offset:3072
ds_read_b64 v[24:25], v7 offset:0
ds_read_b64 v[26:27], v7 offset:512
ds_read_b128 v[28:31], v216 offset:0
ds_read_b64 v[32:33], v3 offset:0
ds_read_b128 v[36:39], v4 offset:0
ds_read_b128 v[40:43], v4 offset:640
s_lshr_b32 s28, s20, 1
s_lshl_b32 s28, s28, 6
s_add_u32 s28, s28, 24805632
v_and_b32 v5, 15, v1
v_lshlrev_b32 v5, 2, v5
buffer_load_dword v204, v5, s[8:11], s28 offen sc1
s_waitcnt lgkmcnt(0)
v_mfma_f32_32x32x16_bf16 v[140:155], v[28:31], v[8:11], 0
v_mfma_f32_32x32x16_bf16 v[156:171], v[28:31], v[12:15], 0
s_bitcmp0_b32 s3, 0
s_cbranch_scc1 Lnokvrest_52
s_add_u32 m0, s32, 0
s_nop 0
buffer_load_dwordx4 v2, s[8:11], s33 offen sc1 lds
buffer_load_dwordx4 v2, s[8:11], s33 offen offset:1024 sc1 lds
buffer_load_dwordx4 v2, s[8:11], s33 offen offset:2048 sc1 lds
buffer_load_dwordx4 v2, s[8:11], s33 offen offset:3072 sc1 lds
s_add_u32 s28, s33, 4096
s_add_u32 m0, s32, 4096
s_nop 0
buffer_load_dwordx4 v2, s[8:11], s28 offen sc1 lds
s_add_u32 s33, s33, 20480
s_add_u32 m0, s32, 20480
s_nop 0
buffer_load_dwordx4 v2, s[8:11], s33 offen sc1 lds
buffer_load_dwordx4 v2, s[8:11], s33 offen offset:1024 sc1 lds
buffer_load_dwordx4 v2, s[8:11], s33 offen offset:2048 sc1 lds
buffer_load_dwordx4 v2, s[8:11], s33 offen offset:3072 sc1 lds
s_add_u32 s28, s33, 4096
s_add_u32 m0, s32, 24576
s_nop 0
buffer_load_dwordx4 v2, s[8:11], s28 offen sc1 lds
s_add_u32 s33, s33, 20480
s_add_u32 m0, s32, 40960
s_nop 0
buffer_load_dwordx4 v2, s[8:11], s33 offen sc1 lds
buffer_load_dwordx4 v2, s[8:11], s33 offen offset:1024 sc1 lds
buffer_load_dwordx4 v2, s[8:11], s33 offen offset:2048 sc1 lds
buffer_load_dwordx4 v2, s[8:11], s33 offen offset:3072 sc1 lds
s_add_u32 s28, s33, 4096
s_add_u32 m0, s32, 45056
s_nop 0
buffer_load_dwordx4 v2, s[8:11], s28 offen sc1 lds
s_add_u32 s33, s33, 20480
Lnokvrest_52:
s_nop 7
v_mfma_f32_32x32x4bf16_1k v[140:171], v[32:33], v[24:25], v[140:171]
s_mov_b32 s35, 0
v_mfma_f32_32x32x16_bf16 v[172:187], v[28:31], v[16:19], 0
s_nop 15
s_nop 1
v_exp_f32 v140, v140
v_exp_f32 v141, v141
v_exp_f32 v142, v142
v_cvt_pk_bf16_f32 v60, v140, v141
v_exp_f32 v143, v143
v_exp_f32 v144, v144
v_cvt_pk_bf16_f32 v61, v142, v143
v_exp_f32 v145, v145
v_exp_f32 v146, v146
v_cvt_pk_bf16_f32 v62, v144, v145
v_exp_f32 v147, v147
v_mfma_f32_32x32x16_bf16 v[188:203], v[28:31], v[20:23], 0
v_exp_f32 v148, v148
v_cvt_pk_bf16_f32 v63, v146, v147
v_exp_f32 v149, v149
v_exp_f32 v150, v150
v_cvt_pk_bf16_f32 v64, v148, v149
v_mfma_f32_32x32x16_bf16 v[76:91], v[36:39], v[60:63], 0
v_exp_f32 v151, v151
v_exp_f32 v152, v152
v_cvt_pk_bf16_f32 v65, v150, v151
v_exp_f32 v153, v153
v_exp_f32 v154, v154
v_mfma_f32_32x32x4bf16_1k v[172:203], v[32:33], v[26:27], v[172:203]
ds_read_b128 v[28:31], v216 offset:2560
ds_read_b64 v[32:33], v3 offset:2560
v_cvt_pk_bf16_f32 v66, v152, v153
v_exp_f32 v155, v155
v_exp_f32 v156, v156
v_cvt_pk_bf16_f32 v67, v154, v155
v_exp_f32 v157, v157
v_exp_f32 v158, v158
v_cvt_pk_bf16_f32 v60, v156, v157
v_exp_f32 v159, v159
v_exp_f32 v160, v160
v_cvt_pk_bf16_f32 v61, v158, v159
v_mfma_f32_32x32x16_bf16 v[76:91], v[40:43], v[64:67], v[76:91]
v_exp_f32 v161, v161
v_exp_f32 v162, v162
v_cvt_pk_bf16_f32 v62, v160, v161
v_exp_f32 v163, v163
v_exp_f32 v164, v164
v_cvt_pk_bf16_f32 v63, v162, v163
v_exp_f32 v165, v165
v_exp_f32 v166, v166
v_cvt_pk_bf16_f32 v64, v164, v165
v_mfma_f32_32x32x16_bf16 v[92:107], v[36:39], v[60:63], 0
v_exp_f32 v167, v167
v_exp_f32 v168, v168
v_cvt_pk_bf16_f32 v65, v166, v167
v_exp_f32 v169, v169
v_exp_f32 v170, v170
v_cvt_pk_bf16_f32 v66, v168, v169
v_exp_f32 v171, v171
s_waitcnt lgkmcnt(0)
v_mfma_f32_32x32x16_bf16 v[140:155], v[28:31], v[8:11], 0
v_exp_f32 v172, v172
v_cvt_pk_bf16_f32 v67, v170, v171
v_exp_f32 v173, v173
v_exp_f32 v174, v174
v_cvt_pk_bf16_f32 v60, v172, v173
v_exp_f32 v175, v175
v_mfma_f32_32x32x16_bf16 v[92:107], v[40:43], v[64:67], v[92:107]
v_exp_f32 v176, v176
v_cvt_pk_bf16_f32 v61, v174, v175
v_exp_f32 v177, v177
v_exp_f32 v178, v178
v_cvt_pk_bf16_f32 v62, v176, v177
v_mfma_f32_32x32x16_bf16 v[156:171], v[28:31], v[12:15], 0
v_exp_f32 v179, v179
v_exp_f32 v180, v180
v_cvt_pk_bf16_f32 v63, v178, v179
v_exp_f32 v181, v181
v_exp_f32 v182, v182
v_mfma_f32_32x32x16_bf16 v[108:123], v[36:39], v[60:63], 0
v_cvt_pk_bf16_f32 v64, v180, v181
v_exp_f32 v183, v183
v_exp_f32 v184, v184
v_cvt_pk_bf16_f32 v65, v182, v183
v_exp_f32 v185, v185
v_mfma_f32_32x32x4bf16_1k v[140:171], v[32:33], v[24:25], v[140:171]
v_exp_f32 v186, v186
v_cvt_pk_bf16_f32 v66, v184, v185
v_exp_f32 v187, v187
v_exp_f32 v188, v188
v_cvt_pk_bf16_f32 v67, v186, v187
v_exp_f32 v189, v189
v_exp_f32 v190, v190
v_cvt_pk_bf16_f32 v60, v188, v189
v_exp_f32 v191, v191
v_exp_f32 v192, v192
v_mfma_f32_32x32x16_bf16 v[108:123], v[40:43], v[64:67], v[108:123]
v_cvt_pk_bf16_f32 v61, v190, v191
v_exp_f32 v193, v193
v_exp_f32 v194, v194
v_cvt_pk_bf16_f32 v62, v192, v193
v_exp_f32 v195, v195
v_exp_f32 v196, v196
v_cvt_pk_bf16_f32 v63, v194, v195
v_exp_f32 v197, v197
v_exp_f32 v198, v198
v_mfma_f32_32x32x16_bf16 v[124:139], v[36:39], v[60:63], 0
ds_read_b128 v[36:39], v4 offset:2560
v_cvt_pk_bf16_f32 v64, v196, v197
v_exp_f32 v199, v199
v_exp_f32 v200, v200
v_cvt_pk_bf16_f32 v65, v198, v199
v_exp_f32 v201, v201
v_exp_f32 v202, v202
v_cvt_pk_bf16_f32 v66, v200, v201
v_exp_f32 v203, v203
s_cmp_ge_u32 s3, 4
v_mfma_f32_32x32x16_bf16 v[172:187], v[28:31], v[16:19], 0
v_exp_f32 v140, v140
v_cvt_pk_bf16_f32 v67, v202, v203
v_exp_f32 v141, v141
v_exp_f32 v142, v142
v_cvt_pk_bf16_f32 v60, v140, v141
v_exp_f32 v143, v143
v_mfma_f32_32x32x16_bf16 v[124:139], v[40:43], v[64:67], v[124:139]
ds_read_b128 v[40:43], v4 offset:3200
v_exp_f32 v144, v144
v_cvt_pk_bf16_f32 v61, v142, v143
v_exp_f32 v145, v145
v_exp_f32 v146, v146
v_cvt_pk_bf16_f32 v62, v144, v145
v_mfma_f32_32x32x16_bf16 v[188:203], v[28:31], v[20:23], 0
v_exp_f32 v147, v147
v_exp_f32 v148, v148
v_cvt_pk_bf16_f32 v63, v146, v147
v_exp_f32 v149, v149
v_exp_f32 v150, v150
s_waitcnt lgkmcnt(0)
v_mfma_f32_32x32x16_bf16 v[76:91], v[36:39], v[60:63], v[76:91]
v_cvt_pk_bf16_f32 v64, v148, v149
v_exp_f32 v151, v151
v_exp_f32 v152, v152
v_cvt_pk_bf16_f32 v65, v150, v151
v_exp_f32 v153, v153
v_mfma_f32_32x32x4bf16_1k v[172:203], v[32:33], v[26:27], v[172:203]
s_cbranch_scc1 Lk2_blk0
s_waitcnt vmcnt(0) lgkmcnt(0)
s_barrier
Lk2_ret0:
s_mov_b32 s39, 4294844416
v_add_u32 v216, s39, v216
v_add_u32 v3, s39, v3
v_mad_i32_i24 v4, v218, s39, v4
ds_read_b128 v[28:31], v216 offset:0
ds_read_b64 v[32:33], v3 offset:0
v_exp_f32 v154, v154
v_cvt_pk_bf16_f32 v66, v152, v153
v_exp_f32 v155, v155
v_exp_f32 v156, v156
v_cvt_pk_bf16_f32 v67, v154, v155
v_exp_f32 v157, v157
v_exp_f32 v158, v158
v_cvt_pk_bf16_f32 v60, v156, v157
v_exp_f32 v159, v159
v_exp_f32 v160, v160
v_mfma_f32_32x32x16_bf16 v[76:91], v[40:43], v[64:67], v[76:91]
v_cvt_pk_bf16_f32 v61, v158, v159
v_exp_f32 v161, v161
v_exp_f32 v162, v162
v_cvt_pk_bf16_f32 v62, v160, v161
v_exp_f32 v163, v163
v_exp_f32 v164, v164
v_cvt_pk_bf16_f32 v63, v162, v163
v_exp_f32 v165, v165
v_exp_f32 v166, v166
v_mfma_f32_32x32x16_bf16 v[92:107], v[36:39], v[60:63], v[92:107]
v_cvt_pk_bf16_f32 v64, v164, v165
v_exp_f32 v167, v167
v_exp_f32 v168, v168
v_cvt_pk_bf16_f32 v65, v166, v167
v_exp_f32 v169, v169
v_exp_f32 v170, v170
v_cvt_pk_bf16_f32 v66, v168, v169
v_exp_f32 v171, v171
s_waitcnt lgkmcnt(0)
v_mfma_f32_32x32x16_bf16 v[140:155], v[28:31], v[8:11], 0
v_exp_f32 v172, v172
v_cvt_pk_bf16_f32 v67, v170, v171
v_exp_f32 v173, v173
v_exp_f32 v174, v174
v_cvt_pk_bf16_f32 v60, v172, v173
v_exp_f32 v175, v175
v_mfma_f32_32x32x16_bf16 v[92:107], v[40:43], v[64:67], v[92:107]
v_exp_f32 v176, v176
v_cvt_pk_bf16_f32 v61, v174, v175
v_exp_f32 v177, v177
v_exp_f32 v178, v178
v_cvt_pk_bf16_f32 v62, v176, v177
v_mfma_f32_32x32x16_bf16 v[156:171], v[28:31], v[12:15], 0
v_exp_f32 v179, v179
v_exp_f32 v180, v180
v_cvt_pk_bf16_f32 v63, v178, v179
v_exp_f32 v181, v181
v_exp_f32 v182, v182
v_mfma_f32_32x32x16_bf16 v[108:123], v[36:39], v[60:63], v[108:123]
v_cvt_pk_bf16_f32 v64, v180, v181
v_exp_f32 v183, v183
v_exp_f32 v184, v184
v_cvt_pk_bf16_f32 v65, v182, v183
v_exp_f32 v185, v185
v_mfma_f32_32x32x4bf16_1k v[140:171], v[32:33], v[24:25], v[140:171]
v_exp_f32 v186, v186
v_cvt_pk_bf16_f32 v66, v184, v185
v_exp_f32 v187, v187
v_exp_f32 v188, v188
v_cvt_pk_bf16_f32 v67, v186, v187
v_exp_f32 v189, v189
v_exp_f32 v190, v190
v_cvt_pk_bf16_f32 v60, v188, v189
v_exp_f32 v191, v191
v_exp_f32 v192, v192
v_mfma_f32_32x32x16_bf16 v[108:123], v[40:43], v[64:67], v[108:123]
v_cvt_pk_bf16_f32 v61, v190, v191
v_exp_f32 v193, v193
v_exp_f32 v194, v194
v_cvt_pk_bf16_f32 v62, v192, v193
v_exp_f32 v195, v195
v_exp_f32 v196, v196
v_cvt_pk_bf16_f32 v63, v194, v195
v_exp_f32 v197, v197
v_exp_f32 v198, v198
v_mfma_f32_32x32x16_bf16 v[124:139], v[36:39], v[60:63], v[124:139]
ds_read_b128 v[36:39], v4 offset:0
v_cvt_pk_bf16_f32 v64, v196, v197
v_exp_f32 v199, v199
v_exp_f32 v200, v200
v_cvt_pk_bf16_f32 v65, v198, v199
v_exp_f32 v201, v201
v_exp_f32 v202, v202
v_cvt_pk_bf16_f32 v66, v200, v201
v_exp_f32 v203, v203
v_mfma_f32_32x32x16_bf16 v[172:187], v[28:31], v[16:19], 0
v_exp_f32 v140, v140
v_cvt_pk_bf16_f32 v67, v202, v203
v_exp_f32 v141, v141
v_exp_f32 v142, v142
v_cvt_pk_bf16_f32 v60, v140, v141
v_exp_f32 v143, v143
v_mfma_f32_32x32x16_bf16 v[124:139], v[40:43], v[64:67], v[124:139]
ds_read_b128 v[40:43], v4 offset:640
v_exp_f32 v144, v144
v_cvt_pk_bf16_f32 v61, v142, v143
v_exp_f32 v145, v145
v_exp_f32 v146, v146
v_cvt_pk_bf16_f32 v62, v144, v145
v_mfma_f32_32x32x16_bf16 v[188:203], v[28:31], v[20:23], 0
v_exp_f32 v147, v147
v_exp_f32 v148, v148
v_cvt_pk_bf16_f32 v63, v146, v147
v_exp_f32 v149, v149
v_exp_f32 v150, v150
s_waitcnt lgkmcnt(0)
v_mfma_f32_32x32x16_bf16 v[76:91], v[36:39], v[60:63], v[76:91]
v_cvt_pk_bf16_f32 v64, v148, v149
v_exp_f32 v151, v151
v_exp_f32 v152, v152
v_cvt_pk_bf16_f32 v65, v150, v151
v_exp_f32 v153, v153
v_mfma_f32_32x32x4bf16_1k v[172:203], v[32:33], v[26:27], v[172:203]
ds_read_b128 v[28:31], v216 offset:2560
ds_read_b64 v[32:33], v3 offset:2560
v_exp_f32 v154, v154
v_cvt_pk_bf16_f32 v66, v152, v153
v_exp_f32 v155, v155
v_exp_f32 v156, v156
v_cvt_pk_bf16_f32 v67, v154, v155
v_exp_f32 v157, v157
v_exp_f32 v158, v158
v_cvt_pk_bf16_f32 v60, v156, v157
v_exp_f32 v159, v159
v_exp_f32 v160, v160
v_mfma_f32_32x32x16_bf16 v[76:91], v[40:43], v[64:67], v[76:91]
v_cvt_pk_bf16_f32 v61, v158, v159
v_exp_f32 v161, v161
v_exp_f32 v162, v162
v_cvt_pk_bf16_f32 v62, v160, v161
v_exp_f32 v163, v163
v_exp_f32 v164, v164
v_cvt_pk_bf16_f32 v63, v162, v163
v_exp_f32 v165, v165
v_exp_f32 v166, v166
v_mfma_f32_32x32x16_bf16 v[92:107], v[36:39], v[60:63], v[92:107]
v_cvt_pk_bf16_f32 v64, v164, v165
v_exp_f32 v167, v167
v_exp_f32 v168, v168
v_cvt_pk_bf16_f32 v65, v166, v167
v_exp_f32 v169, v169
v_exp_f32 v170, v170
v_cvt_pk_bf16_f32 v66, v168, v169
v_exp_f32 v171, v171
s_waitcnt lgkmcnt(0)
v_mfma_f32_32x32x16_bf16 v[140:155], v[28:31], v[8:11], 0
v_exp_f32 v172, v172
v_cvt_pk_bf16_f32 v67, v170, v171
v_exp_f32 v173, v173
v_exp_f32 v174, v174
v_cvt_pk_bf16_f32 v60, v172, v173
v_exp_f32 v175, v175
v_mfma_f32_32x32x16_bf16 v[92:107], v[40:43], v[64:67], v[92:107]
v_exp_f32 v176, v176
v_cvt_pk_bf16_f32 v61, v174, v175
v_exp_f32 v177, v177
v_exp_f32 v178, v178
v_cvt_pk_bf16_f32 v62, v176, v177
v_mfma_f32_32x32x16_bf16 v[156:171], v[28:31], v[12:15], 0
v_exp_f32 v179, v179
v_exp_f32 v180, v180
v_cvt_pk_bf16_f32 v63, v178, v179
v_exp_f32 v181, v181
v_exp_f32 v182, v182
v_mfma_f32_32x32x16_bf16 v[108:123], v[36:39], v[60:63], v[108:123]
v_cvt_pk_bf16_f32 v64, v180, v181
v_exp_f32 v183, v183
v_exp_f32 v184, v184
v_cvt_pk_bf16_f32 v65, v182, v183
v_exp_f32 v185, v185
v_mfma_f32_32x32x4bf16_1k v[140:171], v[32:33], v[24:25], v[140:171]
v_exp_f32 v186, v186
v_cvt_pk_bf16_f32 v66, v184, v185
v_exp_f32 v187, v187
v_exp_f32 v188, v188
v_cvt_pk_bf16_f32 v67, v186, v187
v_exp_f32 v189, v189
v_exp_f32 v190, v190
v_cvt_pk_bf16_f32 v60, v188, v189
v_exp_f32 v191, v191
v_exp_f32 v192, v192
v_mfma_f32_32x32x16_bf16 v[108:123], v[40:43], v[64:67], v[108:123]
v_cvt_pk_bf16_f32 v61, v190, v191
v_exp_f32 v193, v193
v_exp_f32 v194, v194
v_cvt_pk_bf16_f32 v62, v192, v193
v_exp_f32 v195, v195
v_exp_f32 v196, v196
v_cvt_pk_bf16_f32 v63, v194, v195
v_exp_f32 v197, v197
v_exp_f32 v198, v198
v_mfma_f32_32x32x16_bf16 v[124:139], v[36:39], v[60:63], v[124:139]
ds_read_b128 v[36:39], v4 offset:2560
v_cvt_pk_bf16_f32 v64, v196, v197
v_exp_f32 v199, v199
v_exp_f32 v200, v200
v_cvt_pk_bf16_f32 v65, v198, v199
v_exp_f32 v201, v201
v_exp_f32 v202, v202
v_cvt_pk_bf16_f32 v66, v200, v201
v_exp_f32 v203, v203
s_cmp_ge_u32 s3, 4
v_mfma_f32_32x32x16_bf16 v[172:187], v[28:31], v[16:19], 0
v_exp_f32 v140, v140
v_cvt_pk_bf16_f32 v67, v202, v203
v_exp_f32 v141, v141
v_exp_f32 v142, v142
v_cvt_pk_bf16_f32 v60, v140, v141
v_exp_f32 v143, v143
v_mfma_f32_32x32x16_bf16 v[124:139], v[40:43], v[64:67], v[124:139]
ds_read_b128 v[40:43], v4 offset:3200
v_exp_f32 v144, v144
v_cvt_pk_bf16_f32 v61, v142, v143
v_exp_f32 v145, v145
v_exp_f32 v146, v146
v_cvt_pk_bf16_f32 v62, v144, v145
v_mfma_f32_32x32x16_bf16 v[188:203], v[28:31], v[20:23], 0
v_exp_f32 v147, v147
v_exp_f32 v148, v148
v_cvt_pk_bf16_f32 v63, v146, v147
v_exp_f32 v149, v149
v_exp_f32 v150, v150
s_waitcnt lgkmcnt(0)
v_mfma_f32_32x32x16_bf16 v[76:91], v[36:39], v[60:63], v[76:91]
v_cvt_pk_bf16_f32 v64, v148, v149
v_exp_f32 v151, v151
v_exp_f32 v152, v152
v_cvt_pk_bf16_f32 v65, v150, v151
v_exp_f32 v153, v153
v_mfma_f32_32x32x4bf16_1k v[172:203], v[32:33], v[26:27], v[172:203]
s_cbranch_scc1 Lk2_blk1
s_waitcnt lgkmcnt(0)
s_barrier
Lk2_ret1:
s_mov_b32 s39, 20480
v_add_u32 v216, s39, v216
v_add_u32 v3, s39, v3
v_mad_i32_i24 v4, v218, s39, v4
ds_read_b128 v[28:31], v216 offset:0
ds_read_b64 v[32:33], v3 offset:0
v_exp_f32 v154, v154
v_cvt_pk_bf16_f32 v66, v152, v153
v_exp_f32 v155, v155
v_exp_f32 v156, v156
v_cvt_pk_bf16_f32 v67, v154, v155
v_exp_f32 v157, v157
v_exp_f32 v158, v158
v_cvt_pk_bf16_f32 v60, v156, v157
v_exp_f32 v159, v159
v_exp_f32 v160, v160
v_mfma_f32_32x32x16_bf16 v[76:91], v[40:43], v[64:67], v[76:91]
v_cvt_pk_bf16_f32 v61, v158, v159
v_exp_f32 v161, v161
v_exp_f32 v162, v162
v_cvt_pk_bf16_f32 v62, v160, v161
v_exp_f32 v163, v163
v_exp_f32 v164, v164
v_cvt_pk_bf16_f32 v63, v162, v163
v_exp_f32 v165, v165
v_exp_f32 v166, v166
v_mfma_f32_32x32x16_bf16 v[92:107], v[36:39], v[60:63], v[92:107]
v_cvt_pk_bf16_f32 v64, v164, v165
v_exp_f32 v167, v167
v_exp_f32 v168, v168
v_cvt_pk_bf16_f32 v65, v166, v167
v_exp_f32 v169, v169
v_exp_f32 v170, v170
v_cvt_pk_bf16_f32 v66, v168, v169
v_exp_f32 v171, v171
s_waitcnt lgkmcnt(0)
v_mfma_f32_32x32x16_bf16 v[140:155], v[28:31], v[8:11], 0
v_exp_f32 v172, v172
v_cvt_pk_bf16_f32 v67, v170, v171
v_exp_f32 v173, v173
v_exp_f32 v174, v174
v_cvt_pk_bf16_f32 v60, v172, v173
v_exp_f32 v175, v175
v_mfma_f32_32x32x16_bf16 v[92:107], v[40:43], v[64:67], v[92:107]
v_exp_f32 v176, v176
v_cvt_pk_bf16_f32 v61, v174, v175
v_exp_f32 v177, v177
v_exp_f32 v178, v178
v_cvt_pk_bf16_f32 v62, v176, v177
v_mfma_f32_32x32x16_bf16 v[156:171], v[28:31], v[12:15], 0
v_exp_f32 v179, v179
v_exp_f32 v180, v180
v_cvt_pk_bf16_f32 v63, v178, v179
v_exp_f32 v181, v181
v_exp_f32 v182, v182
v_mfma_f32_32x32x16_bf16 v[108:123], v[36:39], v[60:63], v[108:123]
v_cvt_pk_bf16_f32 v64, v180, v181
v_exp_f32 v183, v183
v_exp_f32 v184, v184
v_cvt_pk_bf16_f32 v65, v182, v183
v_exp_f32 v185, v185
v_mfma_f32_32x32x4bf16_1k v[140:171], v[32:33], v[24:25], v[140:171]
v_exp_f32 v186, v186
v_cvt_pk_bf16_f32 v66, v184, v185
v_exp_f32 v187, v187
v_exp_f32 v188, v188
v_cvt_pk_bf16_f32 v67, v186, v187
v_exp_f32 v189, v189
v_exp_f32 v190, v190
v_cvt_pk_bf16_f32 v60, v188, v189
v_exp_f32 v191, v191
v_exp_f32 v192, v192
v_mfma_f32_32x32x16_bf16 v[108:123], v[40:43], v[64:67], v[108:123]
v_cvt_pk_bf16_f32 v61, v190, v191
v_exp_f32 v193, v193
v_exp_f32 v194, v194
v_cvt_pk_bf16_f32 v62, v192, v193
v_exp_f32 v195, v195
v_exp_f32 v196, v196
v_cvt_pk_bf16_f32 v63, v194, v195
v_exp_f32 v197, v197
v_exp_f32 v198, v198
v_mfma_f32_32x32x16_bf16 v[124:139], v[36:39], v[60:63], v[124:139]
ds_read_b128 v[36:39], v4 offset:0
v_cvt_pk_bf16_f32 v64, v196, v197
v_exp_f32 v199, v199
v_exp_f32 v200, v200
v_cvt_pk_bf16_f32 v65, v198, v199
v_exp_f32 v201, v201
v_exp_f32 v202, v202
v_cvt_pk_bf16_f32 v66, v200, v201
v_exp_f32 v203, v203
v_mfma_f32_32x32x16_bf16 v[172:187], v[28:31], v[16:19], 0
v_exp_f32 v140, v140
v_cvt_pk_bf16_f32 v67, v202, v203
v_exp_f32 v141, v141
v_exp_f32 v142, v142
v_cvt_pk_bf16_f32 v60, v140, v141
v_exp_f32 v143, v143
v_mfma_f32_32x32x16_bf16 v[124:139], v[40:43], v[64:67], v[124:139]
ds_read_b128 v[40:43], v4 offset:640
v_exp_f32 v144, v144
v_cvt_pk_bf16_f32 v61, v142, v143
v_exp_f32 v145, v145
v_exp_f32 v146, v146
v_cvt_pk_bf16_f32 v62, v144, v145
v_mfma_f32_32x32x16_bf16 v[188:203], v[28:31], v[20:23], 0
v_exp_f32 v147, v147
v_exp_f32 v148, v148
v_cvt_pk_bf16_f32 v63, v146, v147
v_exp_f32 v149, v149
v_exp_f32 v150, v150
s_waitcnt lgkmcnt(0)
v_mfma_f32_32x32x16_bf16 v[76:91], v[36:39], v[60:63], v[76:91]
v_cvt_pk_bf16_f32 v64, v148, v149
v_exp_f32 v151, v151
v_exp_f32 v152, v152
v_cvt_pk_bf16_f32 v65, v150, v151
v_exp_f32 v153, v153
v_mfma_f32_32x32x4bf16_1k v[172:203], v[32:33], v[26:27], v[172:203]
ds_read_b128 v[28:31], v216 offset:2560
ds_read_b64 v[32:33], v3 offset:2560
v_exp_f32 v154, v154
v_cvt_pk_bf16_f32 v66, v152, v153
v_exp_f32 v155, v155
v_exp_f32 v156, v156
v_cvt_pk_bf16_f32 v67, v154, v155
v_exp_f32 v157, v157
v_exp_f32 v158, v158
v_cvt_pk_bf16_f32 v60, v156, v157
v_exp_f32 v159, v159
v_exp_f32 v160, v160
v_mfma_f32_32x32x16_bf16 v[76:91], v[40:43], v[64:67], v[76:91]
v_cvt_pk_bf16_f32 v61, v158, v159
v_exp_f32 v161, v161
v_exp_f32 v162, v162
v_cvt_pk_bf16_f32 v62, v160, v161
v_exp_f32 v163, v163
v_exp_f32 v164, v164
v_cvt_pk_bf16_f32 v63, v162, v163
v_exp_f32 v165, v165
v_exp_f32 v166, v166
v_mfma_f32_32x32x16_bf16 v[92:107], v[36:39], v[60:63], v[92:107]
v_cvt_pk_bf16_f32 v64, v164, v165
v_exp_f32 v167, v167
v_exp_f32 v168, v168
v_cvt_pk_bf16_f32 v65, v166, v167
v_exp_f32 v169, v169
v_exp_f32 v170, v170
v_cvt_pk_bf16_f32 v66, v168, v169
v_exp_f32 v171, v171
s_waitcnt lgkmcnt(0)
v_mfma_f32_32x32x16_bf16 v[140:155], v[28:31], v[8:11], 0
v_exp_f32 v172, v172
v_cvt_pk_bf16_f32 v67, v170, v171
v_exp_f32 v173, v173
v_exp_f32 v174, v174
v_cvt_pk_bf16_f32 v60, v172, v173
v_exp_f32 v175, v175
v_mfma_f32_32x32x16_bf16 v[92:107], v[40:43], v[64:67], v[92:107]
v_exp_f32 v176, v176
v_cvt_pk_bf16_f32 v61, v174, v175
v_exp_f32 v177, v177
v_exp_f32 v178, v178
v_cvt_pk_bf16_f32 v62, v176, v177
v_mfma_f32_32x32x16_bf16 v[156:171], v[28:31], v[12:15], 0
v_exp_f32 v179, v179
v_exp_f32 v180, v180
v_cvt_pk_bf16_f32 v63, v178, v179
v_exp_f32 v181, v181
v_exp_f32 v182, v182
v_mfma_f32_32x32x16_bf16 v[108:123], v[36:39], v[60:63], v[108:123]
v_cvt_pk_bf16_f32 v64, v180, v181
v_exp_f32 v183, v183
v_exp_f32 v184, v184
v_cvt_pk_bf16_f32 v65, v182, v183
v_exp_f32 v185, v185
v_mfma_f32_32x32x4bf16_1k v[140:171], v[32:33], v[24:25], v[140:171]
v_exp_f32 v186, v186
v_cvt_pk_bf16_f32 v66, v184, v185
v_exp_f32 v187, v187
v_exp_f32 v188, v188
v_cvt_pk_bf16_f32 v67, v186, v187
v_exp_f32 v189, v189
v_exp_f32 v190, v190
v_cvt_pk_bf16_f32 v60, v188, v189
v_exp_f32 v191, v191
v_exp_f32 v192, v192
v_mfma_f32_32x32x16_bf16 v[108:123], v[40:43], v[64:67], v[108:123]
v_cvt_pk_bf16_f32 v61, v190, v191
v_exp_f32 v193, v193
v_exp_f32 v194, v194
v_cvt_pk_bf16_f32 v62, v192, v193
v_exp_f32 v195, v195
v_exp_f32 v196, v196
v_cvt_pk_bf16_f32 v63, v194, v195
v_exp_f32 v197, v197
v_exp_f32 v198, v198
v_mfma_f32_32x32x16_bf16 v[124:139], v[36:39], v[60:63], v[124:139]
ds_read_b128 v[36:39], v4 offset:2560
v_cvt_pk_bf16_f32 v64, v196, v197
v_exp_f32 v199, v199
v_exp_f32 v200, v200
v_cvt_pk_bf16_f32 v65, v198, v199
v_exp_f32 v201, v201
v_exp_f32 v202, v202
v_cvt_pk_bf16_f32 v66, v200, v201
v_exp_f32 v203, v203
s_cmp_ge_u32 s3, 4
v_mfma_f32_32x32x16_bf16 v[172:187], v[28:31], v[16:19], 0
v_exp_f32 v140, v140
v_cvt_pk_bf16_f32 v67, v202, v203
v_exp_f32 v141, v141
v_exp_f32 v142, v142
v_cvt_pk_bf16_f32 v60, v140, v141
v_exp_f32 v143, v143
v_mfma_f32_32x32x16_bf16 v[124:139], v[40:43], v[64:67], v[124:139]
ds_read_b128 v[40:43], v4 offset:3200
v_exp_f32 v144, v144
v_cvt_pk_bf16_f32 v61, v142, v143
v_exp_f32 v145, v145
v_exp_f32 v146, v146
v_cvt_pk_bf16_f32 v62, v144, v145
v_mfma_f32_32x32x16_bf16 v[188:203], v[28:31], v[20:23], 0
v_exp_f32 v147, v147
v_exp_f32 v148, v148
v_cvt_pk_bf16_f32 v63, v146, v147
v_exp_f32 v149, v149
v_exp_f32 v150, v150
s_waitcnt lgkmcnt(0)
v_mfma_f32_32x32x16_bf16 v[76:91], v[36:39], v[60:63], v[76:91]
v_cvt_pk_bf16_f32 v64, v148, v149
v_exp_f32 v151, v151
v_exp_f32 v152, v152
v_cvt_pk_bf16_f32 v65, v150, v151
v_exp_f32 v153, v153
v_mfma_f32_32x32x4bf16_1k v[172:203], v[32:33], v[26:27], v[172:203]
s_cbranch_scc1 Lk2_blk2
s_waitcnt lgkmcnt(0)
s_barrier
Lk2_ret2:
s_mov_b32 s39, 20480
v_add_u32 v216, s39, v216
v_add_u32 v3, s39, v3
v_mad_i32_i24 v4, v218, s39, v4
ds_read_b128 v[28:31], v216 offset:0
ds_read_b64 v[32:33], v3 offset:0
v_exp_f32 v154, v154
v_cvt_pk_bf16_f32 v66, v152, v153
v_exp_f32 v155, v155
v_exp_f32 v156, v156
v_cvt_pk_bf16_f32 v67, v154, v155
v_exp_f32 v157, v157
v_exp_f32 v158, v158
v_cvt_pk_bf16_f32 v60, v156, v157
v_exp_f32 v159, v159
v_exp_f32 v160, v160
v_mfma_f32_32x32x16_bf16 v[76:91], v[40:43], v[64:67], v[76:91]
v_cvt_pk_bf16_f32 v61, v158, v159
v_exp_f32 v161, v161
v_exp_f32 v162, v162
v_cvt_pk_bf16_f32 v62, v160, v161
v_exp_f32 v163, v163
v_exp_f32 v164, v164
v_cvt_pk_bf16_f32 v63, v162, v163
v_exp_f32 v165, v165
v_exp_f32 v166, v166
v_mfma_f32_32x32x16_bf16 v[92:107], v[36:39], v[60:63], v[92:107]
v_cvt_pk_bf16_f32 v64, v164, v165
v_exp_f32 v167, v167
v_exp_f32 v168, v168
v_cvt_pk_bf16_f32 v65, v166, v167
v_exp_f32 v169, v169
v_exp_f32 v170, v170
v_cvt_pk_bf16_f32 v66, v168, v169
v_exp_f32 v171, v171
s_waitcnt lgkmcnt(0)
v_mfma_f32_32x32x16_bf16 v[140:155], v[28:31], v[8:11], 0
v_exp_f32 v172, v172
v_cvt_pk_bf16_f32 v67, v170, v171
v_exp_f32 v173, v173
v_exp_f32 v174, v174
v_cvt_pk_bf16_f32 v60, v172, v173
v_exp_f32 v175, v175
v_mfma_f32_32x32x16_bf16 v[92:107], v[40:43], v[64:67], v[92:107]
v_exp_f32 v176, v176
v_cvt_pk_bf16_f32 v61, v174, v175
v_exp_f32 v177, v177
v_exp_f32 v178, v178
v_cvt_pk_bf16_f32 v62, v176, v177
v_mfma_f32_32x32x16_bf16 v[156:171], v[28:31], v[12:15], 0
v_exp_f32 v179, v179
v_exp_f32 v180, v180
v_cvt_pk_bf16_f32 v63, v178, v179
v_exp_f32 v181, v181
v_exp_f32 v182, v182
v_mfma_f32_32x32x16_bf16 v[108:123], v[36:39], v[60:63], v[108:123]
v_cvt_pk_bf16_f32 v64, v180, v181
v_exp_f32 v183, v183
v_exp_f32 v184, v184
v_cvt_pk_bf16_f32 v65, v182, v183
v_exp_f32 v185, v185
v_mfma_f32_32x32x4bf16_1k v[140:171], v[32:33], v[24:25], v[140:171]
v_exp_f32 v186, v186
v_cvt_pk_bf16_f32 v66, v184, v185
v_exp_f32 v187, v187
v_exp_f32 v188, v188
v_cvt_pk_bf16_f32 v67, v186, v187
v_exp_f32 v189, v189
v_exp_f32 v190, v190
v_cvt_pk_bf16_f32 v60, v188, v189
v_exp_f32 v191, v191
v_exp_f32 v192, v192
v_mfma_f32_32x32x16_bf16 v[108:123], v[40:43], v[64:67], v[108:123]
v_cvt_pk_bf16_f32 v61, v190, v191
v_exp_f32 v193, v193
v_exp_f32 v194, v194
v_cvt_pk_bf16_f32 v62, v192, v193
v_exp_f32 v195, v195
v_exp_f32 v196, v196
v_cvt_pk_bf16_f32 v63, v194, v195
v_exp_f32 v197, v197
v_exp_f32 v198, v198
v_mfma_f32_32x32x16_bf16 v[124:139], v[36:39], v[60:63], v[124:139]
ds_read_b128 v[36:39], v4 offset:0
v_cvt_pk_bf16_f32 v64, v196, v197
v_exp_f32 v199, v199
v_exp_f32 v200, v200
v_cvt_pk_bf16_f32 v65, v198, v199
v_exp_f32 v201, v201
v_exp_f32 v202, v202
v_cvt_pk_bf16_f32 v66, v200, v201
v_exp_f32 v203, v203
v_mfma_f32_32x32x16_bf16 v[172:187], v[28:31], v[16:19], 0
v_exp_f32 v140, v140
v_cvt_pk_bf16_f32 v67, v202, v203
v_exp_f32 v141, v141
v_exp_f32 v142, v142
v_cvt_pk_bf16_f32 v60, v140, v141
v_exp_f32 v143, v143
v_mfma_f32_32x32x16_bf16 v[124:139], v[40:43], v[64:67], v[124:139]
ds_read_b128 v[40:43], v4 offset:640
v_exp_f32 v144, v144
v_cvt_pk_bf16_f32 v61, v142, v143
v_exp_f32 v145, v145
v_exp_f32 v146, v146
v_cvt_pk_bf16_f32 v62, v144, v145
v_mfma_f32_32x32x16_bf16 v[188:203], v[28:31], v[20:23], 0
v_exp_f32 v147, v147
v_exp_f32 v148, v148
v_cvt_pk_bf16_f32 v63, v146, v147
v_exp_f32 v149, v149
v_exp_f32 v150, v150
s_waitcnt lgkmcnt(0)
v_mfma_f32_32x32x16_bf16 v[76:91], v[36:39], v[60:63], v[76:91]
v_cvt_pk_bf16_f32 v64, v148, v149
v_exp_f32 v151, v151
v_exp_f32 v152, v152
v_cvt_pk_bf16_f32 v65, v150, v151
v_exp_f32 v153, v153
v_mfma_f32_32x32x4bf16_1k v[172:203], v[32:33], v[26:27], v[172:203]
ds_read_b128 v[28:31], v216 offset:2560
ds_read_b64 v[32:33], v3 offset:2560
v_exp_f32 v154, v154
v_cvt_pk_bf16_f32 v66, v152, v153
v_exp_f32 v155, v155
v_exp_f32 v156, v156
v_cvt_pk_bf16_f32 v67, v154, v155
v_exp_f32 v157, v157
v_exp_f32 v158, v158
v_cvt_pk_bf16_f32 v60, v156, v157
v_exp_f32 v159, v159
v_exp_f32 v160, v160
v_mfma_f32_32x32x16_bf16 v[76:91], v[40:43], v[64:67], v[76:91]
v_cvt_pk_bf16_f32 v61, v158, v159
v_exp_f32 v161, v161
v_exp_f32 v162, v162
v_cvt_pk_bf16_f32 v62, v160, v161
v_exp_f32 v163, v163
v_exp_f32 v164, v164
v_cvt_pk_bf16_f32 v63, v162, v163
v_exp_f32 v165, v165
v_exp_f32 v166, v166
v_mfma_f32_32x32x16_bf16 v[92:107], v[36:39], v[60:63], v[92:107]
v_cvt_pk_bf16_f32 v64, v164, v165
v_exp_f32 v167, v167
v_exp_f32 v168, v168
v_cvt_pk_bf16_f32 v65, v166, v167
v_exp_f32 v169, v169
v_exp_f32 v170, v170
v_cvt_pk_bf16_f32 v66, v168, v169
v_exp_f32 v171, v171
s_waitcnt lgkmcnt(0)
v_mfma_f32_32x32x16_bf16 v[140:155], v[28:31], v[8:11], 0
v_exp_f32 v172, v172
v_cvt_pk_bf16_f32 v67, v170, v171
v_exp_f32 v173, v173
v_exp_f32 v174, v174
v_cvt_pk_bf16_f32 v60, v172, v173
v_exp_f32 v175, v175
v_mfma_f32_32x32x16_bf16 v[92:107], v[40:43], v[64:67], v[92:107]
v_exp_f32 v176, v176
v_cvt_pk_bf16_f32 v61, v174, v175
v_exp_f32 v177, v177
v_exp_f32 v178, v178
v_cvt_pk_bf16_f32 v62, v176, v177
v_mfma_f32_32x32x16_bf16 v[156:171], v[28:31], v[12:15], 0
v_exp_f32 v179, v179
v_exp_f32 v180, v180
v_cvt_pk_bf16_f32 v63, v178, v179
v_exp_f32 v181, v181
v_exp_f32 v182, v182
v_mfma_f32_32x32x16_bf16 v[108:123], v[36:39], v[60:63], v[108:123]
v_cvt_pk_bf16_f32 v64, v180, v181
v_exp_f32 v183, v183
v_exp_f32 v184, v184
v_cvt_pk_bf16_f32 v65, v182, v183
v_exp_f32 v185, v185
v_mfma_f32_32x32x4bf16_1k v[140:171], v[32:33], v[24:25], v[140:171]
v_exp_f32 v186, v186
v_cvt_pk_bf16_f32 v66, v184, v185
v_exp_f32 v187, v187
v_exp_f32 v188, v188
v_cvt_pk_bf16_f32 v67, v186, v187
v_exp_f32 v189, v189
v_exp_f32 v190, v190
v_cvt_pk_bf16_f32 v60, v188, v189
v_exp_f32 v191, v191
v_exp_f32 v192, v192
v_mfma_f32_32x32x16_bf16 v[108:123], v[40:43], v[64:67], v[108:123]
v_cvt_pk_bf16_f32 v61, v190, v191
v_exp_f32 v193, v193
v_exp_f32 v194, v194
v_cvt_pk_bf16_f32 v62, v192, v193
v_exp_f32 v195, v195
v_exp_f32 v196, v196
v_cvt_pk_bf16_f32 v63, v194, v195
v_exp_f32 v197, v197
v_exp_f32 v198, v198
v_mfma_f32_32x32x16_bf16 v[124:139], v[36:39], v[60:63], v[124:139]
ds_read_b128 v[36:39], v4 offset:2560
v_cvt_pk_bf16_f32 v64, v196, v197
v_exp_f32 v199, v199
v_exp_f32 v200, v200
v_cvt_pk_bf16_f32 v65, v198, v199
v_exp_f32 v201, v201
v_exp_f32 v202, v202
v_cvt_pk_bf16_f32 v66, v200, v201
v_exp_f32 v203, v203
s_cmp_ge_u32 s3, 4
v_mfma_f32_32x32x16_bf16 v[172:187], v[28:31], v[16:19], 0
v_exp_f32 v140, v140
v_cvt_pk_bf16_f32 v67, v202, v203
v_exp_f32 v141, v141
v_exp_f32 v142, v142
v_cvt_pk_bf16_f32 v60, v140, v141
v_exp_f32 v143, v143
v_mfma_f32_32x32x16_bf16 v[124:139], v[40:43], v[64:67], v[124:139]
ds_read_b128 v[40:43], v4 offset:3200
v_exp_f32 v144, v144
v_cvt_pk_bf16_f32 v61, v142, v143
v_exp_f32 v145, v145
v_exp_f32 v146, v146
v_cvt_pk_bf16_f32 v62, v144, v145
v_mfma_f32_32x32x16_bf16 v[188:203], v[28:31], v[20:23], 0
v_exp_f32 v147, v147
v_exp_f32 v148, v148
v_cvt_pk_bf16_f32 v63, v146, v147
v_exp_f32 v149, v149
v_exp_f32 v150, v150
s_waitcnt lgkmcnt(0)
v_mfma_f32_32x32x16_bf16 v[76:91], v[36:39], v[60:63], v[76:91]
v_cvt_pk_bf16_f32 v64, v148, v149
v_exp_f32 v151, v151
v_exp_f32 v152, v152
v_cvt_pk_bf16_f32 v65, v150, v151
v_exp_f32 v153, v153
v_mfma_f32_32x32x4bf16_1k v[172:203], v[32:33], v[26:27], v[172:203]
s_cbranch_scc1 Lk2_blk3
s_waitcnt lgkmcnt(0)
s_barrier
Lk2_ret3:
s_mov_b32 s39, 81920
v_add_u32 v216, s39, v216
v_add_u32 v3, s39, v3
v_mad_i32_i24 v4, v218, s39, v4
ds_read_b128 v[28:31], v216 offset:0
ds_read_b64 v[32:33], v3 offset:0
v_exp_f32 v154, v154
v_cvt_pk_bf16_f32 v66, v152, v153
v_exp_f32 v155, v155
v_exp_f32 v156, v156
v_cvt_pk_bf16_f32 v67, v154, v155
v_exp_f32 v157, v157
v_exp_f32 v158, v158
v_cvt_pk_bf16_f32 v60, v156, v157
v_exp_f32 v159, v159
v_exp_f32 v160, v160
v_mfma_f32_32x32x16_bf16 v[76:91], v[40:43], v[64:67], v[76:91]
v_cvt_pk_bf16_f32 v61, v158, v159
v_exp_f32 v161, v161
v_exp_f32 v162, v162
v_cvt_pk_bf16_f32 v62, v160, v161
v_exp_f32 v163, v163
v_exp_f32 v164, v164
v_cvt_pk_bf16_f32 v63, v162, v163
v_exp_f32 v165, v165
v_exp_f32 v166, v166
v_mfma_f32_32x32x16_bf16 v[92:107], v[36:39], v[60:63], v[92:107]
v_cvt_pk_bf16_f32 v64, v164, v165
v_exp_f32 v167, v167
v_exp_f32 v168, v168
v_cvt_pk_bf16_f32 v65, v166, v167
v_exp_f32 v169, v169
v_exp_f32 v170, v170
v_cvt_pk_bf16_f32 v66, v168, v169
v_exp_f32 v171, v171
s_waitcnt lgkmcnt(0)
v_mfma_f32_32x32x16_bf16 v[140:155], v[28:31], v[8:11], 0
v_exp_f32 v172, v172
v_cvt_pk_bf16_f32 v67, v170, v171
v_exp_f32 v173, v173
v_exp_f32 v174, v174
v_cvt_pk_bf16_f32 v60, v172, v173
v_exp_f32 v175, v175
v_mfma_f32_32x32x16_bf16 v[92:107], v[40:43], v[64:67], v[92:107]
v_exp_f32 v176, v176
v_cvt_pk_bf16_f32 v61, v174, v175
v_exp_f32 v177, v177
v_exp_f32 v178, v178
v_cvt_pk_bf16_f32 v62, v176, v177
v_mfma_f32_32x32x16_bf16 v[156:171], v[28:31], v[12:15], 0
v_exp_f32 v179, v179
v_exp_f32 v180, v180
v_cvt_pk_bf16_f32 v63, v178, v179
v_exp_f32 v181, v181
v_exp_f32 v182, v182
v_mfma_f32_32x32x16_bf16 v[108:123], v[36:39], v[60:63], v[108:123]
v_cvt_pk_bf16_f32 v64, v180, v181
v_exp_f32 v183, v183
v_exp_f32 v184, v184
v_cvt_pk_bf16_f32 v65, v182, v183
v_exp_f32 v185, v185
v_mfma_f32_32x32x4bf16_1k v[140:171], v[32:33], v[24:25], v[140:171]
v_exp_f32 v186, v186
v_cvt_pk_bf16_f32 v66, v184, v185
v_exp_f32 v187, v187
v_exp_f32 v188, v188
v_cvt_pk_bf16_f32 v67, v186, v187
v_exp_f32 v189, v189
v_exp_f32 v190, v190
v_cvt_pk_bf16_f32 v60, v188, v189
v_exp_f32 v191, v191
v_exp_f32 v192, v192
v_mfma_f32_32x32x16_bf16 v[108:123], v[40:43], v[64:67], v[108:123]
v_cvt_pk_bf16_f32 v61, v190, v191
v_exp_f32 v193, v193
v_exp_f32 v194, v194
v_cvt_pk_bf16_f32 v62, v192, v193
v_exp_f32 v195, v195
v_exp_f32 v196, v196
v_cvt_pk_bf16_f32 v63, v194, v195
v_exp_f32 v197, v197
v_exp_f32 v198, v198
v_mfma_f32_32x32x16_bf16 v[124:139], v[36:39], v[60:63], v[124:139]
ds_read_b128 v[36:39], v4 offset:0
v_cvt_pk_bf16_f32 v64, v196, v197
v_exp_f32 v199, v199
v_exp_f32 v200, v200
v_cvt_pk_bf16_f32 v65, v198, v199
v_exp_f32 v201, v201
v_exp_f32 v202, v202
v_cvt_pk_bf16_f32 v66, v200, v201
v_exp_f32 v203, v203
v_mfma_f32_32x32x16_bf16 v[172:187], v[28:31], v[16:19], 0
v_exp_f32 v140, v140
v_cvt_pk_bf16_f32 v67, v202, v203
v_exp_f32 v141, v141
v_exp_f32 v142, v142
v_cvt_pk_bf16_f32 v60, v140, v141
v_exp_f32 v143, v143
v_mfma_f32_32x32x16_bf16 v[124:139], v[40:43], v[64:67], v[124:139]
ds_read_b128 v[40:43], v4 offset:640
v_exp_f32 v144, v144
v_cvt_pk_bf16_f32 v61, v142, v143
v_exp_f32 v145, v145
v_exp_f32 v146, v146
v_cvt_pk_bf16_f32 v62, v144, v145
v_mfma_f32_32x32x16_bf16 v[188:203], v[28:31], v[20:23], 0
v_exp_f32 v147, v147
v_exp_f32 v148, v148
v_cvt_pk_bf16_f32 v63, v146, v147
v_exp_f32 v149, v149
v_exp_f32 v150, v150
s_waitcnt lgkmcnt(0)
v_mfma_f32_32x32x16_bf16 v[76:91], v[36:39], v[60:63], v[76:91]
v_cvt_pk_bf16_f32 v64, v148, v149
v_exp_f32 v151, v151
v_exp_f32 v152, v152
v_cvt_pk_bf16_f32 v65, v150, v151
v_exp_f32 v153, v153
v_mfma_f32_32x32x4bf16_1k v[172:203], v[32:33], v[26:27], v[172:203]
ds_read_b128 v[28:31], v216 offset:2560
ds_read_b64 v[32:33], v3 offset:2560
v_exp_f32 v154, v154
v_cvt_pk_bf16_f32 v66, v152, v153
v_exp_f32 v155, v155
v_exp_f32 v156, v156
v_cvt_pk_bf16_f32 v67, v154, v155
v_exp_f32 v157, v157
v_exp_f32 v158, v158
v_cvt_pk_bf16_f32 v60, v156, v157
v_exp_f32 v159, v159
v_exp_f32 v160, v160
v_mfma_f32_32x32x16_bf16 v[76:91], v[40:43], v[64:67], v[76:91]
v_cvt_pk_bf16_f32 v61, v158, v159
v_exp_f32 v161, v161
v_exp_f32 v162, v162
v_cvt_pk_bf16_f32 v62, v160, v161
v_exp_f32 v163, v163
v_exp_f32 v164, v164
v_cvt_pk_bf16_f32 v63, v162, v163
v_exp_f32 v165, v165
v_exp_f32 v166, v166
v_mfma_f32_32x32x16_bf16 v[92:107], v[36:39], v[60:63], v[92:107]
v_cvt_pk_bf16_f32 v64, v164, v165
v_exp_f32 v167, v167
v_exp_f32 v168, v168
v_cvt_pk_bf16_f32 v65, v166, v167
v_exp_f32 v169, v169
v_exp_f32 v170, v170
v_cvt_pk_bf16_f32 v66, v168, v169
v_exp_f32 v171, v171
s_waitcnt lgkmcnt(0)
v_mfma_f32_32x32x16_bf16 v[140:155], v[28:31], v[8:11], 0
v_exp_f32 v172, v172
v_cvt_pk_bf16_f32 v67, v170, v171
v_exp_f32 v173, v173
v_exp_f32 v174, v174
v_cvt_pk_bf16_f32 v60, v172, v173
v_exp_f32 v175, v175
v_mfma_f32_32x32x16_bf16 v[92:107], v[40:43], v[64:67], v[92:107]
v_exp_f32 v176, v176
v_cvt_pk_bf16_f32 v61, v174, v175
v_exp_f32 v177, v177
v_exp_f32 v178, v178
v_cvt_pk_bf16_f32 v62, v176, v177
v_mfma_f32_32x32x16_bf16 v[156:171], v[28:31], v[12:15], 0
v_exp_f32 v179, v179
v_exp_f32 v180, v180
v_cvt_pk_bf16_f32 v63, v178, v179
v_exp_f32 v181, v181
v_exp_f32 v182, v182
v_mfma_f32_32x32x16_bf16 v[108:123], v[36:39], v[60:63], v[108:123]
v_cvt_pk_bf16_f32 v64, v180, v181
v_exp_f32 v183, v183
v_exp_f32 v184, v184
v_cvt_pk_bf16_f32 v65, v182, v183
v_exp_f32 v185, v185
v_mfma_f32_32x32x4bf16_1k v[140:171], v[32:33], v[24:25], v[140:171]
v_exp_f32 v186, v186
v_cvt_pk_bf16_f32 v66, v184, v185
v_exp_f32 v187, v187
v_exp_f32 v188, v188
v_cvt_pk_bf16_f32 v67, v186, v187
v_exp_f32 v189, v189
v_exp_f32 v190, v190
v_cvt_pk_bf16_f32 v60, v188, v189
v_exp_f32 v191, v191
v_exp_f32 v192, v192
v_mfma_f32_32x32x16_bf16 v[108:123], v[40:43], v[64:67], v[108:123]
v_cvt_pk_bf16_f32 v61, v190, v191
v_exp_f32 v193, v193
v_exp_f32 v194, v194
v_cvt_pk_bf16_f32 v62, v192, v193
v_exp_f32 v195, v195
v_exp_f32 v196, v196
v_cvt_pk_bf16_f32 v63, v194, v195
v_exp_f32 v197, v197
v_exp_f32 v198, v198
v_mfma_f32_32x32x16_bf16 v[124:139], v[36:39], v[60:63], v[124:139]
ds_read_b128 v[36:39], v4 offset:2560
v_cvt_pk_bf16_f32 v64, v196, v197
v_exp_f32 v199, v199
v_exp_f32 v200, v200
v_cvt_pk_bf16_f32 v65, v198, v199
v_exp_f32 v201, v201
v_exp_f32 v202, v202
v_cvt_pk_bf16_f32 v66, v200, v201
v_exp_f32 v203, v203
s_cmp_ge_u32 s3, 4
v_mfma_f32_32x32x16_bf16 v[172:187], v[28:31], v[16:19], 0
v_exp_f32 v140, v140
v_cvt_pk_bf16_f32 v67, v202, v203
v_exp_f32 v141, v141
v_exp_f32 v142, v142
v_cvt_pk_bf16_f32 v60, v140, v141
v_exp_f32 v143, v143
v_mfma_f32_32x32x16_bf16 v[124:139], v[40:43], v[64:67], v[124:139]
ds_read_b128 v[40:43], v4 offset:3200
v_exp_f32 v144, v144
v_cvt_pk_bf16_f32 v61, v142, v143
v_exp_f32 v145, v145
v_exp_f32 v146, v146
v_cvt_pk_bf16_f32 v62, v144, v145
v_mfma_f32_32x32x16_bf16 v[188:203], v[28:31], v[20:23], 0
v_exp_f32 v147, v147
v_exp_f32 v148, v148
v_cvt_pk_bf16_f32 v63, v146, v147
v_exp_f32 v149, v149
v_exp_f32 v150, v150
s_waitcnt lgkmcnt(0)
v_mfma_f32_32x32x16_bf16 v[76:91], v[36:39], v[60:63], v[76:91]
v_cvt_pk_bf16_f32 v64, v148, v149
v_exp_f32 v151, v151
v_exp_f32 v152, v152
v_cvt_pk_bf16_f32 v65, v150, v151
v_exp_f32 v153, v153
v_mfma_f32_32x32x4bf16_1k v[172:203], v[32:33], v[26:27], v[172:203]
s_cbranch_scc1 Lk2_blk4
s_waitcnt lgkmcnt(0)
s_barrier
Lk2_ret4:
s_mov_b32 s39, 4294844416
v_add_u32 v216, s39, v216
v_add_u32 v3, s39, v3
v_mad_i32_i24 v4, v218, s39, v4
ds_read_b128 v[28:31], v216 offset:0
ds_read_b64 v[32:33], v3 offset:0
v_exp_f32 v154, v154
v_cvt_pk_bf16_f32 v66, v152, v153
v_exp_f32 v155, v155
v_exp_f32 v156, v156
v_cvt_pk_bf16_f32 v67, v154, v155
v_exp_f32 v157, v157
v_exp_f32 v158, v158
v_cvt_pk_bf16_f32 v60, v156, v157
v_exp_f32 v159, v159
v_exp_f32 v160, v160
v_mfma_f32_32x32x16_bf16 v[76:91], v[40:43], v[64:67], v[76:91]
v_cvt_pk_bf16_f32 v61, v158, v159
v_exp_f32 v161, v161
v_exp_f32 v162, v162
v_cvt_pk_bf16_f32 v62, v160, v161
v_exp_f32 v163, v163
v_exp_f32 v164, v164
v_cvt_pk_bf16_f32 v63, v162, v163
v_exp_f32 v165, v165
v_exp_f32 v166, v166
v_mfma_f32_32x32x16_bf16 v[92:107], v[36:39], v[60:63], v[92:107]
v_cvt_pk_bf16_f32 v64, v164, v165
v_exp_f32 v167, v167
v_exp_f32 v168, v168
v_cvt_pk_bf16_f32 v65, v166, v167
v_exp_f32 v169, v169
v_exp_f32 v170, v170
v_cvt_pk_bf16_f32 v66, v168, v169
v_exp_f32 v171, v171
s_waitcnt lgkmcnt(0)
v_mfma_f32_32x32x16_bf16 v[140:155], v[28:31], v[8:11], 0
v_exp_f32 v172, v172
v_cvt_pk_bf16_f32 v67, v170, v171
v_exp_f32 v173, v173
v_exp_f32 v174, v174
v_cvt_pk_bf16_f32 v60, v172, v173
v_exp_f32 v175, v175
v_mfma_f32_32x32x16_bf16 v[92:107], v[40:43], v[64:67], v[92:107]
v_exp_f32 v176, v176
v_cvt_pk_bf16_f32 v61, v174, v175
v_exp_f32 v177, v177
v_exp_f32 v178, v178
v_cvt_pk_bf16_f32 v62, v176, v177
v_mfma_f32_32x32x16_bf16 v[156:171], v[28:31], v[12:15], 0
v_exp_f32 v179, v179
v_exp_f32 v180, v180
v_cvt_pk_bf16_f32 v63, v178, v179
v_exp_f32 v181, v181
v_exp_f32 v182, v182
v_mfma_f32_32x32x16_bf16 v[108:123], v[36:39], v[60:63], v[108:123]
v_cvt_pk_bf16_f32 v64, v180, v181
v_exp_f32 v183, v183
v_exp_f32 v184, v184
v_cvt_pk_bf16_f32 v65, v182, v183
v_exp_f32 v185, v185
v_mfma_f32_32x32x4bf16_1k v[140:171], v[32:33], v[24:25], v[140:171]
v_exp_f32 v186, v186
v_cvt_pk_bf16_f32 v66, v184, v185
v_exp_f32 v187, v187
v_exp_f32 v188, v188
v_cvt_pk_bf16_f32 v67, v186, v187
v_exp_f32 v189, v189
v_exp_f32 v190, v190
v_cvt_pk_bf16_f32 v60, v188, v189
v_exp_f32 v191, v191
v_exp_f32 v192, v192
v_mfma_f32_32x32x16_bf16 v[108:123], v[40:43], v[64:67], v[108:123]
v_cvt_pk_bf16_f32 v61, v190, v191
v_exp_f32 v193, v193
v_exp_f32 v194, v194
v_cvt_pk_bf16_f32 v62, v192, v193
v_exp_f32 v195, v195
v_exp_f32 v196, v196
v_cvt_pk_bf16_f32 v63, v194, v195
v_exp_f32 v197, v197
v_exp_f32 v198, v198
v_mfma_f32_32x32x16_bf16 v[124:139], v[36:39], v[60:63], v[124:139]
ds_read_b128 v[36:39], v4 offset:0
v_cvt_pk_bf16_f32 v64, v196, v197
v_exp_f32 v199, v199
v_exp_f32 v200, v200
v_cvt_pk_bf16_f32 v65, v198, v199
v_exp_f32 v201, v201
v_exp_f32 v202, v202
v_cvt_pk_bf16_f32 v66, v200, v201
v_exp_f32 v203, v203
v_mfma_f32_32x32x16_bf16 v[172:187], v[28:31], v[16:19], 0
v_exp_f32 v140, v140
v_cvt_pk_bf16_f32 v67, v202, v203
v_exp_f32 v141, v141
v_exp_f32 v142, v142
v_cvt_pk_bf16_f32 v60, v140, v141
v_exp_f32 v143, v143
v_mfma_f32_32x32x16_bf16 v[124:139], v[40:43], v[64:67], v[124:139]
ds_read_b128 v[40:43], v4 offset:640
v_exp_f32 v144, v144
v_cvt_pk_bf16_f32 v61, v142, v143
v_exp_f32 v145, v145
v_exp_f32 v146, v146
v_cvt_pk_bf16_f32 v62, v144, v145
v_mfma_f32_32x32x16_bf16 v[188:203], v[28:31], v[20:23], 0
v_exp_f32 v147, v147
v_exp_f32 v148, v148
v_cvt_pk_bf16_f32 v63, v146, v147
v_exp_f32 v149, v149
v_exp_f32 v150, v150
s_waitcnt lgkmcnt(0)
v_mfma_f32_32x32x16_bf16 v[76:91], v[36:39], v[60:63], v[76:91]
v_cvt_pk_bf16_f32 v64, v148, v149
v_exp_f32 v151, v151
v_exp_f32 v152, v152
v_cvt_pk_bf16_f32 v65, v150, v151
v_exp_f32 v153, v153
v_mfma_f32_32x32x4bf16_1k v[172:203], v[32:33], v[26:27], v[172:203]
ds_read_b128 v[28:31], v216 offset:2560
ds_read_b64 v[32:33], v3 offset:2560
v_exp_f32 v154, v154
v_cvt_pk_bf16_f32 v66, v152, v153
v_exp_f32 v155, v155
v_exp_f32 v156, v156
v_cvt_pk_bf16_f32 v67, v154, v155
v_exp_f32 v157, v157
v_exp_f32 v158, v158
v_cvt_pk_bf16_f32 v60, v156, v157
v_exp_f32 v159, v159
v_exp_f32 v160, v160
v_mfma_f32_32x32x16_bf16 v[76:91], v[40:43], v[64:67], v[76:91]
v_cvt_pk_bf16_f32 v61, v158, v159
v_exp_f32 v161, v161
v_exp_f32 v162, v162
v_cvt_pk_bf16_f32 v62, v160, v161
v_exp_f32 v163, v163
v_exp_f32 v164, v164
v_cvt_pk_bf16_f32 v63, v162, v163
v_exp_f32 v165, v165
v_exp_f32 v166, v166
v_mfma_f32_32x32x16_bf16 v[92:107], v[36:39], v[60:63], v[92:107]
v_cvt_pk_bf16_f32 v64, v164, v165
v_exp_f32 v167, v167
v_exp_f32 v168, v168
v_cvt_pk_bf16_f32 v65, v166, v167
v_exp_f32 v169, v169
v_exp_f32 v170, v170
v_cvt_pk_bf16_f32 v66, v168, v169
v_exp_f32 v171, v171
s_waitcnt lgkmcnt(0)
v_mfma_f32_32x32x16_bf16 v[140:155], v[28:31], v[8:11], 0
v_exp_f32 v172, v172
v_cvt_pk_bf16_f32 v67, v170, v171
v_exp_f32 v173, v173
v_exp_f32 v174, v174
v_cvt_pk_bf16_f32 v60, v172, v173
v_exp_f32 v175, v175
v_mfma_f32_32x32x16_bf16 v[92:107], v[40:43], v[64:67], v[92:107]
v_exp_f32 v176, v176
v_cvt_pk_bf16_f32 v61, v174, v175
v_exp_f32 v177, v177
v_exp_f32 v178, v178
v_cvt_pk_bf16_f32 v62, v176, v177
v_mfma_f32_32x32x16_bf16 v[156:171], v[28:31], v[12:15], 0
v_exp_f32 v179, v179
v_exp_f32 v180, v180
v_cvt_pk_bf16_f32 v63, v178, v179
v_exp_f32 v181, v181
v_exp_f32 v182, v182
v_mfma_f32_32x32x16_bf16 v[108:123], v[36:39], v[60:63], v[108:123]
v_cvt_pk_bf16_f32 v64, v180, v181
v_exp_f32 v183, v183
v_exp_f32 v184, v184
v_cvt_pk_bf16_f32 v65, v182, v183
v_exp_f32 v185, v185
v_mfma_f32_32x32x4bf16_1k v[140:171], v[32:33], v[24:25], v[140:171]
v_exp_f32 v186, v186
v_cvt_pk_bf16_f32 v66, v184, v185
v_exp_f32 v187, v187
v_exp_f32 v188, v188
v_cvt_pk_bf16_f32 v67, v186, v187
v_exp_f32 v189, v189
v_exp_f32 v190, v190
v_cvt_pk_bf16_f32 v60, v188, v189
v_exp_f32 v191, v191
v_exp_f32 v192, v192
v_mfma_f32_32x32x16_bf16 v[108:123], v[40:43], v[64:67], v[108:123]
v_cvt_pk_bf16_f32 v61, v190, v191
v_exp_f32 v193, v193
v_exp_f32 v194, v194
v_cvt_pk_bf16_f32 v62, v192, v193
v_exp_f32 v195, v195
v_exp_f32 v196, v196
v_cvt_pk_bf16_f32 v63, v194, v195
v_exp_f32 v197, v197
v_exp_f32 v198, v198
v_mfma_f32_32x32x16_bf16 v[124:139], v[36:39], v[60:63], v[124:139]
ds_read_b128 v[36:39], v4 offset:2560
v_cvt_pk_bf16_f32 v64, v196, v197
v_exp_f32 v199, v199
v_exp_f32 v200, v200
v_cvt_pk_bf16_f32 v65, v198, v199
v_exp_f32 v201, v201
v_exp_f32 v202, v202
v_cvt_pk_bf16_f32 v66, v200, v201
v_exp_f32 v203, v203
s_cmp_ge_u32 s3, 4
v_mfma_f32_32x32x16_bf16 v[172:187], v[28:31], v[16:19], 0
v_exp_f32 v140, v140
v_cvt_pk_bf16_f32 v67, v202, v203
v_exp_f32 v141, v141
v_exp_f32 v142, v142
v_cvt_pk_bf16_f32 v60, v140, v141
v_exp_f32 v143, v143
v_mfma_f32_32x32x16_bf16 v[124:139], v[40:43], v[64:67], v[124:139]
ds_read_b128 v[40:43], v4 offset:3200
v_exp_f32 v144, v144
v_cvt_pk_bf16_f32 v61, v142, v143
v_exp_f32 v145, v145
v_exp_f32 v146, v146
v_cvt_pk_bf16_f32 v62, v144, v145
v_mfma_f32_32x32x16_bf16 v[188:203], v[28:31], v[20:23], 0
v_exp_f32 v147, v147
v_exp_f32 v148, v148
v_cvt_pk_bf16_f32 v63, v146, v147
v_exp_f32 v149, v149
v_exp_f32 v150, v150
s_waitcnt lgkmcnt(0)
v_mfma_f32_32x32x16_bf16 v[76:91], v[36:39], v[60:63], v[76:91]
v_cvt_pk_bf16_f32 v64, v148, v149
v_exp_f32 v151, v151
v_exp_f32 v152, v152
v_cvt_pk_bf16_f32 v65, v150, v151
v_exp_f32 v153, v153
v_mfma_f32_32x32x4bf16_1k v[172:203], v[32:33], v[26:27], v[172:203]
s_cbranch_scc1 Lk2_blk5
s_branch Lk2_xblk
Lk2_ret5:
s_mov_b32 s39, 20480
v_add_u32 v216, s39, v216
v_add_u32 v3, s39, v3
v_mad_i32_i24 v4, v218, s39, v4
ds_read_b128 v[28:31], v216 offset:0
ds_read_b64 v[32:33], v3 offset:0
v_exp_f32 v154, v154
v_cvt_pk_bf16_f32 v66, v152, v153
v_exp_f32 v155, v155
v_exp_f32 v156, v156
v_cvt_pk_bf16_f32 v67, v154, v155
v_exp_f32 v157, v157
v_exp_f32 v158, v158
v_cvt_pk_bf16_f32 v60, v156, v157
v_exp_f32 v159, v159
v_exp_f32 v160, v160
v_mfma_f32_32x32x16_bf16 v[76:91], v[40:43], v[64:67], v[76:91]
v_cvt_pk_bf16_f32 v61, v158, v159
v_exp_f32 v161, v161
v_exp_f32 v162, v162
v_cvt_pk_bf16_f32 v62, v160, v161
v_exp_f32 v163, v163
v_exp_f32 v164, v164
v_cvt_pk_bf16_f32 v63, v162, v163
v_exp_f32 v165, v165
v_exp_f32 v166, v166
v_mfma_f32_32x32x16_bf16 v[92:107], v[36:39], v[60:63], v[92:107]
v_cvt_pk_bf16_f32 v64, v164, v165
v_exp_f32 v167, v167
v_exp_f32 v168, v168
v_cvt_pk_bf16_f32 v65, v166, v167
v_exp_f32 v169, v169
v_exp_f32 v170, v170
v_cvt_pk_bf16_f32 v66, v168, v169
v_exp_f32 v171, v171
s_waitcnt lgkmcnt(0)
v_mfma_f32_32x32x16_bf16 v[140:155], v[28:31], v[8:11], 0
v_exp_f32 v172, v172
v_cvt_pk_bf16_f32 v67, v170, v171
v_exp_f32 v173, v173
v_exp_f32 v174, v174
v_cvt_pk_bf16_f32 v60, v172, v173
v_exp_f32 v175, v175
v_mfma_f32_32x32x16_bf16 v[92:107], v[40:43], v[64:67], v[92:107]
v_exp_f32 v176, v176
v_cvt_pk_bf16_f32 v61, v174, v175
v_exp_f32 v177, v177
v_exp_f32 v178, v178
v_cvt_pk_bf16_f32 v62, v176, v177
v_mfma_f32_32x32x16_bf16 v[156:171], v[28:31], v[12:15], 0
v_exp_f32 v179, v179
v_exp_f32 v180, v180
v_cvt_pk_bf16_f32 v63, v178, v179
v_exp_f32 v181, v181
v_exp_f32 v182, v182
v_mfma_f32_32x32x16_bf16 v[108:123], v[36:39], v[60:63], v[108:123]
v_cvt_pk_bf16_f32 v64, v180, v181
v_exp_f32 v183, v183
v_exp_f32 v184, v184
v_cvt_pk_bf16_f32 v65, v182, v183
v_exp_f32 v185, v185
v_mfma_f32_32x32x4bf16_1k v[140:171], v[32:33], v[24:25], v[140:171]
v_exp_f32 v186, v186
v_cvt_pk_bf16_f32 v66, v184, v185
v_exp_f32 v187, v187
v_exp_f32 v188, v188
v_cvt_pk_bf16_f32 v67, v186, v187
v_exp_f32 v189, v189
v_exp_f32 v190, v190
v_cvt_pk_bf16_f32 v60, v188, v189
v_exp_f32 v191, v191
v_exp_f32 v192, v192
v_mfma_f32_32x32x16_bf16 v[108:123], v[40:43], v[64:67], v[108:123]
v_cvt_pk_bf16_f32 v61, v190, v191
v_exp_f32 v193, v193
v_exp_f32 v194, v194
v_cvt_pk_bf16_f32 v62, v192, v193
v_exp_f32 v195, v195
v_exp_f32 v196, v196
v_cvt_pk_bf16_f32 v63, v194, v195
v_exp_f32 v197, v197
v_exp_f32 v198, v198
v_mfma_f32_32x32x16_bf16 v[124:139], v[36:39], v[60:63], v[124:139]
ds_read_b128 v[36:39], v4 offset:0
v_cvt_pk_bf16_f32 v64, v196, v197
v_exp_f32 v199, v199
v_exp_f32 v200, v200
v_cvt_pk_bf16_f32 v65, v198, v199
v_exp_f32 v201, v201
v_exp_f32 v202, v202
v_cvt_pk_bf16_f32 v66, v200, v201
v_exp_f32 v203, v203
v_mfma_f32_32x32x16_bf16 v[172:187], v[28:31], v[16:19], 0
v_exp_f32 v140, v140
v_cvt_pk_bf16_f32 v67, v202, v203
v_exp_f32 v141, v141
v_exp_f32 v142, v142
v_cvt_pk_bf16_f32 v60, v140, v141
v_exp_f32 v143, v143
v_mfma_f32_32x32x16_bf16 v[124:139], v[40:43], v[64:67], v[124:139]
ds_read_b128 v[40:43], v4 offset:640
v_exp_f32 v144, v144
v_cvt_pk_bf16_f32 v61, v142, v143
v_exp_f32 v145, v145
v_exp_f32 v146, v146
v_cvt_pk_bf16_f32 v62, v144, v145
v_mfma_f32_32x32x16_bf16 v[188:203], v[28:31], v[20:23], 0
v_exp_f32 v147, v147
v_exp_f32 v148, v148
v_cvt_pk_bf16_f32 v63, v146, v147
v_exp_f32 v149, v149
v_exp_f32 v150, v150
s_waitcnt lgkmcnt(0)
v_mfma_f32_32x32x16_bf16 v[76:91], v[36:39], v[60:63], v[76:91]
v_cvt_pk_bf16_f32 v64, v148, v149
v_exp_f32 v151, v151
v_exp_f32 v152, v152
v_cvt_pk_bf16_f32 v65, v150, v151
v_exp_f32 v153, v153
v_mfma_f32_32x32x4bf16_1k v[172:203], v[32:33], v[26:27], v[172:203]
ds_read_b128 v[28:31], v216 offset:2560
ds_read_b64 v[32:33], v3 offset:2560
v_exp_f32 v154, v154
v_cvt_pk_bf16_f32 v66, v152, v153
v_exp_f32 v155, v155
v_exp_f32 v156, v156
v_cvt_pk_bf16_f32 v67, v154, v155
v_exp_f32 v157, v157
v_exp_f32 v158, v158
v_cvt_pk_bf16_f32 v60, v156, v157
v_exp_f32 v159, v159
v_exp_f32 v160, v160
v_mfma_f32_32x32x16_bf16 v[76:91], v[40:43], v[64:67], v[76:91]
v_cvt_pk_bf16_f32 v61, v158, v159
v_exp_f32 v161, v161
v_exp_f32 v162, v162
v_cvt_pk_bf16_f32 v62, v160, v161
v_exp_f32 v163, v163
v_exp_f32 v164, v164
v_cvt_pk_bf16_f32 v63, v162, v163
v_exp_f32 v165, v165
v_exp_f32 v166, v166
v_mfma_f32_32x32x16_bf16 v[92:107], v[36:39], v[60:63], v[92:107]
v_cvt_pk_bf16_f32 v64, v164, v165
v_exp_f32 v167, v167
v_exp_f32 v168, v168
v_cvt_pk_bf16_f32 v65, v166, v167
v_exp_f32 v169, v169
v_exp_f32 v170, v170
v_cvt_pk_bf16_f32 v66, v168, v169
v_exp_f32 v171, v171
s_waitcnt lgkmcnt(0)
v_mfma_f32_32x32x16_bf16 v[140:155], v[28:31], v[8:11], 0
v_exp_f32 v172, v172
v_cvt_pk_bf16_f32 v67, v170, v171
v_exp_f32 v173, v173
v_exp_f32 v174, v174
v_cvt_pk_bf16_f32 v60, v172, v173
v_exp_f32 v175, v175
v_mfma_f32_32x32x16_bf16 v[92:107], v[40:43], v[64:67], v[92:107]
v_exp_f32 v176, v176
v_cvt_pk_bf16_f32 v61, v174, v175
v_exp_f32 v177, v177
v_exp_f32 v178, v178
v_cvt_pk_bf16_f32 v62, v176, v177
v_mfma_f32_32x32x16_bf16 v[156:171], v[28:31], v[12:15], 0
v_exp_f32 v179, v179
v_exp_f32 v180, v180
v_cvt_pk_bf16_f32 v63, v178, v179
v_exp_f32 v181, v181
v_exp_f32 v182, v182
v_mfma_f32_32x32x16_bf16 v[108:123], v[36:39], v[60:63], v[108:123]
v_cvt_pk_bf16_f32 v64, v180, v181
v_exp_f32 v183, v183
v_exp_f32 v184, v184
v_cvt_pk_bf16_f32 v65, v182, v183
v_exp_f32 v185, v185
v_mfma_f32_32x32x4bf16_1k v[140:171], v[32:33], v[24:25], v[140:171]
v_exp_f32 v186, v186
v_cvt_pk_bf16_f32 v66, v184, v185
v_exp_f32 v187, v187
v_exp_f32 v188, v188
v_cvt_pk_bf16_f32 v67, v186, v187
v_exp_f32 v189, v189
v_exp_f32 v190, v190
v_cvt_pk_bf16_f32 v60, v188, v189
v_exp_f32 v191, v191
v_exp_f32 v192, v192
v_mfma_f32_32x32x16_bf16 v[108:123], v[40:43], v[64:67], v[108:123]
v_cvt_pk_bf16_f32 v61, v190, v191
v_exp_f32 v193, v193
v_exp_f32 v194, v194
v_cvt_pk_bf16_f32 v62, v192, v193
v_exp_f32 v195, v195
v_exp_f32 v196, v196
v_cvt_pk_bf16_f32 v63, v194, v195
v_exp_f32 v197, v197
v_exp_f32 v198, v198
v_mfma_f32_32x32x16_bf16 v[124:139], v[36:39], v[60:63], v[124:139]
ds_read_b128 v[36:39], v4 offset:2560
v_cvt_pk_bf16_f32 v64, v196, v197
v_exp_f32 v199, v199
v_exp_f32 v200, v200
v_cvt_pk_bf16_f32 v65, v198, v199
v_exp_f32 v201, v201
v_exp_f32 v202, v202
v_cvt_pk_bf16_f32 v66, v200, v201
v_exp_f32 v203, v203
s_cmp_ge_u32 s3, 4
v_mfma_f32_32x32x16_bf16 v[172:187], v[28:31], v[16:19], 0
v_exp_f32 v140, v140
v_cvt_pk_bf16_f32 v67, v202, v203
v_exp_f32 v141, v141
v_exp_f32 v142, v142
v_cvt_pk_bf16_f32 v60, v140, v141
v_exp_f32 v143, v143
v_mfma_f32_32x32x16_bf16 v[124:139], v[40:43], v[64:67], v[124:139]
ds_read_b128 v[40:43], v4 offset:3200
v_exp_f32 v144, v144
v_cvt_pk_bf16_f32 v61, v142, v143
v_exp_f32 v145, v145
v_exp_f32 v146, v146
v_cvt_pk_bf16_f32 v62, v144, v145
v_mfma_f32_32x32x16_bf16 v[188:203], v[28:31], v[20:23], 0
v_exp_f32 v147, v147
v_exp_f32 v148, v148
v_cvt_pk_bf16_f32 v63, v146, v147
v_exp_f32 v149, v149
v_exp_f32 v150, v150
s_waitcnt lgkmcnt(0)
v_mfma_f32_32x32x16_bf16 v[76:91], v[36:39], v[60:63], v[76:91]
v_cvt_pk_bf16_f32 v64, v148, v149
v_exp_f32 v151, v151
v_exp_f32 v152, v152
v_cvt_pk_bf16_f32 v65, v150, v151
v_exp_f32 v153, v153
v_mfma_f32_32x32x4bf16_1k v[172:203], v[32:33], v[26:27], v[172:203]
s_cbranch_scc1 Lk2_blk6
s_waitcnt lgkmcnt(0)
s_barrier
Lk2_ret6:
s_mov_b32 s39, 20480
v_add_u32 v216, s39, v216
v_add_u32 v3, s39, v3
v_mad_i32_i24 v4, v218, s39, v4
ds_read_b128 v[28:31], v216 offset:0
ds_read_b64 v[32:33], v3 offset:0
v_exp_f32 v154, v154
v_cvt_pk_bf16_f32 v66, v152, v153
v_exp_f32 v155, v155
v_exp_f32 v156, v156
v_cvt_pk_bf16_f32 v67, v154, v155
v_exp_f32 v157, v157
v_exp_f32 v158, v158
v_cvt_pk_bf16_f32 v60, v156, v157
v_exp_f32 v159, v159
v_exp_f32 v160, v160
v_mfma_f32_32x32x16_bf16 v[76:91], v[40:43], v[64:67], v[76:91]
v_cvt_pk_bf16_f32 v61, v158, v159
v_exp_f32 v161, v161
v_exp_f32 v162, v162
v_cvt_pk_bf16_f32 v62, v160, v161
v_exp_f32 v163, v163
v_exp_f32 v164, v164
v_cvt_pk_bf16_f32 v63, v162, v163
v_exp_f32 v165, v165
v_exp_f32 v166, v166
v_mfma_f32_32x32x16_bf16 v[92:107], v[36:39], v[60:63], v[92:107]
v_cvt_pk_bf16_f32 v64, v164, v165
v_exp_f32 v167, v167
v_exp_f32 v168, v168
v_cvt_pk_bf16_f32 v65, v166, v167
v_exp_f32 v169, v169
v_exp_f32 v170, v170
v_cvt_pk_bf16_f32 v66, v168, v169
v_exp_f32 v171, v171
s_waitcnt lgkmcnt(0)
v_mfma_f32_32x32x16_bf16 v[140:155], v[28:31], v[8:11], 0
v_exp_f32 v172, v172
v_cvt_pk_bf16_f32 v67, v170, v171
v_exp_f32 v173, v173
v_exp_f32 v174, v174
v_cvt_pk_bf16_f32 v60, v172, v173
v_exp_f32 v175, v175
v_mfma_f32_32x32x16_bf16 v[92:107], v[40:43], v[64:67], v[92:107]
v_exp_f32 v176, v176
v_cvt_pk_bf16_f32 v61, v174, v175
v_exp_f32 v177, v177
v_exp_f32 v178, v178
v_cvt_pk_bf16_f32 v62, v176, v177
v_mfma_f32_32x32x16_bf16 v[156:171], v[28:31], v[12:15], 0
v_exp_f32 v179, v179
v_exp_f32 v180, v180
v_cvt_pk_bf16_f32 v63, v178, v179
v_exp_f32 v181, v181
v_exp_f32 v182, v182
v_mfma_f32_32x32x16_bf16 v[108:123], v[36:39], v[60:63], v[108:123]
v_cvt_pk_bf16_f32 v64, v180, v181
v_exp_f32 v183, v183
v_exp_f32 v184, v184
v_cvt_pk_bf16_f32 v65, v182, v183
v_exp_f32 v185, v185
v_mfma_f32_32x32x4bf16_1k v[140:171], v[32:33], v[24:25], v[140:171]
v_exp_f32 v186, v186
v_cvt_pk_bf16_f32 v66, v184, v185
v_exp_f32 v187, v187
v_exp_f32 v188, v188
v_cvt_pk_bf16_f32 v67, v186, v187
v_exp_f32 v189, v189
v_exp_f32 v190, v190
v_cvt_pk_bf16_f32 v60, v188, v189
v_exp_f32 v191, v191
v_exp_f32 v192, v192
v_mfma_f32_32x32x16_bf16 v[108:123], v[40:43], v[64:67], v[108:123]
v_cvt_pk_bf16_f32 v61, v190, v191
v_exp_f32 v193, v193
v_exp_f32 v194, v194
v_cvt_pk_bf16_f32 v62, v192, v193
v_exp_f32 v195, v195
v_exp_f32 v196, v196
v_cvt_pk_bf16_f32 v63, v194, v195
v_exp_f32 v197, v197
v_exp_f32 v198, v198
v_mfma_f32_32x32x16_bf16 v[124:139], v[36:39], v[60:63], v[124:139]
ds_read_b128 v[36:39], v4 offset:0
v_cvt_pk_bf16_f32 v64, v196, v197
v_exp_f32 v199, v199
v_exp_f32 v200, v200
v_cvt_pk_bf16_f32 v65, v198, v199
v_exp_f32 v201, v201
v_exp_f32 v202, v202
v_cvt_pk_bf16_f32 v66, v200, v201
v_exp_f32 v203, v203
v_mfma_f32_32x32x16_bf16 v[172:187], v[28:31], v[16:19], 0
v_exp_f32 v140, v140
v_cvt_pk_bf16_f32 v67, v202, v203
v_exp_f32 v141, v141
v_exp_f32 v142, v142
v_cvt_pk_bf16_f32 v60, v140, v141
v_exp_f32 v143, v143
v_mfma_f32_32x32x16_bf16 v[124:139], v[40:43], v[64:67], v[124:139]
ds_read_b128 v[40:43], v4 offset:640
v_exp_f32 v144, v144
v_cvt_pk_bf16_f32 v61, v142, v143
v_exp_f32 v145, v145
v_exp_f32 v146, v146
v_cvt_pk_bf16_f32 v62, v144, v145
v_mfma_f32_32x32x16_bf16 v[188:203], v[28:31], v[20:23], 0
v_exp_f32 v147, v147
v_exp_f32 v148, v148
v_cvt_pk_bf16_f32 v63, v146, v147
v_exp_f32 v149, v149
v_exp_f32 v150, v150
s_waitcnt lgkmcnt(0)
v_mfma_f32_32x32x16_bf16 v[76:91], v[36:39], v[60:63], v[76:91]
v_cvt_pk_bf16_f32 v64, v148, v149
v_exp_f32 v151, v151
v_exp_f32 v152, v152
v_cvt_pk_bf16_f32 v65, v150, v151
v_exp_f32 v153, v153
v_mfma_f32_32x32x4bf16_1k v[172:203], v[32:33], v[26:27], v[172:203]
ds_read_b128 v[28:31], v216 offset:2560
ds_read_b64 v[32:33], v3 offset:2560
v_exp_f32 v154, v154
v_cvt_pk_bf16_f32 v66, v152, v153
v_exp_f32 v155, v155
v_exp_f32 v156, v156
v_cvt_pk_bf16_f32 v67, v154, v155
v_exp_f32 v157, v157
v_exp_f32 v158, v158
v_cvt_pk_bf16_f32 v60, v156, v157
v_exp_f32 v159, v159
v_exp_f32 v160, v160
v_mfma_f32_32x32x16_bf16 v[76:91], v[40:43], v[64:67], v[76:91]
v_cvt_pk_bf16_f32 v61, v158, v159
v_exp_f32 v161, v161
v_exp_f32 v162, v162
v_cvt_pk_bf16_f32 v62, v160, v161
v_exp_f32 v163, v163
v_exp_f32 v164, v164
v_cvt_pk_bf16_f32 v63, v162, v163
v_exp_f32 v165, v165
v_exp_f32 v166, v166
v_mfma_f32_32x32x16_bf16 v[92:107], v[36:39], v[60:63], v[92:107]
v_cvt_pk_bf16_f32 v64, v164, v165
v_exp_f32 v167, v167
v_exp_f32 v168, v168
v_cvt_pk_bf16_f32 v65, v166, v167
v_exp_f32 v169, v169
v_exp_f32 v170, v170
v_cvt_pk_bf16_f32 v66, v168, v169
v_exp_f32 v171, v171
s_waitcnt lgkmcnt(0)
v_mfma_f32_32x32x16_bf16 v[140:155], v[28:31], v[8:11], 0
v_exp_f32 v172, v172
v_cvt_pk_bf16_f32 v67, v170, v171
v_exp_f32 v173, v173
v_exp_f32 v174, v174
v_cvt_pk_bf16_f32 v60, v172, v173
v_exp_f32 v175, v175
v_mfma_f32_32x32x16_bf16 v[92:107], v[40:43], v[64:67], v[92:107]
v_exp_f32 v176, v176
v_cvt_pk_bf16_f32 v61, v174, v175
v_exp_f32 v177, v177
v_exp_f32 v178, v178
v_cvt_pk_bf16_f32 v62, v176, v177
v_mfma_f32_32x32x16_bf16 v[156:171], v[28:31], v[12:15], 0
v_exp_f32 v179, v179
v_exp_f32 v180, v180
v_cvt_pk_bf16_f32 v63, v178, v179
v_exp_f32 v181, v181
v_exp_f32 v182, v182
v_mfma_f32_32x32x16_bf16 v[108:123], v[36:39], v[60:63], v[108:123]
v_cvt_pk_bf16_f32 v64, v180, v181
v_exp_f32 v183, v183
v_exp_f32 v184, v184
v_cvt_pk_bf16_f32 v65, v182, v183
v_exp_f32 v185, v185
v_mfma_f32_32x32x4bf16_1k v[140:171], v[32:33], v[24:25], v[140:171]
v_exp_f32 v186, v186
v_cvt_pk_bf16_f32 v66, v184, v185
v_exp_f32 v187, v187
v_exp_f32 v188, v188
v_cvt_pk_bf16_f32 v67, v186, v187
v_exp_f32 v189, v189
v_exp_f32 v190, v190
v_cvt_pk_bf16_f32 v60, v188, v189
v_exp_f32 v191, v191
v_exp_f32 v192, v192
v_mfma_f32_32x32x16_bf16 v[108:123], v[40:43], v[64:67], v[108:123]
v_cvt_pk_bf16_f32 v61, v190, v191
v_exp_f32 v193, v193
v_exp_f32 v194, v194
v_cvt_pk_bf16_f32 v62, v192, v193
v_exp_f32 v195, v195
v_exp_f32 v196, v196
v_cvt_pk_bf16_f32 v63, v194, v195
v_exp_f32 v197, v197
v_exp_f32 v198, v198
v_mfma_f32_32x32x16_bf16 v[124:139], v[36:39], v[60:63], v[124:139]
ds_read_b128 v[36:39], v4 offset:2560
v_cvt_pk_bf16_f32 v64, v196, v197
v_exp_f32 v199, v199
v_exp_f32 v200, v200
v_cvt_pk_bf16_f32 v65, v198, v199
v_exp_f32 v201, v201
v_exp_f32 v202, v202
v_cvt_pk_bf16_f32 v66, v200, v201
v_exp_f32 v203, v203
s_cmp_ge_u32 s3, 4
v_mfma_f32_32x32x16_bf16 v[172:187], v[28:31], v[16:19], 0
v_exp_f32 v140, v140
v_cvt_pk_bf16_f32 v67, v202, v203
v_exp_f32 v141, v141
v_exp_f32 v142, v142
v_cvt_pk_bf16_f32 v60, v140, v141
v_exp_f32 v143, v143
v_mfma_f32_32x32x16_bf16 v[124:139], v[40:43], v[64:67], v[124:139]
ds_read_b128 v[40:43], v4 offset:3200
v_exp_f32 v144, v144
v_cvt_pk_bf16_f32 v61, v142, v143
v_exp_f32 v145, v145
v_exp_f32 v146, v146
v_cvt_pk_bf16_f32 v62, v144, v145
v_mfma_f32_32x32x16_bf16 v[188:203], v[28:31], v[20:23], 0
v_exp_f32 v147, v147
v_exp_f32 v148, v148
v_cvt_pk_bf16_f32 v63, v146, v147
v_exp_f32 v149, v149
v_exp_f32 v150, v150
s_waitcnt lgkmcnt(0)
v_mfma_f32_32x32x16_bf16 v[76:91], v[36:39], v[60:63], v[76:91]
v_cvt_pk_bf16_f32 v64, v148, v149
v_exp_f32 v151, v151
v_exp_f32 v152, v152
v_cvt_pk_bf16_f32 v65, v150, v151
v_exp_f32 v153, v153
v_mfma_f32_32x32x4bf16_1k v[172:203], v[32:33], v[26:27], v[172:203]
s_cbranch_scc1 Lk2_blk7
s_waitcnt lgkmcnt(0)
s_barrier
Lk2_ret7:
ds_read_b128 v[28:31], v216 offset:0
ds_read_b64 v[32:33], v3 offset:0
v_exp_f32 v154, v154
v_cvt_pk_bf16_f32 v66, v152, v153
v_exp_f32 v155, v155
v_exp_f32 v156, v156
v_cvt_pk_bf16_f32 v67, v154, v155
v_exp_f32 v157, v157
v_exp_f32 v158, v158
v_cvt_pk_bf16_f32 v60, v156, v157
v_exp_f32 v159, v159
v_exp_f32 v160, v160
v_mfma_f32_32x32x16_bf16 v[76:91], v[40:43], v[64:67], v[76:91]
v_cvt_pk_bf16_f32 v61, v158, v159
v_exp_f32 v161, v161
v_exp_f32 v162, v162
v_cvt_pk_bf16_f32 v62, v160, v161
v_exp_f32 v163, v163
v_exp_f32 v164, v164
v_cvt_pk_bf16_f32 v63, v162, v163
v_exp_f32 v165, v165
v_exp_f32 v166, v166
v_mfma_f32_32x32x16_bf16 v[92:107], v[36:39], v[60:63], v[92:107]
v_cvt_pk_bf16_f32 v64, v164, v165
v_exp_f32 v167, v167
v_exp_f32 v168, v168
v_cvt_pk_bf16_f32 v65, v166, v167
v_exp_f32 v169, v169
v_exp_f32 v170, v170
v_cvt_pk_bf16_f32 v66, v168, v169
v_exp_f32 v171, v171
s_waitcnt lgkmcnt(0)
v_mfma_f32_32x32x16_bf16 v[140:155], v[28:31], v[8:11], 0
v_exp_f32 v172, v172
v_cvt_pk_bf16_f32 v67, v170, v171
v_exp_f32 v173, v173
v_exp_f32 v174, v174
v_cvt_pk_bf16_f32 v60, v172, v173
v_exp_f32 v175, v175
v_mfma_f32_32x32x16_bf16 v[92:107], v[40:43], v[64:67], v[92:107]
v_exp_f32 v176, v176
v_cvt_pk_bf16_f32 v61, v174, v175
v_exp_f32 v177, v177
v_exp_f32 v178, v178
v_cvt_pk_bf16_f32 v62, v176, v177
v_mfma_f32_32x32x16_bf16 v[156:171], v[28:31], v[12:15], 0
v_exp_f32 v179, v179
v_exp_f32 v180, v180
v_cvt_pk_bf16_f32 v63, v178, v179
v_exp_f32 v181, v181
v_exp_f32 v182, v182
v_mfma_f32_32x32x16_bf16 v[108:123], v[36:39], v[60:63], v[108:123]
v_cvt_pk_bf16_f32 v64, v180, v181
v_exp_f32 v183, v183
v_exp_f32 v184, v184
v_cvt_pk_bf16_f32 v65, v182, v183
v_exp_f32 v185, v185
v_mfma_f32_32x32x4bf16_1k v[140:171], v[32:33], v[24:25], v[140:171]
v_exp_f32 v186, v186
v_cvt_pk_bf16_f32 v66, v184, v185
v_exp_f32 v187, v187
v_exp_f32 v188, v188
v_cvt_pk_bf16_f32 v67, v186, v187
v_exp_f32 v189, v189
v_exp_f32 v190, v190
v_cvt_pk_bf16_f32 v60, v188, v189
v_exp_f32 v191, v191
v_exp_f32 v192, v192
v_mfma_f32_32x32x16_bf16 v[108:123], v[40:43], v[64:67], v[108:123]
v_cvt_pk_bf16_f32 v61, v190, v191
v_exp_f32 v193, v193
v_exp_f32 v194, v194
v_cvt_pk_bf16_f32 v62, v192, v193
v_exp_f32 v195, v195
v_exp_f32 v196, v196
v_cvt_pk_bf16_f32 v63, v194, v195
v_exp_f32 v197, v197
v_exp_f32 v198, v198
v_mfma_f32_32x32x16_bf16 v[124:139], v[36:39], v[60:63], v[124:139]
ds_read_b128 v[36:39], v4 offset:0
v_cvt_pk_bf16_f32 v64, v196, v197
v_exp_f32 v199, v199
v_exp_f32 v200, v200
v_cvt_pk_bf16_f32 v65, v198, v199
v_exp_f32 v201, v201
v_exp_f32 v202, v202
v_cvt_pk_bf16_f32 v66, v200, v201
v_exp_f32 v203, v203
s_nop 0
v_cvt_pk_bf16_f32 v67, v202, v203
s_nop 1
v_mfma_f32_32x32x16_bf16 v[124:139], v[40:43], v[64:67], v[124:139]
s_cmp_ge_u32 s3, 4
s_cbranch_scc1 Lk2_nw
s_waitcnt vmcnt(0)
Lk2_nw:
v_cmp_ne_u32 vcc, s42, v204
s_nop 1
s_cmp_eq_u64 vcc, 0
s_cselect_b32 s41, 1, 0
Lk2_red:
s_and_b32 s28, s3, 3
s_lshr_b32 s29, s3, 2
s_mul_i32 s29, s29, 36864
v_add_u32 v5, s29, v2
s_cmp_lg_u32 s28, 0
s_cbranch_scc1 Lredn_54
ds_write_b128 v5, v[92:95] offset:9216
ds_write_b128 v5, v[96:99] offset:10240
ds_write_b128 v5, v[100:103] offset:11264
ds_write_b128 v5, v[108:111] offset:18432
ds_write_b128 v5, v[112:115] offset:19456
ds_write_b128 v5, v[116:119] offset:20480
ds_write_b128 v5, v[124:127] offset:27648
ds_write_b128 v5, v[128:131] offset:28672
ds_write_b128 v5, v[132:135] offset:29696
v_mov_b32 v140, v76
v_mov_b32 v141, v77
v_mov_b32 v142, v78
v_mov_b32 v143, v79
v_mov_b32 v144, v80
v_mov_b32 v145, v81
v_mov_b32 v146, v82
v_mov_b32 v147, v83
v_mov_b32 v148, v84
v_mov_b32 v149, v85
v_mov_b32 v150, v86
v_mov_b32 v151, v87
s_branch Lredj_53
Lredn_54:
s_cmp_lg_u32 s28, 1
s_cbranch_scc1 Lredn_55
ds_write_b128 v5, v[76:79] offset:0
ds_write_b128 v5, v[80:83] offset:1024
ds_write_b128 v5, v[84:87] offset:2048
ds_write_b128 v5, v[108:111] offset:21504
ds_write_b128 v5, v[112:115] offset:22528
ds_write_b128 v5, v[116:119] offset:23552
ds_write_b128 v5, v[124:127] offset:30720
ds_write_b128 v5, v[128:131] offset:31744
ds_write_b128 v5, v[132:135] offset:32768
v_mov_b32 v140, v92
v_mov_b32 v141, v93
v_mov_b32 v142, v94
v_mov_b32 v143, v95
v_mov_b32 v144, v96
v_mov_b32 v145, v97
v_mov_b32 v146, v98
v_mov_b32 v147, v99
v_mov_b32 v148, v100
v_mov_b32 v149, v101
v_mov_b32 v150, v102
v_mov_b32 v151, v103
s_branch Lredj_53
Lredn_55:
s_cmp_lg_u32 s28, 2
s_cbranch_scc1 Lredn_56
ds_write_b128 v5, v[76:79] offset:3072
ds_write_b128 v5, v[80:83] offset:4096
ds_write_b128 v5, v[84:87] offset:5120
ds_write_b128 v5, v[92:95] offset:12288
ds_write_b128 v5, v[96:99] offset:13312
ds_write_b128 v5, v[100:103] offset:14336
ds_write_b128 v5, v[124:127] offset:33792
ds_write_b128 v5, v[128:131] offset:34816
ds_write_b128 v5, v[132:135] offset:35840
v_mov_b32 v140, v108
v_mov_b32 v141, v109
v_mov_b32 v142, v110
v_mov_b32 v143, v111
v_mov_b32 v144, v112
v_mov_b32 v145, v113
v_mov_b32 v146, v114
v_mov_b32 v147, v115
v_mov_b32 v148, v116
v_mov_b32 v149, v117
v_mov_b32 v150, v118
v_mov_b32 v151, v119
s_branch Lredj_53
Lredn_56:
ds_write_b128 v5, v[76:79] offset:6144
ds_write_b128 v5, v[80:83] offset:7168
ds_write_b128 v5, v[84:87] offset:8192
ds_write_b128 v5, v[92:95] offset:15360
ds_write_b128 v5, v[96:99] offset:16384
ds_write_b128 v5, v[100:103] offset:17408
ds_write_b128 v5, v[108:111] offset:24576
ds_write_b128 v5, v[112:115] offset:25600
ds_write_b128 v5, v[116:119] offset:26624
v_mov_b32 v140, v124
v_mov_b32 v141, v125
v_mov_b32 v142, v126
v_mov_b32 v143, v127
v_mov_b32 v144, v128
v_mov_b32 v145, v129
v_mov_b32 v146, v130
v_mov_b32 v147, v131
v_mov_b32 v148, v132
v_mov_b32 v149, v133
v_mov_b32 v150, v134
v_mov_b32 v151, v135
Lredj_53:
s_mul_i32 s30, s28, 9216
v_add_u32 v5, s30, v5
v_lshrrev_b32 v6, 5, v1
s_mul_i32 s30, s28, 5
v_add_u32 v6, s30, v6
v_bfe_u32 v7, v1, 4, 1
v_mul_u32_u24 v7, 20480, v7
v_and_b32 v204, 15, v1
v_lshl_add_u32 v7, v204, 4, v7
v_lshrrev_b32 v204, 1, v6
v_lshl_add_u32 v7, v204, 8, v7
v_and_b32 v204, 1, v6
v_lshl_add_u32 v7, v204, 3, v7
s_mul_i32 s28, s20, 81920
s_lshr_b32 s29, s3, 2
s_mul_i32 s29, s29, 40960
s_add_u32 s28, s28, s29
s_mul_i32 s29, s21, 2560
s_add_u32 s28, s28, s29
s_add_u32 s28, s28, 10649600
s_mov_b32 s38, 0x1f800000
v_mov_b32 v205, 0x5f800000
s_waitcnt lgkmcnt(0)
s_barrier
ds_read_b128 v[68:71], v5 offset:2048
ds_read_b128 v[80:83], v5 offset:5120
ds_read_b128 v[92:95], v5 offset:8192
ds_read_b128 v[60:63], v5 offset:0
ds_read_b128 v[72:75], v5 offset:3072
ds_read_b128 v[84:87], v5 offset:6144
ds_read_b128 v[64:67], v5 offset:1024
ds_read_b128 v[76:79], v5 offset:4096
ds_read_b128 v[88:91], v5 offset:7168
s_waitcnt lgkmcnt(6)
v_pk_add_f32 v[148:149], v[148:149], v[68:69]
v_pk_add_f32 v[80:81], v[80:81], v[92:93]
v_pk_add_f32 v[150:151], v[150:151], v[70:71]
v_pk_add_f32 v[82:83], v[82:83], v[94:95]
v_pk_add_f32 v[148:149], v[148:149], v[80:81]
v_pk_add_f32 v[150:151], v[150:151], v[82:83]
v_mov_b32 v206, v148
v_mov_b32 v207, v148
s_nop 1
v_permlane32_swap_b32 v206, v207
v_rcp_f32 v208, v207
v_med3_f32 v206, v207, s38, v205
v_cmp_neq_f32 vcc, v206, v207
v_mov_b32 v209, v208
v_pk_mul_f32 v[148:149], v[148:149], v[208:209]
v_pk_mul_f32 v[150:151], v[150:151], v[208:209]
v_cvt_pk_bf16_f32 v104, v148, v149
v_cvt_pk_bf16_f32 v105, v150, v151
s_mov_b32 exec_hi, 0
buffer_store_dwordx2 v[104:105], v7, s[8:11], s28 offen offset:512
s_mov_b32 exec_hi, -1
s_waitcnt lgkmcnt(3)
v_pk_add_f32 v[140:141], v[140:141], v[60:61]
v_pk_add_f32 v[72:73], v[72:73], v[84:85]
v_pk_add_f32 v[142:143], v[142:143], v[62:63]
v_pk_add_f32 v[74:75], v[74:75], v[86:87]
v_pk_add_f32 v[140:141], v[140:141], v[72:73]
v_pk_add_f32 v[142:143], v[142:143], v[74:75]
v_pk_mul_f32 v[140:141], v[140:141], v[208:209]
v_pk_mul_f32 v[142:143], v[142:143], v[208:209]
v_cvt_pk_bf16_f32 v100, v140, v141
v_cvt_pk_bf16_f32 v101, v142, v143
buffer_store_dwordx2 v[100:101], v7, s[8:11], s28 offen offset:0
s_waitcnt lgkmcnt(0)
v_pk_add_f32 v[144:145], v[144:145], v[64:65]
v_pk_add_f32 v[76:77], v[76:77], v[88:89]
v_pk_add_f32 v[146:147], v[146:147], v[66:67]
v_pk_add_f32 v[78:79], v[78:79], v[90:91]
v_pk_add_f32 v[144:145], v[144:145], v[76:77]
v_pk_add_f32 v[146:147], v[146:147], v[78:79]
v_pk_mul_f32 v[144:145], v[144:145], v[208:209]
v_pk_mul_f32 v[146:147], v[146:147], v[208:209]
v_cvt_pk_bf16_f32 v102, v144, v145
v_cvt_pk_bf16_f32 v103, v146, v147
buffer_store_dwordx2 v[102:103], v7, s[8:11], s28 offen offset:256
s_cbranch_vccz Lk2_ok
v_mov_b32 v206, 159744
v_mov_b32 v207, 1
ds_write_b32 v206, v207
Lk2_ok:
s_waitcnt lgkmcnt(0)
s_barrier
s_cmp_lg_u32 s37, 0
s_cbranch_scc1 Lk2_done
v_mov_b32 v206, 159744
ds_read_b32 v207, v206
s_waitcnt lgkmcnt(0)
v_readfirstlane_b32 s28, v207
s_nop 1
s_cmp_eq_u32 s28, 0
s_cbranch_scc1 Lk2_done
s_mov_b32 s37, 1
s_waitcnt vmcnt(0)
v_lshrrev_b32 v4, 5, v1
v_mul_u32_u24 v4, 320, v4
v_lshl_add_u32 v4, v217, 1, v4
v_and_b32 v5, 31, v1
v_mov_b32 v6, 0x3f803f80
v_cmp_eq_u32 vcc, 20, v5
s_nop 1
v_cndmask_b32 v36, 0, v6, vcc
v_mov_b32 v37, v36
v_mov_b32 v38, v36
v_mov_b32 v39, v36
v_mov_b32 v40, v36
v_mov_b32 v41, v36
v_mov_b32 v42, v36
v_mov_b32 v43, v36
v_lshrrev_b32 v5, 2, v0
v_and_b32 v5, 64, v5
v_lshlrev_b32 v5, 4, v5
v_add_u32 v5, v5, v217
v_add_u32 v5, 157696, v5
ds_read_b64 v[204:205], v5 offset:0
ds_read_b64 v[206:207], v5 offset:256
ds_read_b64 v[208:209], v5 offset:512
ds_read_b64 v[210:211], v5 offset:768
v_cmp_gt_u32 s[32:33], 32, v1
s_waitcnt lgkmcnt(0)
s_nop 0
v_cndmask_b32 v204, 0, v204, s[32:33]
v_cndmask_b32 v205, 0, v205, s[32:33]
v_cndmask_b32 v206, 0, v206, s[32:33]
v_cndmask_b32 v207, 0, v207, s[32:33]
v_cndmask_b32 v208, 0, v208, s[32:33]
v_cndmask_b32 v209, 0, v209, s[32:33]
v_cndmask_b32 v210, 0, v210, s[32:33]
v_cndmask_b32 v211, 0, v211, s[32:33]
v_mov_b32 v212, 0xff800000
v_mov_b32 v213, 0xff800000
v_mov_b32 v214, 0xff800000
v_mov_b32 v215, 0xff800000
s_and_b32 s34, s3, 3
s_mul_i32 s34, s34, 5120
s_add_u32 s34, s34, 24911872
s_mov_b32 s35, 16
Lk2_max:
buffer_load_dwordx4 v[28:31], v2, s[8:11], s34 offen sc1
buffer_load_dwordx2 v[32:33], v217, s[8:11], s34 offen offset:1024 sc1
s_bitcmp1_b32 s35, 0
s_mov_b32 s28, 2560
s_cselect_b32 s28, 17920, s28
s_add_u32 s34, s34, s28
v_mov_b32 v6, 0x3f803f80
s_waitcnt vmcnt(0)
v_cndmask_b32 v32, v6, v32, s[32:33]
v_cndmask_b32 v33, 0, v33, s[32:33]
v_mfma_f32_32x32x16_bf16 v[140:155], v[28:31], v[8:11], 0
s_nop 0
v_mfma_f32_32x32x8bf16_1k v[140:155], v[32:33], v[204:205], v[140:155]
s_nop 11
v_max3_f32 v212, v140, v141, v212
v_max3_f32 v212, v142, v143, v212
v_max3_f32 v212, v144, v145, v212
v_max3_f32 v212, v146, v147, v212
v_max3_f32 v212, v148, v149, v212
v_max3_f32 v212, v150, v151, v212
v_max3_f32 v212, v152, v153, v212
v_max3_f32 v212, v154, v155, v212
v_mfma_f32_32x32x16_bf16 v[140:155], v[28:31], v[12:15], 0
v_mfma_f32_32x32x8bf16_1k v[140:155], v[32:33], v[206:207], v[140:155]
s_nop 11
v_max3_f32 v213, v140, v141, v213
v_max3_f32 v213, v142, v143, v213
v_max3_f32 v213, v144, v145, v213
v_max3_f32 v213, v146, v147, v213
v_max3_f32 v213, v148, v149, v213
v_max3_f32 v213, v150, v151, v213
v_max3_f32 v213, v152, v153, v213
v_max3_f32 v213, v154, v155, v213
v_mfma_f32_32x32x16_bf16 v[140:155], v[28:31], v[16:19], 0
v_mfma_f32_32x32x8bf16_1k v[140:155], v[32:33], v[208:209], v[140:155]
s_nop 11
v_max3_f32 v214, v140, v141, v214
v_max3_f32 v214, v142, v143, v214
v_max3_f32 v214, v144, v145, v214
v_max3_f32 v214, v146, v147, v214
v_max3_f32 v214, v148, v149, v214
v_max3_f32 v214, v150, v151, v214
v_max3_f32 v214, v152, v153, v214
v_max3_f32 v214, v154, v155, v214
v_mfma_f32_32x32x16_bf16 v[140:155], v[28:31], v[20:23], 0
v_mfma_f32_32x32x8bf16_1k v[140:155], v[32:33], v[210:211], v[140:155]
s_nop 11
v_max3_f32 v215, v140, v141, v215
v_max3_f32 v215, v142, v143, v215
v_max3_f32 v215, v144, v145, v215
v_max3_f32 v215, v146, v147, v215
v_max3_f32 v215, v148, v149, v215
v_max3_f32 v215, v150, v151, v215
v_max3_f32 v215, v152, v153, v215
v_max3_f32 v215, v154, v155, v215
s_sub_u32 s35, s35, 1
s_cmp_lg_u32 s35, 0
s_cbranch_scc1 Lk2_max
v_lshrrev_b32 v5, 2, v0
v_and_b32 v5, 64, v5
v_lshlrev_b32 v5, 6, v5
v_lshl_add_u32 v5, v217, 2, v5
v_lshrrev_b32 v6, 5, v1
s_and_b32 s28, s3, 3
s_lshl_b32 s28, s28, 3
v_lshl_add_u32 v6, v6, 2, s28
v_add_u32 v6, v5, v6
ds_write_b32 v6, v212 offset:0
ds_write_b32 v6, v213 offset:1024
ds_write_b32 v6, v214 offset:2048
ds_write_b32 v6, v215 offset:3072
s_waitcnt lgkmcnt(0)
s_barrier
ds_read_b128 v[140:143], v5 offset:0
ds_read_b128 v[144:147], v5 offset:16
s_waitcnt lgkmcnt(0)
v_max3_f32 v140, v140, v141, v142
v_max3_f32 v140, v140, v143, v144
v_max3_f32 v140, v140, v145, v146
v_max_f32 v140, v140, v147
v_sub_f32 v140, 0, v140
v_cvt_pk_bf16_f32 v141, v140, v140
v_and_b32 v141, 0xffff0000, v141
v_sub_f32 v142, v140, v141
v_cvt_pk_bf16_f32 v141, v141, v142
v_cndmask_b32 v204, v141, v204, s[32:33]
ds_read_b128 v[140:143], v5 offset:1024
ds_read_b128 v[144:147], v5 offset:1040
s_waitcnt lgkmcnt(0)
v_max3_f32 v140, v140, v141, v142
v_max3_f32 v140, v140, v143, v144
v_max3_f32 v140, v140, v145, v146
v_max_f32 v140, v140, v147
v_sub_f32 v140, 0, v140
v_cvt_pk_bf16_f32 v141, v140, v140
v_and_b32 v141, 0xffff0000, v141
v_sub_f32 v142, v140, v141
v_cvt_pk_bf16_f32 v141, v141, v142
v_cndmask_b32 v206, v141, v206, s[32:33]
ds_read_b128 v[140:143], v5 offset:2048
ds_read_b128 v[144:147], v5 offset:2064
s_waitcnt lgkmcnt(0)
v_max3_f32 v140, v140, v141, v142
v_max3_f32 v140, v140, v143, v144
v_max3_f32 v140, v140, v145, v146
v_max_f32 v140, v140, v147
v_sub_f32 v140, 0, v140
v_cvt_pk_bf16_f32 v141, v140, v140
v_and_b32 v141, 0xffff0000, v141
v_sub_f32 v142, v140, v141
v_cvt_pk_bf16_f32 v141, v141, v142
v_cndmask_b32 v208, v141, v208, s[32:33]
ds_read_b128 v[140:143], v5 offset:3072
ds_read_b128 v[144:147], v5 offset:3088
s_waitcnt lgkmcnt(0)
v_max3_f32 v140, v140, v141, v142
v_max3_f32 v140, v140, v143, v144
v_max3_f32 v140, v140, v145, v146
v_max_f32 v140, v140, v147
v_sub_f32 v140, 0, v140
v_cvt_pk_bf16_f32 v141, v140, v140
v_and_b32 v141, 0xffff0000, v141
v_sub_f32 v142, v140, v141
v_cvt_pk_bf16_f32 v141, v141, v142
v_cndmask_b32 v210, v141, v210, s[32:33]
v_mov_b32 v76, 0
v_mov_b32 v77, 0
v_mov_b32 v78, 0
v_mov_b32 v79, 0
v_mov_b32 v80, 0
v_mov_b32 v81, 0
v_mov_b32 v82, 0
v_mov_b32 v83, 0
v_mov_b32 v84, 0
v_mov_b32 v85, 0
v_mov_b32 v86, 0
v_mov_b32 v87, 0
v_mov_b32 v88, 0
v_mov_b32 v89, 0
v_mov_b32 v90, 0
v_mov_b32 v91, 0
v_mov_b32 v92, 0
v_mov_b32 v93, 0
v_mov_b32 v94, 0
v_mov_b32 v95, 0
v_mov_b32 v96, 0
v_mov_b32 v97, 0
v_mov_b32 v98, 0
v_mov_b32 v99, 0
v_mov_b32 v100, 0
v_mov_b32 v101, 0
v_mov_b32 v102, 0
v_mov_b32 v103, 0
v_mov_b32 v104, 0
v_mov_b32 v105, 0
v_mov_b32 v106, 0
v_mov_b32 v107, 0
v_mov_b32 v108, 0
v_mov_b32 v109, 0
v_mov_b32 v110, 0
v_mov_b32 v111, 0
v_mov_b32 v112, 0
v_mov_b32 v113, 0
v_mov_b32 v114, 0
v_mov_b32 v115, 0
v_mov_b32 v116, 0
v_mov_b32 v117, 0
v_mov_b32 v118, 0
v_mov_b32 v119, 0
v_mov_b32 v120, 0
v_mov_b32 v121, 0
v_mov_b32 v122, 0
v_mov_b32 v123, 0
v_mov_b32 v124, 0
v_mov_b32 v125, 0
v_mov_b32 v126, 0
v_mov_b32 v127, 0
v_mov_b32 v128, 0
v_mov_b32 v129, 0
v_mov_b32 v130, 0
v_mov_b32 v131, 0
v_mov_b32 v132, 0
v_mov_b32 v133, 0
v_mov_b32 v134, 0
v_mov_b32 v135, 0
v_mov_b32 v136, 0
v_mov_b32 v137, 0
v_mov_b32 v138, 0
v_mov_b32 v139, 0
s_barrier
s_and_b32 s34, s3, 3
s_mul_i32 s34, s34, 5120
s_add_u32 s34, s34, 24911872
s_mov_b32 s35, 16
Lk2_slow:
buffer_load_dwordx4 v[28:31], v2, s[8:11], s34 offen sc1
buffer_load_dwordx2 v[32:33], v217, s[8:11], s34 offen offset:1024 sc1
s_mov_b32 exec_lo, 0xfffff
s_mov_b32 exec_hi, 0xfffff
buffer_load_dwordx4 v[36:39], v4, s[8:11], s34 offen offset:1280 sc1
buffer_load_dwordx4 v[40:43], v4, s[8:11], s34 offen offset:1920 sc1
s_mov_b64 exec, -1
s_bitcmp1_b32 s35, 0
s_mov_b32 s28, 2560
s_cselect_b32 s28, 17920, s28
s_add_u32 s34, s34, s28
v_mov_b32 v6, 0x3f803f80
s_waitcnt vmcnt(0)
v_cndmask_b32 v32, v6, v32, s[32:33]
v_cndmask_b32 v33, 0, v33, s[32:33]
v_mfma_f32_32x32x16_bf16 v[140:155], v[28:31], v[8:11], 0
s_nop 0
v_mfma_f32_32x32x8bf16_1k v[140:155], v[32:33], v[204:205], v[140:155]
s_nop 11
v_exp_f32 v140, v140
v_exp_f32 v141, v141
v_exp_f32 v142, v142
v_exp_f32 v143, v143
v_exp_f32 v144, v144
v_exp_f32 v145, v145
v_exp_f32 v146, v146
v_exp_f32 v147, v147
v_exp_f32 v148, v148
v_exp_f32 v149, v149
v_exp_f32 v150, v150
v_exp_f32 v151, v151
v_exp_f32 v152, v152
v_exp_f32 v153, v153
v_exp_f32 v154, v154
v_exp_f32 v155, v155
v_cvt_pk_bf16_f32 v60, v140, v141
v_cvt_pk_bf16_f32 v61, v142, v143
v_cvt_pk_bf16_f32 v62, v144, v145
v_cvt_pk_bf16_f32 v63, v146, v147
v_cvt_pk_bf16_f32 v64, v148, v149
v_cvt_pk_bf16_f32 v65, v150, v151
v_cvt_pk_bf16_f32 v66, v152, v153
v_cvt_pk_bf16_f32 v67, v154, v155
v_mfma_f32_32x32x16_bf16 v[76:91], v[36:39], v[60:63], v[76:91]
s_nop 0
v_mfma_f32_32x32x16_bf16 v[76:91], v[40:43], v[64:67], v[76:91]
v_mfma_f32_32x32x16_bf16 v[140:155], v[28:31], v[12:15], 0
v_mfma_f32_32x32x8bf16_1k v[140:155], v[32:33], v[206:207], v[140:155]
s_nop 11
v_exp_f32 v140, v140
v_exp_f32 v141, v141
v_exp_f32 v142, v142
v_exp_f32 v143, v143
v_exp_f32 v144, v144
v_exp_f32 v145, v145
v_exp_f32 v146, v146
v_exp_f32 v147, v147
v_exp_f32 v148, v148
v_exp_f32 v149, v149
v_exp_f32 v150, v150
v_exp_f32 v151, v151
v_exp_f32 v152, v152
v_exp_f32 v153, v153
v_exp_f32 v154, v154
v_exp_f32 v155, v155
v_cvt_pk_bf16_f32 v60, v140, v141
v_cvt_pk_bf16_f32 v61, v142, v143
v_cvt_pk_bf16_f32 v62, v144, v145
v_cvt_pk_bf16_f32 v63, v146, v147
v_cvt_pk_bf16_f32 v64, v148, v149
v_cvt_pk_bf16_f32 v65, v150, v151
v_cvt_pk_bf16_f32 v66, v152, v153
v_cvt_pk_bf16_f32 v67, v154, v155
v_mfma_f32_32x32x16_bf16 v[92:107], v[36:39], v[60:63], v[92:107]
s_nop 0
v_mfma_f32_32x32x16_bf16 v[92:107], v[40:43], v[64:67], v[92:107]
v_mfma_f32_32x32x16_bf16 v[140:155], v[28:31], v[16:19], 0
v_mfma_f32_32x32x8bf16_1k v[140:155], v[32:33], v[208:209], v[140:155]
s_nop 11
v_exp_f32 v140, v140
v_exp_f32 v141, v141
v_exp_f32 v142, v142
v_exp_f32 v143, v143
v_exp_f32 v144, v144
v_exp_f32 v145, v145
v_exp_f32 v146, v146
v_exp_f32 v147, v147
v_exp_f32 v148, v148
v_exp_f32 v149, v149
v_exp_f32 v150, v150
v_exp_f32 v151, v151
v_exp_f32 v152, v152
v_exp_f32 v153, v153
v_exp_f32 v154, v154
v_exp_f32 v155, v155
v_cvt_pk_bf16_f32 v60, v140, v141
v_cvt_pk_bf16_f32 v61, v142, v143
v_cvt_pk_bf16_f32 v62, v144, v145
v_cvt_pk_bf16_f32 v63, v146, v147
v_cvt_pk_bf16_f32 v64, v148, v149
v_cvt_pk_bf16_f32 v65, v150, v151
v_cvt_pk_bf16_f32 v66, v152, v153
v_cvt_pk_bf16_f32 v67, v154, v155
v_mfma_f32_32x32x16_bf16 v[108:123], v[36:39], v[60:63], v[108:123]
s_nop 0
v_mfma_f32_32x32x16_bf16 v[108:123], v[40:43], v[64:67], v[108:123]
v_mfma_f32_32x32x16_bf16 v[140:155], v[28:31], v[20:23], 0
v_mfma_f32_32x32x8bf16_1k v[140:155], v[32:33], v[210:211], v[140:155]
s_nop 11
v_exp_f32 v140, v140
v_exp_f32 v141, v141
v_exp_f32 v142, v142
v_exp_f32 v143, v143
v_exp_f32 v144, v144
v_exp_f32 v145, v145
v_exp_f32 v146, v146
v_exp_f32 v147, v147
v_exp_f32 v148, v148
v_exp_f32 v149, v149
v_exp_f32 v150, v150
v_exp_f32 v151, v151
v_exp_f32 v152, v152
v_exp_f32 v153, v153
v_exp_f32 v154, v154
v_exp_f32 v155, v155
v_cvt_pk_bf16_f32 v60, v140, v141
v_cvt_pk_bf16_f32 v61, v142, v143
v_cvt_pk_bf16_f32 v62, v144, v145
v_cvt_pk_bf16_f32 v63, v146, v147
v_cvt_pk_bf16_f32 v64, v148, v149
v_cvt_pk_bf16_f32 v65, v150, v151
v_cvt_pk_bf16_f32 v66, v152, v153
v_cvt_pk_bf16_f32 v67, v154, v155
v_mfma_f32_32x32x16_bf16 v[124:139], v[36:39], v[60:63], v[124:139]
s_nop 0
v_mfma_f32_32x32x16_bf16 v[124:139], v[40:43], v[64:67], v[124:139]
s_sub_u32 s35, s35, 1
s_cmp_lg_u32 s35, 0
s_cbranch_scc1 Lk2_slow
s_branch Lk2_red
Lk2_xblk:
s_waitcnt lgkmcnt(0)
s_barrier
s_lshl_b32 s24, s20, 2
s_add_u32 s24, s24, s3
v_lshrrev_b32 v230, 4, v1
v_and_b32 v231, 15, v1
v_mul_u32_u24 v231, 1280, v231
v_lshl_add_u32 v231, v230, 3, v231
s_mul_i32 s28, s24, 20480
s_mul_i32 s29, s21, 160
s_add_u32 s28, s28, s29
buffer_load_dwordx2 v[220:221], v231, s[12:15], s28 offen offset:0
buffer_load_dwordx2 v[222:223], v231, s[12:15], s28 offen offset:32
buffer_load_dwordx2 v[224:225], v231, s[12:15], s28 offen offset:64
buffer_load_dwordx2 v[226:227], v231, s[12:15], s28 offen offset:96
buffer_load_dwordx2 v[228:229], v231, s[12:15], s28 offen offset:128
s_branch Lk2_ret5
Lk2_blk0:
s_sub_u32 s47, s46, 80
s_cmp_lt_u32 s47, 136
s_cselect_b32 s40, 1, 0
s_cmp_lt_u32 s44, 20
s_cselect_b32 s40, 2, s40
s_cselect_b32 s47, s46, s47
s_sub_u32 s28, s46, 160
s_cmp_ge_u32 s44, 60
s_cselect_b32 s40, 2, s40
s_cselect_b32 s47, s28, s47
s_cmp_lg_u32 s40, 2
s_cbranch_scc1 Lfw_60
s_load_dwordx2 s[16:17], s[0:1], 48
s_mov_b32 s18, 1966080
s_mov_b32 s19, 0x20000
s_load_dwordx2 s[48:49], s[0:1], 56
s_mov_b32 s50, 1966080
s_mov_b32 s51, 0x20000
v_bfe_u32 v220, v1, 3, 2
v_lshlrev_b32 v220, 3, v220
v_lshrrev_b32 v221, 5, v1
v_lshl_add_u32 v220, v221, 2, v220
v_bfe_u32 v221, v1, 1, 2
v_add_u32 v220, v220, v221
v_mul_u32_u24 v220, 3072, v220
v_and_b32 v221, 1, v1
v_lshl_add_u32 v222, v221, 4, v220
s_mul_i32 s33, s43, 491520
s_lshl_b32 s28, s47, 5
s_add_u32 s33, s33, s28
s_mul_i32 s29, s47, 10923
s_lshr_b32 s29, s29, 16
s_mul_i32 s30, s29, 6
s_sub_u32 s30, s47, s30
s_mul_i32 s29, s29, 251904
s_add_u32 s29, s29, 3997696
s_lshr_b32 s31, s30, 1
s_mul_i32 s31, s31, 81920
s_and_b32 s28, s30, 1
s_lshl_b32 s28, s28, 10
s_add_u32 s31, s31, s28
s_mul_i32 s28, s43, 20480
s_add_u32 s31, s31, s28
s_add_u32 s31, s31, s29
s_add_u32 s32, s31, 6144
s_lshl_b32 s30, s30, 10
s_add_u32 s38, s30, s29
s_branch Lfjoin_61
Lfw_60:
s_min_u32 s27, s47, 135
s_lshr_b32 s27, s27, 1
s_cmp_lt_u32 s27, 20
s_cselect_b32 s28, 32, 64
s_load_dwordx2 s[16:17], s[0:1], s28
s_mov_b32 s18, 1966080
s_cselect_b32 s18, 819200, s18
s_mov_b32 s19, 0x20000
s_mov_b32 s29, 2031616
s_cselect_b32 s29, 1212416, s29
s_cselect_b32 s30, 20, 48
s_cselect_b32 s31, 0, 20
s_sub_u32 s31, s27, s31
s_mul_i32 s28, s31, 21846
s_lshr_b32 s28, s28, 16
s_mul_i32 s33, s28, 3
s_sub_u32 s33, s31, s33
s_lshl_b32 s33, s33, 4
s_add_u32 s33, s33, s28
s_cmp_lt_u32 s27, 20
s_cselect_b32 s33, s31, s33
s_and_b32 s28, s47, 1
s_lshl_b32 s28, s28, 2
s_add_u32 s28, s28, s43
s_mul_i32 s30, s30, s28
s_add_u32 s30, s30, s33
s_mul_i32 s30, s30, 5120
s_add_u32 s32, s30, s29
s_mul_i32 s31, s31, 40960
s_mul_i32 s28, s28, 160
s_add_u32 s33, s31, s28
v_bfe_u32 v220, v1, 3, 2
v_lshlrev_b32 v220, 3, v220
v_lshrrev_b32 v221, 5, v1
v_lshl_add_u32 v220, v221, 2, v220
v_bfe_u32 v221, v1, 1, 2
v_add_u32 v220, v220, v221
v_mul_u32_u24 v220, 1280, v220
v_and_b32 v221, 1, v1
v_lshl_add_u32 v222, v221, 4, v220
Lfjoin_61:
s_mul_i32 s7, s43, 5120
s_add_u32 s6, s7, 24993792
s_waitcnt vmcnt(0) lgkmcnt(0)
v_cmp_ne_u32 vcc, s42, v204
s_nop 1
s_cmp_eq_u64 vcc, 0
s_cselect_b32 s41, 1, 0
s_mul_i32 s27, s43, 10240
s_add_u32 s27, s27, 61440
s_cmp_lg_u32 s40, 2
s_cbranch_scc1 Lng_62
s_add_u32 m0, s27, 0
s_nop 0
buffer_load_dwordx4 v222, s[16:19], s33 offen lds
s_add_u32 m0, s27, 1024
s_nop 0
buffer_load_dwordx4 v222, s[48:51], s33 offen lds
s_add_u32 s33, s33, 98304
s_add_u32 m0, s27, 2048
s_nop 0
buffer_load_dwordx4 v222, s[16:19], s33 offen lds
s_add_u32 m0, s27, 3072
s_nop 0
buffer_load_dwordx4 v222, s[48:51], s33 offen lds
s_add_u32 s33, s33, 98304
s_branch Lnw_63
Lng_62:
s_mul_i32 s27, s43, 5120
s_add_u32 s27, s27, 61440
s_cmp_lt_u32 s44, 20
s_cbranch_scc1 Lnounit_64
s_cmp_ge_u32 s44, 60
s_cbranch_scc1 Lnounit_64
s_load_dwordx2 s[48:49], s[0:1], 80
s_mov_b32 s50, 4915200
s_mov_b32 s51, 0x20000
v_bfe_u32 v220, v1, 3, 2
v_lshlrev_b32 v220, 3, v220
v_lshrrev_b32 v221, 5, v1
v_lshl_add_u32 v220, v221, 2, v220
v_bfe_u32 v221, v1, 1, 2
v_add_u32 v220, v220, v221
v_mul_u32_u24 v220, 7680, v220
v_and_b32 v221, 1, v1
v_lshl_add_u32 v223, v221, 4, v220
s_lshl_b32 s28, s46, 5
s_mul_i32 s29, s43, 1228800
s_add_u32 s25, s28, s29
s_waitcnt lgkmcnt(0)
s_add_u32 m0, s27, 20480
s_nop 0
buffer_load_dwordx4 v223, s[48:51], s25 offen lds
s_add_u32 s25, s25, 245760
s_add_u32 m0, s27, 21504
s_nop 0
buffer_load_dwordx4 v223, s[48:51], s25 offen lds
s_add_u32 s25, s25, 245760
s_add_u32 m0, s27, 22528
s_nop 0
buffer_load_dwordx4 v223, s[48:51], s25 offen lds
s_add_u32 s25, s25, 245760
s_add_u32 m0, s27, 23552
s_nop 0
buffer_load_dwordx4 v223, s[48:51], s25 offen lds
s_add_u32 s25, s25, 245760
Lnounit_64:
Lnw_63:
s_waitcnt lgkmcnt(0)
s_barrier
s_branch Lk2_ret0
Lk2_blk1:
s_add_u32 m0, s7, 122880
s_nop 0
buffer_load_dwordx4 v2, s[8:11], s6 offen sc1 lds
buffer_load_dwordx4 v2, s[8:11], s6 offen offset:1024 sc1 lds
buffer_load_dwordx4 v2, s[8:11], s6 offen offset:2048 sc1 lds
buffer_load_dwordx4 v2, s[8:11], s6 offen offset:3072 sc1 lds
s_add_u32 s28, s6, 4096
s_add_u32 m0, s7, 126976
s_nop 0
buffer_load_dwordx4 v2, s[8:11], s28 offen sc1 lds
s_add_u32 s6, s6, 20480
s_mul_i32 s27, s43, 10240
s_add_u32 s27, s27, 61440
s_cmp_lg_u32 s40, 2
s_cbranch_scc1 Lng_67
s_add_u32 m0, s27, 4096
s_nop 0
buffer_load_dwordx4 v222, s[16:19], s33 offen lds
s_add_u32 m0, s27, 5120
s_nop 0
buffer_load_dwordx4 v222, s[48:51], s33 offen lds
s_add_u32 s33, s33, 98304
s_add_u32 m0, s27, 6144
s_nop 0
buffer_load_dwordx4 v222, s[16:19], s33 offen lds
s_branch Lnw_68
Lng_67:
s_mul_i32 s27, s43, 5120
s_add_u32 s27, s27, 61440
s_cmp_lt_u32 s44, 20
s_cbranch_scc1 Lnounit_69
s_cmp_ge_u32 s44, 60
s_cbranch_scc1 Lnounit_69
s_add_u32 m0, s27, 24576
s_nop 0
buffer_load_dwordx4 v223, s[48:51], s25 offen lds
Lnounit_69:
s_cmp_lg_u32 s40, 1
s_cbranch_scc1 Lnw_68
s_add_u32 m0, s27, 0
s_nop 0
buffer_load_dwordx4 v222, s[16:19], s33 offen lds
s_add_u32 s33, s33, 32
s_add_u32 m0, s27, 1024
s_nop 0
buffer_load_dwordx4 v222, s[16:19], s33 offen lds
s_add_u32 s33, s33, 32
Lnw_68:
s_waitcnt lgkmcnt(0)
s_barrier
s_branch Lk2_ret1
Lk2_blk2:
s_cmp_eq_u32 s40, 2
s_cbranch_scc1 Lbgu_70
s_cmp_eq_u32 s40, 1
s_cbranch_scc1 Lbj_71a
s_waitcnt vmcnt(0)
Lbj_71a:
s_waitcnt vmcnt(2)
s_cmp_lt_u32 s44, 20
s_cbranch_scc1 Lnopart_72
s_cmp_ge_u32 s44, 60
s_cbranch_scc1 Lnopart_72
v_lshrrev_b32 v220, 4, v1
s_mul_i32 s28, s43, 320
s_add_u32 s28, s28, 160768
v_lshl_add_u32 v220, v220, 4, s28
s_mul_i32 s28, s43, 5120
s_add_u32 s28, s28, 81920
v_lshl_add_u32 v221, v1, 3, s28
s_nop 1
ds_read_b128 v[232:235], v220 offset:0
ds_read_b64_tr_b16 v[44:45], v221 offset:0
ds_read_b64_tr_b16 v[46:47], v221 offset:512
ds_read_b128 v[236:239], v220 offset:64
ds_read_b64_tr_b16 v[48:49], v221 offset:1024
ds_read_b64_tr_b16 v[50:51], v221 offset:1536
ds_read_b128 v[240:243], v220 offset:128
ds_read_b64_tr_b16 v[52:53], v221 offset:2048
ds_read_b64_tr_b16 v[54:55], v221 offset:2560
ds_read_b128 v[244:247], v220 offset:192
ds_read_b64_tr_b16 v[56:57], v221 offset:3072
ds_read_b64_tr_b16 v[58:59], v221 offset:3584
ds_read_b128 v[248:251], v220 offset:256
ds_read_b64_tr_b16 v[228:229], v221 offset:4096
ds_read_b64_tr_b16 v[230:231], v221 offset:4608
s_waitcnt lgkmcnt(12)
v_mfma_f32_16x16x32_bf16 v[252:255], v[44:47], v[232:235], 0
s_waitcnt lgkmcnt(9)
v_mfma_f32_16x16x32_bf16 v[252:255], v[48:51], v[236:239], v[252:255]
s_waitcnt lgkmcnt(6)
v_mfma_f32_16x16x32_bf16 v[252:255], v[52:55], v[240:243], v[252:255]
s_waitcnt lgkmcnt(3)
v_mfma_f32_16x16x32_bf16 v[252:255], v[56:59], v[244:247], v[252:255]
s_waitcnt lgkmcnt(0)
v_mfma_f32_16x16x32_bf16 v[252:255], v[228:231], v[248:251], v[252:255]
v_lshrrev_b32 v220, 4, v1
s_lshl_b32 s28, s43, 6
s_add_u32 s28, s28, 143392
v_lshl_add_u32 v220, v220, 4, s28
s_mov_b32 exec_lo, 0x10001
s_mov_b32 exec_hi, 0x10001
s_nop 1
ds_write_b128 v220, v[252:255]
s_mov_b64 exec, -1
Lnopart_72:
s_branch Lbj_71
Lbgu_70:
Lbj_71:
s_add_u32 m0, s7, 0
s_nop 0
buffer_load_dwordx4 v2, s[8:11], s6 offen sc1 lds
buffer_load_dwordx4 v2, s[8:11], s6 offen offset:1024 sc1 lds
buffer_load_dwordx4 v2, s[8:11], s6 offen offset:2048 sc1 lds
buffer_load_dwordx4 v2, s[8:11], s6 offen offset:3072 sc1 lds
s_add_u32 s28, s6, 4096
s_add_u32 m0, s7, 4096
s_nop 0
buffer_load_dwordx4 v2, s[8:11], s28 offen sc1 lds
s_add_u32 s6, s6, 20480
s_mul_i32 s27, s43, 10240
s_add_u32 s27, s27, 61440
s_cmp_lg_u32 s40, 2
s_cbranch_scc1 Lng_73
s_add_u32 m0, s27, 7168
s_nop 0
buffer_load_dwordx4 v222, s[48:51], s33 offen lds
s_add_u32 s33, s33, 98304
s_add_u32 m0, s27, 8192
s_nop 0
buffer_load_dwordx4 v222, s[16:19], s33 offen lds
s_add_u32 m0, s27, 9216
s_nop 0
buffer_load_dwordx4 v222, s[48:51], s33 offen lds
s_branch Lnw_74
Lng_73:
s_mul_i32 s27, s43, 5120
s_add_u32 s27, s27, 61440
s_cmp_lg_u32 s40, 1
s_cbranch_scc1 Lnw_74
s_add_u32 m0, s27, 2048
s_nop 0
buffer_load_dwordx4 v222, s[16:19], s33 offen lds
s_add_u32 s33, s33, 32
s_add_u32 m0, s27, 3072
s_nop 0
buffer_load_dwordx4 v222, s[16:19], s33 offen lds
s_add_u32 s33, s33, 32
s_add_u32 m0, s27, 4096
s_nop 0
buffer_load_dwordx4 v222, s[16:19], s33 offen lds
Lnw_74:
s_waitcnt lgkmcnt(0)
s_barrier
s_branch Lk2_ret2
Lk2_blk3:
s_cmp_eq_u32 s40, 2
s_cbranch_scc1 Lbgu_76
s_waitcnt vmcnt(0)
s_cmp_lt_u32 s44, 20
s_cbranch_scc1 Lb2ns_78
s_cmp_ge_u32 s44, 60
s_cbranch_scc1 Lb2ns_78
s_cmp_lg_u32 s3, 5
s_cbranch_scc1 Lb2ns_78
v_and_b32 v220, 48, v1
v_add_u32 v220, 143392, v220
ds_read_b128 v[44:47], v220 offset:0
ds_read_b128 v[48:51], v220 offset:64
ds_read_b128 v[52:55], v220 offset:128
ds_read_b128 v[56:59], v220 offset:192
s_waitcnt lgkmcnt(0)
v_add_f32 v44, v44, v48
v_add_f32 v52, v52, v56
v_add_f32 v45, v45, v49
v_add_f32 v53, v53, v57
v_add_f32 v46, v46, v50
v_add_f32 v54, v54, v58
v_add_f32 v47, v47, v51
v_add_f32 v55, v55, v59
v_add_f32 v44, v44, v52
v_add_f32 v45, v45, v53
v_add_f32 v46, v46, v54
v_add_f32 v47, v47, v55
v_cvt_pk_bf16_f32 v48, v44, v45
v_cvt_pk_bf16_f32 v50, v46, v47
s_mul_i32 s30, s46, 1639
s_lshr_b32 s30, s30, 16
s_cmp_eq_u32 s30, 1
s_cselect_b32 s31, 1, 0
s_cmp_eq_u32 s30, 4
s_cselect_b32 s31, 1, s31
s_cmp_eq_u32 s31, 0
s_cbranch_scc1 Lnoone_79
v_lshlrev_b32 v44, 16, v48
v_and_b32 v45, 0xffff0000, v48
v_add_f32 v44, 1.0, v44
v_add_f32 v45, 1.0, v45
v_cvt_pk_bf16_f32 v48, v44, v45
v_lshlrev_b32 v44, 16, v50
v_and_b32 v45, 0xffff0000, v50
v_add_f32 v44, 1.0, v44
v_add_f32 v45, 1.0, v45
v_cvt_pk_bf16_f32 v50, v44, v45
Lnoone_79:
v_mov_b32 v49, s23
v_mov_b32 v51, s23
s_lshl_b32 s30, s46, 7
s_add_u32 s30, s30, 24875008
v_and_b32 v220, 48, v1
s_mov_b32 exec_lo, 0x10001
s_mov_b32 exec_hi, 0x10001
buffer_store_dwordx4 v[48:51], v220, s[8:11], s30 offen sc1
s_mov_b64 exec, -1
Lb2ns_78:
s_cmp_lg_u32 s40, 1
s_cbranch_scc1 Lb1d_80
s_mul_i32 s28, s43, 5120
s_add_u32 s28, s28, 61440
v_lshl_add_u32 v220, v1, 3, s28
ds_read_b64_tr_b16 v[224:225], v220 offset:0
ds_read_b64_tr_b16 v[226:227], v220 offset:512
ds_read_b64_tr_b16 v[228:229], v220 offset:1024
ds_read_b64_tr_b16 v[230:231], v220 offset:1536
ds_read_b64_tr_b16 v[232:233], v220 offset:2048
ds_read_b64_tr_b16 v[234:235], v220 offset:2560
ds_read_b64_tr_b16 v[236:237], v220 offset:3072
ds_read_b64_tr_b16 v[238:239], v220 offset:3584
ds_read_b64_tr_b16 v[240:241], v220 offset:4096
ds_read_b64_tr_b16 v[242:243], v220 offset:4608
s_waitcnt lgkmcnt(8)
buffer_store_dwordx4 v[224:227], v2, s[8:11], s32 offen offset:0 sc1
s_waitcnt lgkmcnt(6)
buffer_store_dwordx4 v[228:231], v2, s[8:11], s32 offen offset:1024 sc1
s_waitcnt lgkmcnt(4)
buffer_store_dwordx4 v[232:235], v2, s[8:11], s32 offen offset:2048 sc1
s_waitcnt lgkmcnt(2)
buffer_store_dwordx4 v[236:239], v2, s[8:11], s32 offen offset:3072 sc1
s_waitcnt lgkmcnt(0)
s_add_u32 s32, s32, 4096
buffer_store_dwordx4 v[240:243], v2, s[8:11], s32 offen offset:0 sc1
Lb1d_80:
s_branch Lbj_77
Lbgu_76:
s_waitcnt vmcnt(8)
v_bfe_u32 v221, v1, 4, 1
v_lshlrev_b32 v220, 10, v221
v_bfe_u32 v221, v1, 5, 1
v_lshl_add_u32 v220, v221, 7, v220
v_bfe_u32 v221, v1, 2, 2
v_lshl_add_u32 v220, v221, 5, v220
v_bfe_u32 v221, v1, 0, 1
v_lshl_add_u32 v220, v221, 4, v220
v_bfe_u32 v221, v1, 1, 1
v_lshl_add_u32 v220, v221, 3, v220
s_mul_i32 s28, s43, 10240
s_add_u32 s28, s28, 61440
v_add_u32 v220, s28, v220
ds_read_b64_tr_b16 v[224:225], v220 offset:0
ds_read_b64_tr_b16 v[226:227], v220 offset:512
ds_read_b64_tr_b16 v[228:229], v220 offset:256
ds_read_b64_tr_b16 v[230:231], v220 offset:768
ds_read_b64_tr_b16 v[232:233], v220 offset:2048
ds_read_b64_tr_b16 v[234:235], v220 offset:2560
ds_read_b64_tr_b16 v[236:237], v220 offset:2304
ds_read_b64_tr_b16 v[238:239], v220 offset:2816
ds_read_b64_tr_b16 v[240:241], v220 offset:4096
ds_read_b64_tr_b16 v[242:243], v220 offset:4608
ds_read_b64_tr_b16 v[244:245], v220 offset:4352
ds_read_b64_tr_b16 v[246:247], v220 offset:4864
s_waitcnt lgkmcnt(10)
buffer_store_dwordx4 v[224:227], v2, s[8:11], s32 offen offset:0 sc1
s_waitcnt lgkmcnt(8)
buffer_store_dwordx4 v[228:231], v2, s[8:11], s32 offen offset:2048 sc1
s_add_u32 s32, s32, 4096
s_waitcnt lgkmcnt(6)
buffer_store_dwordx4 v[232:235], v2, s[8:11], s32 offen offset:0 sc1
s_waitcnt lgkmcnt(4)
buffer_store_dwordx4 v[236:239], v2, s[8:11], s32 offen offset:2048 sc1
s_add_u32 s32, s32, 4096
s_waitcnt lgkmcnt(2)
buffer_store_dwordx4 v[240:243], v2, s[8:11], s32 offen offset:0 sc1
s_waitcnt lgkmcnt(0)
buffer_store_dwordx4 v[244:247], v2, s[8:11], s32 offen offset:2048 sc1
s_add_u32 s32, s32, 4096
Lbj_77:
s_add_u32 m0, s7, 20480
s_nop 0
buffer_load_dwordx4 v2, s[8:11], s6 offen sc1 lds
buffer_load_dwordx4 v2, s[8:11], s6 offen offset:1024 sc1 lds
buffer_load_dwordx4 v2, s[8:11], s6 offen offset:2048 sc1 lds
buffer_load_dwordx4 v2, s[8:11], s6 offen offset:3072 sc1 lds
s_add_u32 s28, s6, 4096
s_add_u32 m0, s7, 24576
s_nop 0
buffer_load_dwordx4 v2, s[8:11], s28 offen sc1 lds
s_add_u32 s6, s6, 20480
s_waitcnt lgkmcnt(0)
s_barrier
s_branch Lk2_ret3
Lk2_blk4:
s_cmp_eq_u32 s40, 2
s_cbranch_scc1 Lbgu_81
s_waitcnt vmcnt(5)
s_cmp_eq_u32 s40, 0
s_cbranch_scc1 Lb2d_83
v_mov_b32 v220, 159760
v_mov_b32 v221, 1
s_mov_b64 exec, 1
ds_add_rtn_u32 v221, v220, v221
s_mov_b64 exec, -1
s_waitcnt lgkmcnt(0)
v_readfirstlane_b32 s28, v221
s_nop 1
s_cmp_lg_u32 s28, 3
s_cbranch_scc1 Lb2d_83
s_add_u32 s28, s47, 96
s_lshl_b32 s28, s28, 2
s_add_u32 s28, s28, 24807424
s_mov_b64 exec, 1
v_mov_b32 v220, 0
v_mov_b32 v221, s23
buffer_store_dword v221, v220, s[8:11], s28 offen sc1
s_mov_b64 exec, -1
Lb2d_83:
s_branch Lbj_82
Lbgu_81:
s_waitcnt vmcnt(5)
v_bfe_u32 v221, v1, 4, 1
v_lshlrev_b32 v220, 10, v221
v_bfe_u32 v221, v1, 5, 1
v_lshl_add_u32 v220, v221, 7, v220
v_bfe_u32 v221, v1, 2, 2
v_lshl_add_u32 v220, v221, 5, v220
v_bfe_u32 v221, v1, 0, 1
v_lshl_add_u32 v220, v221, 4, v220
v_bfe_u32 v221, v1, 1, 1
v_lshl_add_u32 v220, v221, 3, v220
s_mul_i32 s28, s43, 10240
s_add_u32 s28, s28, 61440
v_add_u32 v220, s28, v220
ds_read_b64_tr_b16 v[224:225], v220 offset:6144
ds_read_b64_tr_b16 v[226:227], v220 offset:6656
ds_read_b64_tr_b16 v[228:229], v220 offset:6400
ds_read_b64_tr_b16 v[230:231], v220 offset:6912
ds_read_b64_tr_b16 v[232:233], v220 offset:8192
ds_read_b64_tr_b16 v[234:235], v220 offset:8704
ds_read_b64_tr_b16 v[236:237], v220 offset:8448
ds_read_b64_tr_b16 v[238:239], v220 offset:8960
s_waitcnt lgkmcnt(6)
buffer_store_dwordx4 v[224:227], v2, s[8:11], s32 offen offset:0 sc1
s_waitcnt lgkmcnt(4)
buffer_store_dwordx4 v[228:231], v2, s[8:11], s32 offen offset:2048 sc1
s_add_u32 s32, s32, 4096
s_waitcnt lgkmcnt(2)
buffer_store_dwordx4 v[232:235], v2, s[8:11], s32 offen offset:0 sc1
s_waitcnt lgkmcnt(0)
buffer_store_dwordx4 v[236:239], v2, s[8:11], s32 offen offset:2048 sc1
s_add_u32 s32, s32, 4096
Lbj_82:
s_cmp_lg_u32 s40, 2
s_cbranch_scc1 Lnoask_84
v_lshrrev_b32 v220, 2, v1
v_and_b32 v221, 3, v1
v_lshlrev_b32 v220, 7, v220
v_lshl_add_u32 v220, v221, 4, v220
s_mul_i32 s28, s43, 1280
s_add_u32 s28, s28, 24890368
s_add_u32 s29, s28, 5120
s_mov_b32 exec_hi, 0xff
buffer_load_dwordx4 v[44:47], v220, s[8:11], s28 offen sc1
buffer_load_dwordx4 v[48:51], v220, s[8:11], s29 offen sc1
s_mov_b32 exec_hi, -1
Lnoask_84:
s_add_u32 m0, s7, 40960
s_nop 0
buffer_load_dwordx4 v2, s[8:11], s6 offen sc1 lds
buffer_load_dwordx4 v2, s[8:11], s6 offen offset:1024 sc1 lds
buffer_load_dwordx4 v2, s[8:11], s6 offen offset:2048 sc1 lds
buffer_load_dwordx4 v2, s[8:11], s6 offen offset:3072 sc1 lds
s_add_u32 s28, s6, 4096
s_add_u32 m0, s7, 45056
s_nop 0
buffer_load_dwordx4 v2, s[8:11], s28 offen sc1 lds
s_add_u32 s6, s6, 20480
s_cmp_eq_u32 s41, 0
s_cbranch_scc1 Lnoown_85
s_lshl_b32 s28, s20, 2
s_add_u32 s28, s28, s43
s_mul_i32 s29, s28, 20480
s_mul_i32 s30, s21, 2560
s_add_u32 s29, s29, s30
s_add_u32 s29, s29, 10649600
v_lshlrev_b32 v228, 7, v1
v_add_u32 v228, s29, v228
s_lshr_b32 s29, s28, 1
s_mul_i32 s29, s29, 40960
s_mul_i32 s30, s21, 5120
s_add_u32 s29, s29, s30
s_and_b32 s30, s28, 1
s_lshl_b32 s30, s30, 8
s_add_u32 s29, s29, s30
s_add_u32 s29, s29, 15892480
v_subrev_u32 v229, 20, v1
v_lshrrev_b32 v230, 1, v229
v_lshlrev_b32 v230, 9, v230
v_and_b32 v229, 1, v229
v_lshl_add_u32 v230, v229, 7, v230
v_add_u32 v230, s29, v230
v_cmp_lt_u32 vcc, 19, v1
s_nop 1
v_cndmask_b32 v228, v228, v230, vcc
s_lshl_b32 s29, s28, 10
s_lshl_b32 s30, s21, 7
s_add_u32 s29, s29, s30
s_add_u32 s29, s29, 32768
v_mov_b32 v230, s29
v_cmp_eq_u32 vcc, 40, v1
s_nop 1
v_cndmask_b32 v228, v228, v230, vcc
s_lshl_b32 s29, s20, 8
s_and_b32 s30, s43, 1
s_lshl_b32 s30, s30, 7
s_add_u32 s29, s29, s30
s_add_u32 s29, s29, 24809472
v_mov_b32 v230, s29
v_cmp_eq_u32 vcc, 41, v1
s_nop 1
v_cndmask_b32 v228, v228, v230, vcc
s_lshr_b32 s29, s28, 1
s_lshl_b32 s29, s29, 7
s_add_u32 s29, s29, 24817664
v_mov_b32 v230, s29
v_cmp_eq_u32 vcc, 42, v1
s_nop 1
v_cndmask_b32 v228, v228, v230, vcc
s_lshr_b32 s29, s28, 1
s_lshl_b32 s29, s29, 8
s_and_b32 s30, s28, 1
s_lshl_b32 s30, s30, 7
s_add_u32 s29, s29, s30
s_add_u32 s29, s29, 24825856
v_mov_b32 v230, s29
v_cmp_eq_u32 vcc, 43, v1
s_nop 1
v_cndmask_b32 v228, v228, v230, vcc
s_mov_b32 exec_lo, 0xffffffff
s_mov_b32 exec_hi, 0xfff
buffer_load_dword v223, v228, s[8:11], 0 offen
s_mov_b64 exec, -1
Lnoown_85:
s_waitcnt lgkmcnt(0)
s_barrier
s_branch Lk2_ret4
Lk2_blk5:
s_cmp_eq_u32 s40, 2
s_cbranch_scc1 Lbgu_86
s_waitcnt vmcnt(5)
s_branch Lbj_87
Lbgu_86:
s_waitcnt vmcnt(5)
v_lshrrev_b32 v220, 2, v1
v_and_b32 v221, 3, v1
v_lshlrev_b32 v220, 7, v220
v_lshl_add_u32 v220, v221, 4, v220
s_mul_i32 s28, s43, 1280
s_add_u32 s28, s28, 24890368
s_add_u32 s29, s28, 5120
v_mov_b32 v224, v44
v_mov_b32 v225, v45
v_mov_b32 v226, v46
v_mov_b32 v227, v47
v_mov_b32 v228, v48
v_mov_b32 v229, v49
v_mov_b32 v230, v50
v_mov_b32 v231, v51
s_mov_b32 s27, 524288
s_branch Lgchk_90
Lgpoll_88:
s_mov_b32 exec_lo, 0xffffffff
s_mov_b32 exec_hi, 0xff
buffer_load_dwordx4 v[224:227], v220, s[8:11], s28 offen offset:0 sc1
s_mov_b64 exec, -1
s_mov_b32 exec_lo, 0xffffffff
s_mov_b32 exec_hi, 0xff
buffer_load_dwordx4 v[228:231], v220, s[8:11], s29 offen offset:0 sc1
s_mov_b64 exec, -1
s_waitcnt vmcnt(0)
Lgchk_90:
s_mov_b64 s[30:31], 0
s_mov_b32 exec_lo, 0xffffffff
s_mov_b32 exec_hi, 0xff
v_cmp_ne_u32 vcc, s23, v225
s_nop 1
s_or_b64 s[30:31], s[30:31], vcc
v_cmp_ne_u32 vcc, s23, v227
s_nop 1
s_or_b64 s[30:31], s[30:31], vcc
s_mov_b64 exec, -1
s_mov_b32 exec_lo, 0xffffffff
s_mov_b32 exec_hi, 0xff
v_cmp_ne_u32 vcc, s23, v229
s_nop 1
s_or_b64 s[30:31], s[30:31], vcc
v_cmp_ne_u32 vcc, s23, v231
s_nop 1
s_or_b64 s[30:31], s[30:31], vcc
s_mov_b64 exec, -1
s_cmp_eq_u64 s[30:31], 0
s_cbranch_scc1 Lgdone_89
s_sleep 2
s_sub_u32 s27, s27, 1
s_cmp_lg_u32 s27, 0
s_cbranch_scc1 Lgpoll_88
Lgdone_89:
s_mul_i32 s28, s43, 640
s_add_u32 s28, s28, 146592
v_lshl_add_u32 v220, v1, 3, s28
v_mov_b32 v225, v226
v_mov_b32 v229, v230
s_mov_b32 exec_lo, 0xffffffff
s_mov_b32 exec_hi, 0xff
ds_write_b64 v220, v[224:225] offset:320
ds_write_b64 v220, v[228:229]
s_mov_b64 exec, -1
v_and_b32 v222, 1, v1
v_mul_u32_u24 v222, 320, v222
v_lshrrev_b32 v221, 5, v1
v_lshl_add_u32 v222, v221, 4, v222
v_add_u32 v222, s28, v222
v_bfe_u32 v221, v1, 4, 1
v_lshlrev_b32 v220, 10, v221
v_bfe_u32 v221, v1, 5, 1
v_lshl_add_u32 v220, v221, 7, v220
v_bfe_u32 v221, v1, 2, 2
v_lshl_add_u32 v220, v221, 5, v220
v_bfe_u32 v221, v1, 0, 1
v_lshl_add_u32 v220, v221, 4, v220
v_bfe_u32 v221, v1, 1, 1
v_lshl_add_u32 v220, v221, 3, v220
s_mul_i32 s28, s43, 10240
s_add_u32 s28, s28, 61440
v_add_u32 v220, s28, v220
s_waitcnt lgkmcnt(0)
ds_read_b64_tr_b16 v[224:225], v220 offset:0
ds_read_b64_tr_b16 v[226:227], v220 offset:512
ds_read_b128 v[228:231], v222 offset:0
ds_read_b64_tr_b16 v[232:233], v220 offset:256
ds_read_b64_tr_b16 v[234:235], v220 offset:768
ds_read_b128 v[236:239], v222 offset:32
ds_read_b64_tr_b16 v[240:241], v220 offset:2048
ds_read_b64_tr_b16 v[242:243], v220 offset:2560
ds_read_b128 v[244:247], v222 offset:64
ds_read_b64_tr_b16 v[248:249], v220 offset:2304
ds_read_b64_tr_b16 v[250:251], v220 offset:2816
ds_read_b128 v[252:255], v222 offset:96
s_waitcnt lgkmcnt(9)
v_mfma_f32_32x32x16_bf16 v[44:59], v[224:227], v[228:231], 0
ds_read_b64_tr_b16 v[224:225], v220 offset:4096
ds_read_b64_tr_b16 v[226:227], v220 offset:4608
ds_read_b128 v[228:231], v222 offset:128
s_waitcnt lgkmcnt(9)
v_mfma_f32_32x32x16_bf16 v[44:59], v[232:235], v[236:239], v[44:59]
ds_read_b64_tr_b16 v[232:233], v220 offset:4352
ds_read_b64_tr_b16 v[234:235], v220 offset:4864
ds_read_b128 v[236:239], v222 offset:160
s_waitcnt lgkmcnt(9)
v_mfma_f32_32x32x16_bf16 v[44:59], v[240:243], v[244:247], v[44:59]
ds_read_b64_tr_b16 v[240:241], v220 offset:6144
ds_read_b64_tr_b16 v[242:243], v220 offset:6656
ds_read_b128 v[244:247], v222 offset:192
s_waitcnt lgkmcnt(9)
v_mfma_f32_32x32x16_bf16 v[44:59], v[248:251], v[252:255], v[44:59]
ds_read_b64_tr_b16 v[248:249], v220 offset:6400
ds_read_b64_tr_b16 v[250:251], v220 offset:6912
ds_read_b128 v[252:255], v222 offset:224
s_waitcnt lgkmcnt(9)
v_mfma_f32_32x32x16_bf16 v[44:59], v[224:227], v[228:231], v[44:59]
ds_read_b64_tr_b16 v[224:225], v220 offset:8192
ds_read_b64_tr_b16 v[226:227], v220 offset:8704
ds_read_b128 v[228:231], v222 offset:256
s_waitcnt lgkmcnt(9)
v_mfma_f32_32x32x16_bf16 v[44:59], v[232:235], v[236:239], v[44:59]
ds_read_b64_tr_b16 v[232:233], v220 offset:8448
ds_read_b64_tr_b16 v[234:235], v220 offset:8960
ds_read_b128 v[236:239], v222 offset:288
s_waitcnt lgkmcnt(9)
v_mfma_f32_32x32x16_bf16 v[44:59], v[240:243], v[244:247], v[44:59]
s_waitcnt lgkmcnt(6)
v_mfma_f32_32x32x16_bf16 v[44:59], v[248:251], v[252:255], v[44:59]
s_waitcnt lgkmcnt(3)
v_mfma_f32_32x32x16_bf16 v[44:59], v[224:227], v[228:231], v[44:59]
s_waitcnt lgkmcnt(0)
v_mfma_f32_32x32x16_bf16 v[44:59], v[232:235], v[236:239], v[44:59]
v_and_b32 v220, 31, v1
v_lshrrev_b32 v221, 5, v1
v_lshlrev_b32 v221, 4, v221
v_lshl_add_u32 v221, v220, 7, v221
s_lshl_b32 s28, s43, 8
s_add_u32 s28, s28, 144032
v_add_u32 v221, s28, v221
s_mov_b32 exec_lo, 3
s_mov_b32 exec_hi, 3
s_nop 2
ds_write_b128 v221, v[44:47] offset:0
ds_write_b128 v221, v[48:51] offset:32
ds_write_b128 v221, v[52:55] offset:64
ds_write_b128 v221, v[56:59] offset:96
s_mov_b64 exec, -1
Lbj_87:
s_lshr_b32 s28, s21, 2
s_lshl_b32 s28, s28, 2
s_add_u32 s28, s28, 24807808
v_lshlrev_b32 v219, 3, v1
s_mov_b64 exec, 0xfffff
buffer_load_dword v219, v219, s[8:11], s28 offen sc1
s_mov_b64 exec, -1
s_waitcnt lgkmcnt(0)
s_barrier
s_branch Lk2_ret5
Lk2_blk6:
s_cmp_eq_u32 s40, 2
s_cbranch_scc1 Lbgu_91
s_branch Lbj_92
Lbgu_91:
v_mov_b32 v220, 159760
v_mov_b32 v221, 1
s_mov_b64 exec, 1
ds_add_rtn_u32 v221, v220, v221
s_mov_b64 exec, -1
s_waitcnt lgkmcnt(0)
v_readfirstlane_b32 s28, v221
s_nop 1
s_cmp_lg_u32 s28, 3
s_cbranch_scc1 Lb2d_93
s_add_u32 s28, s47, 0
s_lshl_b32 s28, s28, 2
s_add_u32 s28, s28, 24807424
s_mov_b64 exec, 1
v_mov_b32 v220, 0
v_mov_b32 v221, s23
buffer_store_dword v221, v220, s[8:11], s28 offen sc1
s_mov_b64 exec, -1
Lb2d_93:
s_cmp_lg_u32 s3, 7
s_cbranch_scc1 Lb4d_94
v_lshrrev_b32 v228, 1, v217
v_add_u32 v228, 144032, v228
ds_read_b32 v232, v228 offset:0
ds_read_b32 v236, v228 offset:128
ds_read_b32 v233, v228 offset:256
ds_read_b32 v237, v228 offset:384
ds_read_b32 v234, v228 offset:512
ds_read_b32 v238, v228 offset:640
ds_read_b32 v235, v228 offset:768
ds_read_b32 v239, v228 offset:896
s_waitcnt lgkmcnt(0)
v_add_f32 v232, v232, v233
v_add_f32 v234, v234, v235
v_add_f32 v232, v232, v234
v_add_f32 v236, v236, v237
v_add_f32 v238, v238, v239
v_add_f32 v236, v236, v238
v_cvt_pk_bf16_f32 v240, v232, v232
v_cvt_pk_bf16_f32 v242, v236, v236
v_and_b32 v233, 0xffff0000, v240
v_sub_f32 v233, v232, v233
v_and_b32 v237, 0xffff0000, v242
v_sub_f32 v237, v236, v237
v_cvt_pk_bf16_f32 v241, v233, v236
v_cvt_pk_bf16_f32 v242, v236, v237
v_mov_b32 v243, 0
v_cmp_gt_u32 vcc, 32, v1
s_nop 1
v_cndmask_b32 v240, 0, v240, vcc
v_cndmask_b32 v241, 0, v241, vcc
v_cndmask_b32 v242, 0, v242, vcc
buffer_store_dwordx4 v[240:243], v2, s[8:11], s38 offen sc1
Lb4d_94:
Lbj_92:
s_mov_b32 s32, s47
s_waitcnt vmcnt(0)
s_lshr_b32 s28, s21, 2
s_lshl_b32 s28, s28, 2
s_add_u32 s28, s28, 24807808
v_lshlrev_b32 v220, 3, v1
v_mov_b32 v221, v219
s_mov_b32 exec_lo, 0xfffff
s_mov_b32 exec_hi, 0x0
s_mov_b32 s29, 524288
s_branch Lpollchk_97
Lpoll_95:
buffer_load_dword v221, v220, s[8:11], s28 offen sc1
Lpollchk_97:
s_waitcnt vmcnt(0)
v_cmp_ne_u32 vcc, s23, v221
s_nop 1
s_cbranch_vccz Lpolled_96
s_sleep 1
s_sub_u32 s29, s29, 1
s_cmp_lg_u32 s29, 0
s_cbranch_scc1 Lpoll_95
Lpolled_96:
s_mov_b64 exec, -1
s_and_b32 s29, s20, 3
s_lshl_b32 s29, s29, 2
s_add_u32 s29, s29, s43
s_mul_i32 s29, s29, 2560
s_mul_i32 s30, s21, 102400
s_add_u32 s29, s29, s30
s_add_u32 s25, s29, 1273856
v_lshlrev_b32 v222, 7, v1
s_mul_i32 s45, s43, 5120
s_mul_i32 s44, s21, 102400
s_add_u32 s44, s44, 1212416
s_add_u32 s44, s44, s45
s_add_u32 m0, s45, 81920
s_nop 0
buffer_load_dwordx4 v2, s[8:11], s44 offen sc1 lds
buffer_load_dwordx4 v2, s[8:11], s44 offen offset:1024 sc1 lds
buffer_load_dwordx4 v2, s[8:11], s44 offen offset:2048 sc1 lds
buffer_load_dwordx4 v2, s[8:11], s44 offen offset:3072 sc1 lds
s_add_u32 s46, s44, 4096
s_add_u32 m0, s45, 86016
s_nop 0
buffer_load_dwordx4 v2, s[8:11], s46 offen sc1 lds
s_add_u32 s44, s44, 20480
s_add_u32 m0, s45, 102400
s_nop 0
buffer_load_dwordx4 v2, s[8:11], s44 offen sc1 lds
buffer_load_dwordx4 v2, s[8:11], s44 offen offset:1024 sc1 lds
buffer_load_dwordx4 v2, s[8:11], s44 offen offset:2048 sc1 lds
buffer_load_dwordx4 v2, s[8:11], s44 offen offset:3072 sc1 lds
s_add_u32 s46, s44, 4096
s_add_u32 m0, s45, 106496
s_nop 0
buffer_load_dwordx4 v2, s[8:11], s46 offen sc1 lds
s_add_u32 s44, s44, 20480
s_add_u32 m0, s45, 122880
s_nop 0
buffer_load_dwordx4 v2, s[8:11], s44 offen sc1 lds
buffer_load_dwordx4 v2, s[8:11], s44 offen offset:1024 sc1 lds
buffer_load_dwordx4 v2, s[8:11], s44 offen offset:2048 sc1 lds
buffer_load_dwordx4 v2, s[8:11], s44 offen offset:3072 sc1 lds
s_add_u32 s46, s44, 4096
s_add_u32 m0, s45, 126976
s_nop 0
buffer_load_dwordx4 v2, s[8:11], s46 offen sc1 lds
s_mov_b32 exec_lo, 0xfffff
s_mov_b32 exec_hi, 0x0
buffer_load_dword v223, v222, s[8:11], s25 offen sc1
s_mov_b64 exec, -1
s_add_u32 s25, s25, 2560
s_waitcnt lgkmcnt(0)
s_barrier
s_branch Lk2_ret6
Lk2_blk7:
s_cmp_eq_u32 s40, 2
s_cbranch_scc1 Lbgu_98
s_branch Lbj_99
Lbgu_98:
s_cmp_lg_u32 s3, 7
s_cbranch_scc1 Lb5d_100
s_waitcnt vmcnt(0)
s_lshl_b32 s28, s32, 2
s_add_u32 s28, s28, 24808352
s_mov_b64 exec, 1
v_mov_b32 v228, 0
v_mov_b32 v229, s23
buffer_store_dword v229, v228, s[8:11], s28 offen sc1
s_mov_b64 exec, -1
Lb5d_100:
Lbj_99:
s_cmp_lg_u32 s3, 6
s_cbranch_scc1 Lnoepi_101
v_lshrrev_b32 v228, 2, v1
v_cmp_lt_u32 vcc, 4, v228
s_nop 1
v_cndmask_b32 v229, 0, 1, vcc
v_cmp_lt_u32 vcc, 9, v228
s_nop 1
v_cndmask_b32 v229, v229, 2, vcc
v_mul_u32_u24 v230, 5, v229
v_sub_u32 v228, v228, v230
v_mul_u32_u24 v230, 80, v229
v_min_u32 v230, 120, v230
v_add_u32 v228, v228, v230
v_and_b32 v229, 3, v1
v_lshlrev_b32 v228, 7, v228
v_lshl_add_u32 v228, v229, 4, v228
s_mul_i32 s28, s21, 640
s_add_u32 s28, s28, 24885248
s_mov_b32 s27, 524288
Lgpoll_102:
s_mov_b32 exec_lo, 0xffffffff
s_mov_b32 exec_hi, 0xfffffff
buffer_load_dwordx4 v[232:235], v228, s[8:11], s28 offen offset:0 sc1
s_mov_b64 exec, -1
Lgchk_104:
s_waitcnt vmcnt(0)
s_mov_b64 s[30:31], 0
s_mov_b32 exec_lo, 0xffffffff
s_mov_b32 exec_hi, 0xfffffff
v_cmp_ne_u32 vcc, s23, v233
s_nop 1
s_or_b64 s[30:31], s[30:31], vcc
v_cmp_ne_u32 vcc, s23, v235
s_nop 1
s_or_b64 s[30:31], s[30:31], vcc
s_mov_b64 exec, -1
s_cmp_eq_u64 s[30:31], 0
s_cbranch_scc1 Lgdone_103
s_sleep 2
s_sub_u32 s27, s27, 1
s_cmp_lg_u32 s27, 0
s_cbranch_scc1 Lgpoll_102
Lgdone_103:
v_mov_b32 v233, v234
v_lshlrev_b32 v228, 3, v1
v_add_u32 v228, 159808, v228
ds_write_b64 v228, v[232:233]
Lnoepi_101:
s_waitcnt lgkmcnt(0)
s_barrier
s_branch Lk2_ret7
Lk2_done:
s_setprio 0
s_waitcnt vmcnt(0)
s_lshl_b32 s25, s20, 6
s_lshl_b32 s26, s21, 3
s_add_u32 s25, s25, s26
s_add_u32 s25, s25, s3
s_lshl_b32 s25, s25, 2
s_add_u32 s25, s25, 24809472
s_mov_b64 exec, 1
v_mov_b32 v5, 0
v_mov_b32 v6, s23
s_cmp_eq_u32 s41, 0
s_cbranch_scc1 Lflsafe_105
buffer_store_dword v6, v5, s[8:11], s25 offen
s_branch Lfldone_106
Lflsafe_105:
buffer_wbl2 sc1
s_waitcnt vmcnt(0)
buffer_store_dword v6, v5, s[8:11], s25 offen sc1
Lfldone_106:
s_mov_b64 exec, -1
v_add_u32 v3, 61440, v2
v_add_u32 v4, 122880, v2
s_cmp_lt_u32 s3, 4
s_cbranch_scc1 Lf_comp
s_lshl_b32 s25, s20, 1
s_lshl_b32 s25, s25, 8
s_add_u32 s25, s25, 24825856
s_add_u32 s26, s25, 64
s_add_u32 s27, s25, 128
v_and_b32 v6, 15, v1
v_lshlrev_b32 v6, 2, v6
v_bfe_u32 v7, v1, 4, 1
v_lshl_add_u32 v6, v7, 8, v6
s_mul_i32 s28, s22, 24
s_add_u32 s28, s28, 24807424
v_lshlrev_b32 v8, 2, v1
v_add_u32 v9, 904, v8
v_cmp_gt_u32 vcc, 6, v1
s_nop 1
v_cndmask_b32 v8, v9, v8, vcc
s_add_u32 s44, s44, 20480
s_add_u32 m0, s45, 0
s_nop 0
buffer_load_dwordx4 v2, s[8:11], s44 offen sc1 lds
buffer_load_dwordx4 v2, s[8:11], s44 offen offset:1024 sc1 lds
buffer_load_dwordx4 v2, s[8:11], s44 offen offset:2048 sc1 lds
buffer_load_dwordx4 v2, s[8:11], s44 offen offset:3072 sc1 lds
s_add_u32 s46, s44, 4096
s_add_u32 m0, s45, 4096
s_nop 0
buffer_load_dwordx4 v2, s[8:11], s46 offen sc1 lds
s_add_u32 s44, s44, 20480
s_add_u32 m0, s45, 20480
s_nop 0
buffer_load_dwordx4 v2, s[8:11], s44 offen sc1 lds
buffer_load_dwordx4 v2, s[8:11], s44 offen offset:1024 sc1 lds
buffer_load_dwordx4 v2, s[8:11], s44 offen offset:2048 sc1 lds
buffer_load_dwordx4 v2, s[8:11], s44 offen offset:3072 sc1 lds
s_add_u32 s46, s44, 4096
s_add_u32 m0, s45, 24576
s_nop 0
buffer_load_dwordx4 v2, s[8:11], s46 offen sc1 lds
s_mov_b32 exec_lo, 0xfff
s_mov_b32 exec_hi, 0x0
s_mov_b32 s29, 524288
Lpoll_107:
buffer_load_dword v9, v8, s[8:11], s28 offen sc1
Lpollchk_109:
s_waitcnt vmcnt(0)
v_cmp_ne_u32 vcc, s23, v9
s_nop 1
s_cbranch_vccz Lpolled_108
s_sleep 1
s_sub_u32 s29, s29, 1
s_cmp_lg_u32 s29, 0
s_cbranch_scc1 Lpoll_107
Lpolled_108:
s_mov_b64 exec, -1
s_barrier
s_barrier
s_mul_i32 s44, s22, 251904
s_add_u32 s44, s44, 3997696
s_min_u32 s46, s43, 2
s_lshl_b32 s46, s46, 11
s_add_u32 s47, s46, s44
s_add_u32 m0, s46, 143360
s_nop 0
buffer_load_dwordx4 v2, s[8:11], s47 offen sc1 lds
buffer_load_dwordx4 v2, s[8:11], s47 offen offset:1024 sc1 lds
s_add_u32 s44, s44, 6144
s_add_u32 s44, s44, s45
s_add_u32 m0, s45, 40960
s_nop 0
buffer_load_dwordx4 v2, s[8:11], s44 offen sc1 lds
buffer_load_dwordx4 v2, s[8:11], s44 offen offset:1024 sc1 lds
buffer_load_dwordx4 v2, s[8:11], s44 offen offset:2048 sc1 lds
buffer_load_dwordx4 v2, s[8:11], s44 offen offset:3072 sc1 lds
s_add_u32 s46, s44, 4096
s_add_u32 m0, s45, 45056
s_nop 0
buffer_load_dwordx4 v2, s[8:11], s46 offen sc1 lds
s_barrier
s_add_u32 s44, s44, 20480
s_add_u32 m0, s45, 61440
s_nop 0
buffer_load_dwordx4 v2, s[8:11], s44 offen sc1 lds
buffer_load_dwordx4 v2, s[8:11], s44 offen offset:1024 sc1 lds
buffer_load_dwordx4 v2, s[8:11], s44 offen offset:2048 sc1 lds
buffer_load_dwordx4 v2, s[8:11], s44 offen offset:3072 sc1 lds
s_add_u32 s46, s44, 4096
s_add_u32 m0, s45, 65536
s_nop 0
buffer_load_dwordx4 v2, s[8:11], s46 offen sc1 lds
s_add_u32 s44, s44, 20480
s_add_u32 m0, s45, 81920
s_nop 0
buffer_load_dwordx4 v2, s[8:11], s44 offen sc1 lds
buffer_load_dwordx4 v2, s[8:11], s44 offen offset:1024 sc1 lds
buffer_load_dwordx4 v2, s[8:11], s44 offen offset:2048 sc1 lds
buffer_load_dwordx4 v2, s[8:11], s44 offen offset:3072 sc1 lds
s_add_u32 s46, s44, 4096
s_add_u32 m0, s45, 86016
s_nop 0
buffer_load_dwordx4 v2, s[8:11], s46 offen sc1 lds
s_barrier
s_add_u32 s44, s44, 20480
s_add_u32 m0, s45, 102400
s_nop 0
buffer_load_dwordx4 v2, s[8:11], s44 offen sc1 lds
buffer_load_dwordx4 v2, s[8:11], s44 offen offset:1024 sc1 lds
buffer_load_dwordx4 v2, s[8:11], s44 offen offset:2048 sc1 lds
buffer_load_dwordx4 v2, s[8:11], s44 offen offset:3072 sc1 lds
s_add_u32 s46, s44, 4096
s_add_u32 m0, s45, 106496
s_nop 0
buffer_load_dwordx4 v2, s[8:11], s46 offen sc1 lds
s_barrier
s_add_u32 s44, s44, 20480
s_add_u32 m0, s45, 122880
s_nop 0
buffer_load_dwordx4 v2, s[8:11], s44 offen sc1 lds
buffer_load_dwordx4 v2, s[8:11], s44 offen offset:1024 sc1 lds
buffer_load_dwordx4 v2, s[8:11], s44 offen offset:2048 sc1 lds
buffer_load_dwordx4 v2, s[8:11], s44 offen offset:3072 sc1 lds
s_add_u32 s46, s44, 4096
s_add_u32 m0, s45, 126976
s_nop 0
buffer_load_dwordx4 v2, s[8:11], s46 offen sc1 lds
s_lshr_b32 s28, s21, 2
s_lshl_b32 s28, s28, 2
s_add_u32 s28, s28, 24807968
v_lshlrev_b32 v8, 3, v1
s_mov_b32 exec_lo, 0xffffffff
s_mov_b32 exec_hi, 0xffff
s_mov_b32 s29, 524288
Lpoll_110:
buffer_load_dword v9, v8, s[8:11], s28 offen sc1
Lpollchk_112:
s_waitcnt vmcnt(0)
v_cmp_ne_u32 vcc, s23, v9
s_nop 1
s_cbranch_vccz Lpolled_111
s_sleep 1
s_sub_u32 s29, s29, 1
s_cmp_lg_u32 s29, 0
s_cbranch_scc1 Lpoll_110
Lpolled_111:
s_mov_b64 exec, -1
s_and_b32 s28, s20, 3
s_lshl_b32 s28, s28, 2
s_add_u32 s28, s28, s43
s_mul_i32 s28, s28, 15360
s_mul_i32 s29, s21, 245760
s_add_u32 s28, s28, s29
s_add_u32 s28, s28, 2031616
v_lshlrev_b32 v8, 7, v1
s_barrier
s_barrier
s_barrier
s_add_u32 s44, s44, 20480
s_add_u32 m0, s45, 0
s_nop 0
buffer_load_dwordx4 v2, s[8:11], s44 offen sc1 lds
buffer_load_dwordx4 v2, s[8:11], s44 offen offset:1024 sc1 lds
buffer_load_dwordx4 v2, s[8:11], s44 offen offset:2048 sc1 lds
buffer_load_dwordx4 v2, s[8:11], s44 offen offset:3072 sc1 lds
s_add_u32 s46, s44, 4096
s_add_u32 m0, s45, 4096
s_nop 0
buffer_load_dwordx4 v2, s[8:11], s46 offen sc1 lds
s_barrier
s_add_u32 s44, s44, 20480
s_add_u32 m0, s45, 20480
s_nop 0
buffer_load_dwordx4 v2, s[8:11], s44 offen sc1 lds
buffer_load_dwordx4 v2, s[8:11], s44 offen offset:1024 sc1 lds
buffer_load_dwordx4 v2, s[8:11], s44 offen offset:2048 sc1 lds
buffer_load_dwordx4 v2, s[8:11], s44 offen offset:3072 sc1 lds
s_add_u32 s46, s44, 4096
s_add_u32 m0, s45, 24576
s_nop 0
buffer_load_dwordx4 v2, s[8:11], s46 offen sc1 lds
s_add_u32 s44, s44, 20480
s_add_u32 m0, s45, 40960
s_nop 0
buffer_load_dwordx4 v2, s[8:11], s44 offen sc1 lds
buffer_load_dwordx4 v2, s[8:11], s44 offen offset:1024 sc1 lds
buffer_load_dwordx4 v2, s[8:11], s44 offen offset:2048 sc1 lds
buffer_load_dwordx4 v2, s[8:11], s44 offen offset:3072 sc1 lds
s_add_u32 s46, s44, 4096
s_add_u32 m0, s45, 45056
s_nop 0
buffer_load_dwordx4 v2, s[8:11], s46 offen sc1 lds
s_barrier
s_add_u32 s44, s44, 20480
s_add_u32 m0, s45, 61440
s_nop 0
buffer_load_dwordx4 v2, s[8:11], s44 offen sc1 lds
buffer_load_dwordx4 v2, s[8:11], s44 offen offset:1024 sc1 lds
buffer_load_dwordx4 v2, s[8:11], s44 offen offset:2048 sc1 lds
buffer_load_dwordx4 v2, s[8:11], s44 offen offset:3072 sc1 lds
s_add_u32 s46, s44, 4096
s_add_u32 m0, s45, 65536
s_nop 0
buffer_load_dwordx4 v2, s[8:11], s46 offen sc1 lds
s_add_u32 s44, s44, 20480
s_add_u32 m0, s45, 81920
s_nop 0
buffer_load_dwordx4 v2, s[8:11], s44 offen sc1 lds
buffer_load_dwordx4 v2, s[8:11], s44 offen offset:1024 sc1 lds
buffer_load_dwordx4 v2, s[8:11], s44 offen offset:2048 sc1 lds
buffer_load_dwordx4 v2, s[8:11], s44 offen offset:3072 sc1 lds
s_add_u32 s46, s44, 4096
s_add_u32 m0, s45, 86016
s_nop 0
buffer_load_dwordx4 v2, s[8:11], s46 offen sc1 lds
s_waitcnt vmcnt(20)
s_barrier
s_add_u32 s44, s44, 20480
s_add_u32 m0, s45, 102400
s_nop 0
buffer_load_dwordx4 v2, s[8:11], s44 offen sc1 lds
buffer_load_dwordx4 v2, s[8:11], s44 offen offset:1024 sc1 lds
buffer_load_dwordx4 v2, s[8:11], s44 offen offset:2048 sc1 lds
buffer_load_dwordx4 v2, s[8:11], s44 offen offset:3072 sc1 lds
s_add_u32 s46, s44, 4096
s_add_u32 m0, s45, 106496
s_nop 0
buffer_load_dwordx4 v2, s[8:11], s46 offen sc1 lds
s_waitcnt vmcnt(20)
s_barrier
s_add_u32 s44, s44, 20480
s_add_u32 m0, s45, 122880
s_nop 0
buffer_load_dwordx4 v2, s[8:11], s44 offen sc1 lds
buffer_load_dwordx4 v2, s[8:11], s44 offen offset:1024 sc1 lds
buffer_load_dwordx4 v2, s[8:11], s44 offen offset:2048 sc1 lds
buffer_load_dwordx4 v2, s[8:11], s44 offen offset:3072 sc1 lds
s_add_u32 s46, s44, 4096
s_add_u32 m0, s45, 126976
s_nop 0
buffer_load_dwordx4 v2, s[8:11], s46 offen sc1 lds
s_waitcnt vmcnt(20)
s_barrier
s_mul_i32 s44, s21, 245760
s_add_u32 s44, s44, 2031616
s_add_u32 s44, s44, s45
s_add_u32 m0, s45, 0
s_nop 0
buffer_load_dwordx4 v2, s[8:11], s44 offen sc1 lds
buffer_load_dwordx4 v2, s[8:11], s44 offen offset:1024 sc1 lds
buffer_load_dwordx4 v2, s[8:11], s44 offen offset:2048 sc1 lds
buffer_load_dwordx4 v2, s[8:11], s44 offen offset:3072 sc1 lds
s_add_u32 s46, s44, 4096
s_add_u32 m0, s45, 4096
s_nop 0
buffer_load_dwordx4 v2, s[8:11], s46 offen sc1 lds
s_waitcnt vmcnt(20)
s_barrier
s_add_u32 s44, s44, 20480
s_add_u32 m0, s45, 20480
s_nop 0
buffer_load_dwordx4 v2, s[8:11], s44 offen sc1 lds
buffer_load_dwordx4 v2, s[8:11], s44 offen offset:1024 sc1 lds
buffer_load_dwordx4 v2, s[8:11], s44 offen offset:2048 sc1 lds
buffer_load_dwordx4 v2, s[8:11], s44 offen offset:3072 sc1 lds
s_add_u32 s46, s44, 4096
s_add_u32 m0, s45, 24576
s_nop 0
buffer_load_dwordx4 v2, s[8:11], s46 offen sc1 lds
s_waitcnt vmcnt(20)
s_barrier
s_add_u32 s44, s44, 20480
s_add_u32 m0, s45, 40960
s_nop 0
buffer_load_dwordx4 v2, s[8:11], s44 offen sc1 lds
buffer_load_dwordx4 v2, s[8:11], s44 offen offset:1024 sc1 lds
buffer_load_dwordx4 v2, s[8:11], s44 offen offset:2048 sc1 lds
buffer_load_dwordx4 v2, s[8:11], s44 offen offset:3072 sc1 lds
s_add_u32 s46, s44, 4096
s_add_u32 m0, s45, 45056
s_nop 0
buffer_load_dwordx4 v2, s[8:11], s46 offen sc1 lds
s_waitcnt vmcnt(20)
s_barrier
s_mov_b32 exec_lo, 0xffffffff
s_mov_b32 exec_hi, 0
buffer_load_dword v7, v6, s[8:11], s25 offen sc1
s_mov_b64 exec, -1
s_add_u32 s44, s44, 20480
s_add_u32 m0, s45, 61440
s_nop 0
buffer_load_dwordx4 v2, s[8:11], s44 offen sc1 lds
buffer_load_dwordx4 v2, s[8:11], s44 offen offset:1024 sc1 lds
buffer_load_dwordx4 v2, s[8:11], s44 offen offset:2048 sc1 lds
buffer_load_dwordx4 v2, s[8:11], s44 offen offset:3072 sc1 lds
s_add_u32 s46, s44, 4096
s_add_u32 m0, s45, 65536
s_nop 0
buffer_load_dwordx4 v2, s[8:11], s46 offen sc1 lds
s_waitcnt vmcnt(21)
s_waitcnt vmcnt(5)
s_mov_b32 exec_lo, 0xffffffff
s_mov_b32 exec_hi, 0
v_cmp_ne_u32 vcc, s23, v7
s_mov_b64 exec, -1
s_nop 0
s_cbranch_vccz Lchkok_113
s_mov_b32 exec_lo, 0xffffffff
s_mov_b32 exec_hi, 0x0
s_mov_b32 s46, 524288
Lpoll_114:
buffer_load_dword v7, v6, s[8:11], s25 offen sc1
Lpollchk_116:
s_waitcnt vmcnt(0)
v_cmp_ne_u32 vcc, s23, v7
s_nop 1
s_cbranch_vccz Lpolled_115
s_sleep 1
s_sub_u32 s46, s46, 1
s_cmp_lg_u32 s46, 0
s_cbranch_scc1 Lpoll_114
Lpolled_115:
s_mov_b64 exec, -1
Lchkok_113:
s_barrier
s_add_u32 s44, s44, 20480
s_add_u32 m0, s45, 81920
s_nop 0
buffer_load_dwordx4 v2, s[8:11], s44 offen sc1 lds
buffer_load_dwordx4 v2, s[8:11], s44 offen offset:1024 sc1 lds
buffer_load_dwordx4 v2, s[8:11], s44 offen offset:2048 sc1 lds
buffer_load_dwordx4 v2, s[8:11], s44 offen offset:3072 sc1 lds
s_add_u32 s46, s44, 4096
s_add_u32 m0, s45, 86016
s_nop 0
buffer_load_dwordx4 v2, s[8:11], s46 offen sc1 lds
s_barrier
s_add_u32 s44, s44, 20480
s_add_u32 m0, s45, 102400
s_nop 0
buffer_load_dwordx4 v2, s[8:11], s44 offen sc1 lds
buffer_load_dwordx4 v2, s[8:11], s44 offen offset:1024 sc1 lds
buffer_load_dwordx4 v2, s[8:11], s44 offen offset:2048 sc1 lds
buffer_load_dwordx4 v2, s[8:11], s44 offen offset:3072 sc1 lds
s_add_u32 s46, s44, 4096
s_add_u32 m0, s45, 106496
s_nop 0
buffer_load_dwordx4 v2, s[8:11], s46 offen sc1 lds
s_barrier
s_mov_b32 exec_lo, 0xffffffff
s_mov_b32 exec_hi, 0
buffer_load_dword v7, v6, s[8:11], s26 offen sc1
s_mov_b64 exec, -1
s_add_u32 s44, s44, 20480
s_add_u32 m0, s45, 122880
s_nop 0
buffer_load_dwordx4 v2, s[8:11], s44 offen sc1 lds
buffer_load_dwordx4 v2, s[8:11], s44 offen offset:1024 sc1 lds
buffer_load_dwordx4 v2, s[8:11], s44 offen offset:2048 sc1 lds
buffer_load_dwordx4 v2, s[8:11], s44 offen offset:3072 sc1 lds
s_add_u32 s46, s44, 4096
s_add_u32 m0, s45, 126976
s_nop 0
buffer_load_dwordx4 v2, s[8:11], s46 offen sc1 lds
s_waitcnt vmcnt(5)
s_mov_b32 exec_lo, 0xffffffff
s_mov_b32 exec_hi, 0
v_cmp_ne_u32 vcc, s23, v7
s_mov_b64 exec, -1
s_nop 0
s_cbranch_vccz Lchkok_117
s_mov_b32 exec_lo, 0xffffffff
s_mov_b32 exec_hi, 0x0
s_mov_b32 s46, 524288
Lpoll_118:
buffer_load_dword v7, v6, s[8:11], s26 offen sc1
Lpollchk_120:
s_waitcnt vmcnt(0)
v_cmp_ne_u32 vcc, s23, v7
s_nop 1
s_cbranch_vccz Lpolled_119
s_sleep 1
s_sub_u32 s46, s46, 1
s_cmp_lg_u32 s46, 0
s_cbranch_scc1 Lpoll_118
Lpolled_119:
s_mov_b64 exec, -1
Lchkok_117:
s_barrier
s_add_u32 s44, s44, 20480
s_add_u32 m0, s45, 0
s_nop 0
buffer_load_dwordx4 v2, s[8:11], s44 offen sc1 lds
buffer_load_dwordx4 v2, s[8:11], s44 offen offset:1024 sc1 lds
buffer_load_dwordx4 v2, s[8:11], s44 offen offset:2048 sc1 lds
buffer_load_dwordx4 v2, s[8:11], s44 offen offset:3072 sc1 lds
s_add_u32 s46, s44, 4096
s_add_u32 m0, s45, 4096
s_nop 0
buffer_load_dwordx4 v2, s[8:11], s46 offen sc1 lds
s_barrier
s_add_u32 s44, s44, 20480
s_add_u32 m0, s45, 20480
s_nop 0
buffer_load_dwordx4 v2, s[8:11], s44 offen sc1 lds
buffer_load_dwordx4 v2, s[8:11], s44 offen offset:1024 sc1 lds
buffer_load_dwordx4 v2, s[8:11], s44 offen offset:2048 sc1 lds
buffer_load_dwordx4 v2, s[8:11], s44 offen offset:3072 sc1 lds
s_add_u32 s46, s44, 4096
s_add_u32 m0, s45, 24576
s_nop 0
buffer_load_dwordx4 v2, s[8:11], s46 offen sc1 lds
s_barrier
s_mov_b32 exec_lo, 0xffffffff
s_mov_b32 exec_hi, 0
buffer_load_dword v7, v6, s[8:11], s27 offen sc1
s_mov_b64 exec, -1
s_add_u32 s44, s44, 20480
s_add_u32 m0, s45, 40960
s_nop 0
buffer_load_dwordx4 v2, s[8:11], s44 offen sc1 lds
buffer_load_dwordx4 v2, s[8:11], s44 offen offset:1024 sc1 lds
buffer_load_dwordx4 v2, s[8:11], s44 offen offset:2048 sc1 lds
buffer_load_dwordx4 v2, s[8:11], s44 offen offset:3072 sc1 lds
s_add_u32 s46, s44, 4096
s_add_u32 m0, s45, 45056
s_nop 0
buffer_load_dwordx4 v2, s[8:11], s46 offen sc1 lds
s_waitcnt vmcnt(5)
s_mov_b32 exec_lo, 0xffffffff
s_mov_b32 exec_hi, 0
v_cmp_ne_u32 vcc, s23, v7
s_mov_b64 exec, -1
s_nop 0
s_cbranch_vccz Lchkok_121
s_mov_b32 exec_lo, 0xffffffff
s_mov_b32 exec_hi, 0x0
s_mov_b32 s46, 524288
Lpoll_122:
buffer_load_dword v7, v6, s[8:11], s27 offen sc1
Lpollchk_124:
s_waitcnt vmcnt(0)
v_cmp_ne_u32 vcc, s23, v7
s_nop 1
s_cbranch_vccz Lpolled_123
s_sleep 1
s_sub_u32 s46, s46, 1
s_cmp_lg_u32 s46, 0
s_cbranch_scc1 Lpoll_122
Lpolled_123:
s_mov_b64 exec, -1
Lchkok_121:
s_barrier
s_add_u32 s44, s44, 20480
s_add_u32 m0, s45, 61440
s_nop 0
buffer_load_dwordx4 v2, s[8:11], s44 offen sc1 lds
buffer_load_dwordx4 v2, s[8:11], s44 offen offset:1024 sc1 lds
buffer_load_dwordx4 v2, s[8:11], s44 offen offset:2048 sc1 lds
buffer_load_dwordx4 v2, s[8:11], s44 offen offset:3072 sc1 lds
s_add_u32 s46, s44, 4096
s_add_u32 m0, s45, 65536
s_nop 0
buffer_load_dwordx4 v2, s[8:11], s46 offen sc1 lds
s_barrier
s_add_u32 s44, s44, 20480
s_add_u32 m0, s45, 81920
s_nop 0
buffer_load_dwordx4 v2, s[8:11], s44 offen sc1 lds
buffer_load_dwordx4 v2, s[8:11], s44 offen offset:1024 sc1 lds
buffer_load_dwordx4 v2, s[8:11], s44 offen offset:2048 sc1 lds
buffer_load_dwordx4 v2, s[8:11], s44 offen offset:3072 sc1 lds
s_add_u32 s46, s44, 4096
s_add_u32 m0, s45, 86016
s_nop 0
buffer_load_dwordx4 v2, s[8:11], s46 offen sc1 lds
s_barrier
s_barrier
s_waitcnt vmcnt(10)
s_barrier
s_waitcnt vmcnt(5)
s_barrier
s_waitcnt vmcnt(0)
s_barrier
s_endpgm
Lf_comp:
s_load_dwordx2 s[16:17], s[0:1], 88
s_mov_b32 s18, 2621440
s_mov_b32 s19, 0x20000
s_mul_i32 s25, s24, 20480
s_add_u32 s25, s25, 10649600
s_lshl_b32 s29, s20, 8
s_add_u32 s29, s29, 24809472
v_lshlrev_b32 v7, 2, v1
v_lshrrev_b32 v6, 4, v1
v_lshlrev_b32 v6, 3, v6
v_add_u32 v6, 159808, v6
ds_read_b64 v[12:13], v6 offset:0
ds_read_b64 v[14:15], v6 offset:32
ds_read_b64 v[16:17], v6 offset:64
ds_read_b64 v[18:19], v6 offset:96
ds_read_b64 v[20:21], v6 offset:128
v_lshrrev_b32 v6, 4, v1
v_lshlrev_b32 v6, 3, v6
v_add_u32 v6, 159968, v6
ds_read_b64 v[22:23], v6 offset:0
ds_read_b64 v[24:25], v6 offset:32
ds_read_b64 v[26:27], v6 offset:64
ds_read_b64 v[28:29], v6 offset:96
ds_read_b64 v[30:31], v6 offset:128
s_waitcnt lgkmcnt(0)
v_lshlrev_b32 v84, 16, v12
v_and_b32 v85, 0xffff0000, v12
v_lshlrev_b32 v86, 16, v13
v_and_b32 v87, 0xffff0000, v13
v_lshlrev_b32 v88, 16, v14
v_and_b32 v89, 0xffff0000, v14
v_lshlrev_b32 v90, 16, v15
v_and_b32 v91, 0xffff0000, v15
v_lshlrev_b32 v92, 16, v16
v_and_b32 v93, 0xffff0000, v16
v_lshlrev_b32 v94, 16, v17
v_and_b32 v95, 0xffff0000, v17
v_lshlrev_b32 v96, 16, v18
v_and_b32 v97, 0xffff0000, v18
v_lshlrev_b32 v98, 16, v19
v_and_b32 v99, 0xffff0000, v19
v_lshlrev_b32 v100, 16, v20
v_and_b32 v101, 0xffff0000, v20
v_lshlrev_b32 v102, 16, v21
v_and_b32 v103, 0xffff0000, v21
v_lshlrev_b32 v104, 16, v22
v_and_b32 v105, 0xffff0000, v22
v_lshlrev_b32 v106, 16, v23
v_and_b32 v107, 0xffff0000, v23
v_lshlrev_b32 v108, 16, v24
v_and_b32 v109, 0xffff0000, v24
v_lshlrev_b32 v110, 16, v25
v_and_b32 v111, 0xffff0000, v25
v_lshlrev_b32 v112, 16, v26
v_and_b32 v113, 0xffff0000, v26
v_lshlrev_b32 v114, 16, v27
v_and_b32 v115, 0xffff0000, v27
v_lshlrev_b32 v116, 16, v28
v_and_b32 v117, 0xffff0000, v28
v_lshlrev_b32 v118, 16, v29
v_and_b32 v119, 0xffff0000, v29
v_lshlrev_b32 v120, 16, v30
v_and_b32 v121, 0xffff0000, v30
v_lshlrev_b32 v122, 16, v31
v_and_b32 v123, 0xffff0000, v31
s_waitcnt vmcnt(0)
v_lshlrev_b32 v232, 16, v220
v_and_b32 v233, 0xffff0000, v220
v_lshlrev_b32 v234, 16, v221
v_and_b32 v235, 0xffff0000, v221
v_lshlrev_b32 v236, 16, v222
v_and_b32 v237, 0xffff0000, v222
v_lshlrev_b32 v238, 16, v223
v_and_b32 v239, 0xffff0000, v223
v_lshlrev_b32 v240, 16, v224
v_and_b32 v241, 0xffff0000, v224
v_lshlrev_b32 v242, 16, v225
v_and_b32 v243, 0xffff0000, v225
v_lshlrev_b32 v244, 16, v226
v_and_b32 v245, 0xffff0000, v226
v_lshlrev_b32 v246, 16, v227
v_and_b32 v247, 0xffff0000, v227
v_lshlrev_b32 v248, 16, v228
v_and_b32 v249, 0xffff0000, v228
v_lshlrev_b32 v250, 16, v229
v_and_b32 v251, 0xffff0000, v229
s_lshr_b32 s26, s24, 1
s_mul_i32 s26, s26, 40960
s_mul_i32 s30, s21, 5120
s_add_u32 s26, s26, s30
s_and_b32 s30, s24, 1
s_lshl_b32 s30, s30, 8
s_add_u32 s26, s26, s30
s_add_u32 s26, s26, 15892480
s_add_u32 s27, s26, 4096
v_lshrrev_b32 v6, 5, v1
v_lshlrev_b32 v6, 9, v6
v_and_b32 v5, 15, v1
v_lshl_add_u32 v6, v5, 4, v6
v_bfe_u32 v8, v1, 4, 1
v_lshl_add_u32 v6, v8, 3, v6
v_lshlrev_b32 v5, 3, v5
s_lshl_b32 s28, s24, 10
s_lshl_b32 s30, s21, 7
s_add_u32 s28, s28, s30
s_add_u32 s28, s28, 32768
s_barrier
ds_read_b128 v[12:15], v3 offset:20480
ds_read_b128 v[16:19], v3 offset:21504
ds_read_b128 v[20:23], v3 offset:22528
ds_read_b128 v[24:27], v3 offset:23552
ds_read_b128 v[28:31], v3 offset:24576
s_mov_b32 s30, 524288
Lpoll_125:
buffer_load_dword v8, v7, s[8:11], s29 offen sc1
Lpollchk_127:
s_waitcnt vmcnt(0)
v_cmp_ne_u32 vcc, s23, v8
s_nop 1
s_cbranch_vccz Lpolled_126
s_sleep 1
s_sub_u32 s30, s30, 1
s_cmp_lg_u32 s30, 0
s_cbranch_scc1 Lpoll_125
Lpolled_126:
buffer_load_dwordx4 v[124:127], v2, s[8:11], s25 offen offset:0 sc1
buffer_load_dwordx4 v[128:131], v2, s[8:11], s25 offen offset:1024 sc1
buffer_load_dwordx4 v[132:135], v2, s[8:11], s25 offen offset:2048 sc1
buffer_load_dwordx4 v[136:139], v2, s[8:11], s25 offen offset:3072 sc1
s_add_u32 s25, s25, 4096
buffer_load_dwordx4 v[140:143], v2, s[8:11], s25 offen offset:0 sc1
buffer_load_dwordx4 v[144:147], v2, s[8:11], s25 offen offset:1024 sc1
buffer_load_dwordx4 v[148:151], v2, s[8:11], s25 offen offset:2048 sc1
buffer_load_dwordx4 v[152:155], v2, s[8:11], s25 offen offset:3072 sc1
s_add_u32 s25, s25, 4096
buffer_load_dwordx4 v[156:159], v2, s[8:11], s25 offen offset:0 sc1
buffer_load_dwordx4 v[160:163], v2, s[8:11], s25 offen offset:1024 sc1
buffer_load_dwordx4 v[164:167], v2, s[8:11], s25 offen offset:2048 sc1
buffer_load_dwordx4 v[168:171], v2, s[8:11], s25 offen offset:3072 sc1
s_waitcnt vmcnt(11) lgkmcnt(3)
v_mfma_f32_16x16x32_bf16 v[52:55], v[12:15], v[124:127], 0
ds_read_b128 v[32:35], v3 offset:25600
v_mfma_f32_16x16x32_bf16 v[56:59], v[16:19], v[124:127], 0
ds_read_b128 v[36:39], v3 offset:26624
s_waitcnt lgkmcnt(3)
v_mfma_f32_16x16x32_bf16 v[60:63], v[20:23], v[124:127], 0
ds_read_b128 v[40:43], v3 offset:27648
v_mfma_f32_16x16x32_bf16 v[64:67], v[24:27], v[124:127], 0
ds_read_b128 v[44:47], v3 offset:28672
s_waitcnt lgkmcnt(4)
v_mfma_f32_16x16x32_bf16 v[68:71], v[28:31], v[124:127], 0
ds_read_b128 v[48:51], v3 offset:29696
s_add_u32 s25, s25, 4096
buffer_load_dwordx4 v[172:175], v2, s[8:11], s25 offen offset:0 sc1
buffer_load_dwordx4 v[176:179], v2, s[8:11], s25 offen offset:1024 sc1
buffer_load_dwordx4 v[180:183], v2, s[8:11], s25 offen offset:2048 sc1
buffer_load_dwordx4 v[184:187], v2, s[8:11], s25 offen offset:3072 sc1
s_waitcnt vmcnt(14) lgkmcnt(3)
v_mfma_f32_16x16x32_bf16 v[52:55], v[32:35], v[128:131], v[52:55]
ds_read_b128 v[12:15], v3 offset:30720
v_mfma_f32_16x16x32_bf16 v[56:59], v[36:39], v[128:131], v[56:59]
ds_read_b128 v[16:19], v3 offset:31744
s_waitcnt lgkmcnt(3)
v_mfma_f32_16x16x32_bf16 v[60:63], v[40:43], v[128:131], v[60:63]
ds_read_b128 v[20:23], v3 offset:32768
v_mfma_f32_16x16x32_bf16 v[64:67], v[44:47], v[128:131], v[64:67]
ds_read_b128 v[24:27], v3 offset:33792
s_waitcnt lgkmcnt(4)
v_mfma_f32_16x16x32_bf16 v[68:71], v[48:51], v[128:131], v[68:71]
ds_read_b128 v[28:31], v3 offset:34816
s_add_u32 s25, s25, 4096
buffer_load_dwordx4 v[188:191], v2, s[8:11], s25 offen offset:0 sc1
buffer_load_dwordx4 v[192:195], v2, s[8:11], s25 offen offset:1024 sc1
buffer_load_dwordx4 v[196:199], v2, s[8:11], s25 offen offset:2048 sc1
buffer_load_dwordx4 v[200:203], v2, s[8:11], s25 offen offset:3072 sc1
s_waitcnt vmcnt(17) lgkmcnt(3)
v_mfma_f32_16x16x32_bf16 v[52:55], v[12:15], v[132:135], v[52:55]
ds_read_b128 v[32:35], v3 offset:35840
v_mfma_f32_16x16x32_bf16 v[56:59], v[16:19], v[132:135], v[56:59]
ds_read_b128 v[36:39], v3 offset:36864
s_waitcnt lgkmcnt(3)
v_mfma_f32_16x16x32_bf16 v[60:63], v[20:23], v[132:135], v[60:63]
ds_read_b128 v[40:43], v3 offset:37888
v_mfma_f32_16x16x32_bf16 v[64:67], v[24:27], v[132:135], v[64:67]
ds_read_b128 v[44:47], v3 offset:38912
s_waitcnt lgkmcnt(4)
v_mfma_f32_16x16x32_bf16 v[68:71], v[28:31], v[132:135], v[68:71]
ds_read_b128 v[48:51], v3 offset:39936
s_barrier
s_waitcnt vmcnt(16) lgkmcnt(3)
v_mfma_f32_16x16x32_bf16 v[52:55], v[32:35], v[136:139], v[52:55]
ds_read_b128 v[12:15], v3 offset:40960
v_mfma_f32_16x16x32_bf16 v[56:59], v[36:39], v[136:139], v[56:59]
ds_read_b128 v[16:19], v3 offset:41984
s_waitcnt lgkmcnt(3)
v_mfma_f32_16x16x32_bf16 v[60:63], v[40:43], v[136:139], v[60:63]
ds_read_b128 v[20:23], v3 offset:43008
v_mfma_f32_16x16x32_bf16 v[64:67], v[44:47], v[136:139], v[64:67]
ds_read_b128 v[24:27], v3 offset:44032
s_waitcnt lgkmcnt(4)
v_mfma_f32_16x16x32_bf16 v[68:71], v[48:51], v[136:139], v[68:71]
ds_read_b128 v[28:31], v3 offset:45056
s_waitcnt vmcnt(15) lgkmcnt(3)
v_mfma_f32_16x16x32_bf16 v[52:55], v[12:15], v[140:143], v[52:55]
ds_read_b128 v[32:35], v3 offset:46080
v_mfma_f32_16x16x32_bf16 v[56:59], v[16:19], v[140:143], v[56:59]
ds_read_b128 v[36:39], v3 offset:47104
s_waitcnt lgkmcnt(3)
v_mfma_f32_16x16x32_bf16 v[60:63], v[20:23], v[140:143], v[60:63]
ds_read_b128 v[40:43], v3 offset:48128
v_mfma_f32_16x16x32_bf16 v[64:67], v[24:27], v[140:143], v[64:67]
ds_read_b128 v[44:47], v3 offset:49152
s_waitcnt lgkmcnt(4)
v_mfma_f32_16x16x32_bf16 v[68:71], v[28:31], v[140:143], v[68:71]
ds_read_b128 v[48:51], v3 offset:50176
s_waitcnt vmcnt(14) lgkmcnt(3)
v_mfma_f32_16x16x32_bf16 v[52:55], v[32:35], v[144:147], v[52:55]
ds_read_b128 v[12:15], v3 offset:51200
v_mfma_f32_16x16x32_bf16 v[56:59], v[36:39], v[144:147], v[56:59]
ds_read_b128 v[16:19], v3 offset:52224
s_waitcnt lgkmcnt(3)
v_mfma_f32_16x16x32_bf16 v[60:63], v[40:43], v[144:147], v[60:63]
ds_read_b128 v[20:23], v3 offset:53248
v_mfma_f32_16x16x32_bf16 v[64:67], v[44:47], v[144:147], v[64:67]
ds_read_b128 v[24:27], v3 offset:54272
s_waitcnt lgkmcnt(4)
v_mfma_f32_16x16x32_bf16 v[68:71], v[48:51], v[144:147], v[68:71]
ds_read_b128 v[28:31], v3 offset:55296
s_waitcnt vmcnt(13) lgkmcnt(3)
v_mfma_f32_16x16x32_bf16 v[52:55], v[12:15], v[148:151], v[52:55]
ds_read_b128 v[32:35], v3 offset:56320
v_mfma_f32_16x16x32_bf16 v[56:59], v[16:19], v[148:151], v[56:59]
ds_read_b128 v[36:39], v3 offset:57344
s_waitcnt lgkmcnt(3)
v_mfma_f32_16x16x32_bf16 v[60:63], v[20:23], v[148:151], v[60:63]
ds_read_b128 v[40:43], v3 offset:58368
v_mfma_f32_16x16x32_bf16 v[64:67], v[24:27], v[148:151], v[64:67]
ds_read_b128 v[44:47], v3 offset:59392
s_waitcnt lgkmcnt(4)
v_mfma_f32_16x16x32_bf16 v[68:71], v[28:31], v[148:151], v[68:71]
ds_read_b128 v[48:51], v3 offset:60416
s_barrier
s_waitcnt vmcnt(12) lgkmcnt(3)
v_mfma_f32_16x16x32_bf16 v[52:55], v[32:35], v[152:155], v[52:55]
ds_read_b128 v[12:15], v4 offset:0
v_mfma_f32_16x16x32_bf16 v[56:59], v[36:39], v[152:155], v[56:59]
ds_read_b128 v[16:19], v4 offset:1024
s_waitcnt lgkmcnt(3)
v_mfma_f32_16x16x32_bf16 v[60:63], v[40:43], v[152:155], v[60:63]
ds_read_b128 v[20:23], v4 offset:2048
v_mfma_f32_16x16x32_bf16 v[64:67], v[44:47], v[152:155], v[64:67]
ds_read_b128 v[24:27], v4 offset:3072
s_waitcnt lgkmcnt(4)
v_mfma_f32_16x16x32_bf16 v[68:71], v[48:51], v[152:155], v[68:71]
ds_read_b128 v[28:31], v4 offset:4096
s_waitcnt vmcnt(11) lgkmcnt(3)
v_mfma_f32_16x16x32_bf16 v[52:55], v[12:15], v[156:159], v[52:55]
ds_read_b128 v[32:35], v4 offset:5120
v_mfma_f32_16x16x32_bf16 v[56:59], v[16:19], v[156:159], v[56:59]
ds_read_b128 v[36:39], v4 offset:6144
s_waitcnt lgkmcnt(3)
v_mfma_f32_16x16x32_bf16 v[60:63], v[20:23], v[156:159], v[60:63]
ds_read_b128 v[40:43], v4 offset:7168
v_mfma_f32_16x16x32_bf16 v[64:67], v[24:27], v[156:159], v[64:67]
ds_read_b128 v[44:47], v4 offset:8192
s_waitcnt lgkmcnt(4)
v_mfma_f32_16x16x32_bf16 v[68:71], v[28:31], v[156:159], v[68:71]
ds_read_b128 v[48:51], v4 offset:9216
s_waitcnt vmcnt(10) lgkmcnt(3)
v_mfma_f32_16x16x32_bf16 v[52:55], v[32:35], v[160:163], v[52:55]
ds_read_b128 v[12:15], v4 offset:10240
v_mfma_f32_16x16x32_bf16 v[56:59], v[36:39], v[160:163], v[56:59]
ds_read_b128 v[16:19], v4 offset:11264
s_waitcnt lgkmcnt(3)
v_mfma_f32_16x16x32_bf16 v[60:63], v[40:43], v[160:163], v[60:63]
ds_read_b128 v[20:23], v4 offset:12288
v_mfma_f32_16x16x32_bf16 v[64:67], v[44:47], v[160:163], v[64:67]
ds_read_b128 v[24:27], v4 offset:13312
s_waitcnt lgkmcnt(4)
v_mfma_f32_16x16x32_bf16 v[68:71], v[48:51], v[160:163], v[68:71]
ds_read_b128 v[28:31], v4 offset:14336
s_waitcnt vmcnt(9) lgkmcnt(3)
v_mfma_f32_16x16x32_bf16 v[52:55], v[12:15], v[164:167], v[52:55]
ds_read_b128 v[32:35], v4 offset:15360
v_mfma_f32_16x16x32_bf16 v[56:59], v[16:19], v[164:167], v[56:59]
ds_read_b128 v[36:39], v4 offset:16384
s_waitcnt lgkmcnt(3)
v_mfma_f32_16x16x32_bf16 v[60:63], v[20:23], v[164:167], v[60:63]
ds_read_b128 v[40:43], v4 offset:17408
v_mfma_f32_16x16x32_bf16 v[64:67], v[24:27], v[164:167], v[64:67]
ds_read_b128 v[44:47], v4 offset:18432
s_waitcnt lgkmcnt(4)
v_mfma_f32_16x16x32_bf16 v[68:71], v[28:31], v[164:167], v[68:71]
ds_read_b128 v[48:51], v4 offset:19456
s_barrier
s_waitcnt vmcnt(8) lgkmcnt(3)
v_mfma_f32_16x16x32_bf16 v[52:55], v[32:35], v[168:171], v[52:55]
ds_read_b128 v[12:15], v2 offset:0
v_mfma_f32_16x16x32_bf16 v[56:59], v[36:39], v[168:171], v[56:59]
ds_read_b128 v[16:19], v2 offset:1024
s_waitcnt lgkmcnt(3)
v_mfma_f32_16x16x32_bf16 v[60:63], v[40:43], v[168:171], v[60:63]
ds_read_b128 v[20:23], v2 offset:2048
v_mfma_f32_16x16x32_bf16 v[64:67], v[44:47], v[168:171], v[64:67]
ds_read_b128 v[24:27], v2 offset:3072
s_waitcnt lgkmcnt(4)
v_mfma_f32_16x16x32_bf16 v[68:71], v[48:51], v[168:171], v[68:71]
ds_read_b128 v[28:31], v2 offset:4096
s_waitcnt vmcnt(7) lgkmcnt(3)
v_mfma_f32_16x16x32_bf16 v[52:55], v[12:15], v[172:175], v[52:55]
ds_read_b128 v[32:35], v2 offset:5120
v_mfma_f32_16x16x32_bf16 v[56:59], v[16:19], v[172:175], v[56:59]
ds_read_b128 v[36:39], v2 offset:6144
s_waitcnt lgkmcnt(3)
v_mfma_f32_16x16x32_bf16 v[60:63], v[20:23], v[172:175], v[60:63]
ds_read_b128 v[40:43], v2 offset:7168
v_mfma_f32_16x16x32_bf16 v[64:67], v[24:27], v[172:175], v[64:67]
ds_read_b128 v[44:47], v2 offset:8192
s_waitcnt lgkmcnt(4)
v_mfma_f32_16x16x32_bf16 v[68:71], v[28:31], v[172:175], v[68:71]
ds_read_b128 v[48:51], v2 offset:9216
s_waitcnt vmcnt(6) lgkmcnt(3)
v_mfma_f32_16x16x32_bf16 v[52:55], v[32:35], v[176:179], v[52:55]
ds_read_b128 v[12:15], v2 offset:10240
v_mfma_f32_16x16x32_bf16 v[56:59], v[36:39], v[176:179], v[56:59]
ds_read_b128 v[16:19], v2 offset:11264
s_waitcnt lgkmcnt(3)
v_mfma_f32_16x16x32_bf16 v[60:63], v[40:43], v[176:179], v[60:63]
ds_read_b128 v[20:23], v2 offset:12288
v_mfma_f32_16x16x32_bf16 v[64:67], v[44:47], v[176:179], v[64:67]
ds_read_b128 v[24:27], v2 offset:13312
s_waitcnt lgkmcnt(4)
v_mfma_f32_16x16x32_bf16 v[68:71], v[48:51], v[176:179], v[68:71]
ds_read_b128 v[28:31], v2 offset:14336
s_waitcnt vmcnt(5) lgkmcnt(3)
v_mfma_f32_16x16x32_bf16 v[52:55], v[12:15], v[180:183], v[52:55]
ds_read_b128 v[32:35], v2 offset:15360
v_mfma_f32_16x16x32_bf16 v[56:59], v[16:19], v[180:183], v[56:59]
ds_read_b128 v[36:39], v2 offset:16384
s_waitcnt lgkmcnt(3)
v_mfma_f32_16x16x32_bf16 v[60:63], v[20:23], v[180:183], v[60:63]
ds_read_b128 v[40:43], v2 offset:17408
v_mfma_f32_16x16x32_bf16 v[64:67], v[24:27], v[180:183], v[64:67]
ds_read_b128 v[44:47], v2 offset:18432
s_waitcnt lgkmcnt(4)
v_mfma_f32_16x16x32_bf16 v[68:71], v[28:31], v[180:183], v[68:71]
ds_read_b128 v[48:51], v2 offset:19456
s_barrier
s_waitcnt vmcnt(4) lgkmcnt(3)
v_mfma_f32_16x16x32_bf16 v[52:55], v[32:35], v[184:187], v[52:55]
ds_read_b128 v[12:15], v2 offset:20480
v_mfma_f32_16x16x32_bf16 v[56:59], v[36:39], v[184:187], v[56:59]
ds_read_b128 v[16:19], v2 offset:21504
s_waitcnt lgkmcnt(3)
v_mfma_f32_16x16x32_bf16 v[60:63], v[40:43], v[184:187], v[60:63]
ds_read_b128 v[20:23], v2 offset:22528
v_mfma_f32_16x16x32_bf16 v[64:67], v[44:47], v[184:187], v[64:67]
ds_read_b128 v[24:27], v2 offset:23552
s_waitcnt lgkmcnt(4)
v_mfma_f32_16x16x32_bf16 v[68:71], v[48:51], v[184:187], v[68:71]
ds_read_b128 v[28:31], v2 offset:24576
s_waitcnt vmcnt(3) lgkmcnt(3)
v_mfma_f32_16x16x32_bf16 v[52:55], v[12:15], v[188:191], v[52:55]
ds_read_b128 v[32:35], v2 offset:25600
v_mfma_f32_16x16x32_bf16 v[56:59], v[16:19], v[188:191], v[56:59]
ds_read_b128 v[36:39], v2 offset:26624
s_waitcnt lgkmcnt(3)
v_mfma_f32_16x16x32_bf16 v[60:63], v[20:23], v[188:191], v[60:63]
ds_read_b128 v[40:43], v2 offset:27648
v_mfma_f32_16x16x32_bf16 v[64:67], v[24:27], v[188:191], v[64:67]
ds_read_b128 v[44:47], v2 offset:28672
s_waitcnt lgkmcnt(4)
v_mfma_f32_16x16x32_bf16 v[68:71], v[28:31], v[188:191], v[68:71]
ds_read_b128 v[48:51], v2 offset:29696
s_waitcnt vmcnt(2) lgkmcnt(3)
v_mfma_f32_16x16x32_bf16 v[52:55], v[32:35], v[192:195], v[52:55]
ds_read_b128 v[12:15], v2 offset:30720
v_mfma_f32_16x16x32_bf16 v[56:59], v[36:39], v[192:195], v[56:59]
ds_read_b128 v[16:19], v2 offset:31744
s_waitcnt lgkmcnt(3)
v_mfma_f32_16x16x32_bf16 v[60:63], v[40:43], v[192:195], v[60:63]
ds_read_b128 v[20:23], v2 offset:32768
v_mfma_f32_16x16x32_bf16 v[64:67], v[44:47], v[192:195], v[64:67]
ds_read_b128 v[24:27], v2 offset:33792
s_waitcnt lgkmcnt(4)
v_mfma_f32_16x16x32_bf16 v[68:71], v[48:51], v[192:195], v[68:71]
ds_read_b128 v[28:31], v2 offset:34816
s_waitcnt vmcnt(1) lgkmcnt(3)
v_mfma_f32_16x16x32_bf16 v[52:55], v[12:15], v[196:199], v[52:55]
ds_read_b128 v[32:35], v2 offset:35840
v_mfma_f32_16x16x32_bf16 v[56:59], v[16:19], v[196:199], v[56:59]
ds_read_b128 v[36:39], v2 offset:36864
s_waitcnt lgkmcnt(3)
v_mfma_f32_16x16x32_bf16 v[60:63], v[20:23], v[196:199], v[60:63]
ds_read_b128 v[40:43], v2 offset:37888
v_mfma_f32_16x16x32_bf16 v[64:67], v[24:27], v[196:199], v[64:67]
ds_read_b128 v[44:47], v2 offset:38912
s_waitcnt lgkmcnt(4)
v_mfma_f32_16x16x32_bf16 v[68:71], v[28:31], v[196:199], v[68:71]
ds_read_b128 v[48:51], v2 offset:39936
s_waitcnt vmcnt(0) lgkmcnt(3)
v_mfma_f32_16x16x32_bf16 v[52:55], v[32:35], v[200:203], v[52:55]
v_mfma_f32_16x16x32_bf16 v[56:59], v[36:39], v[200:203], v[56:59]
s_waitcnt lgkmcnt(1)
v_mfma_f32_16x16x32_bf16 v[60:63], v[40:43], v[200:203], v[60:63]
v_mfma_f32_16x16x32_bf16 v[64:67], v[44:47], v[200:203], v[64:67]
s_waitcnt lgkmcnt(0)
v_mfma_f32_16x16x32_bf16 v[68:71], v[48:51], v[200:203], v[68:71]
s_nop 1
v_pk_fma_f32 v[12:13], v[52:53], v[84:85], v[232:233]
v_pk_fma_f32 v[14:15], v[54:55], v[86:87], v[234:235]
v_pk_fma_f32 v[16:17], v[56:57], v[88:89], v[236:237]
v_pk_fma_f32 v[18:19], v[58:59], v[90:91], v[238:239]
v_pk_fma_f32 v[20:21], v[60:61], v[92:93], v[240:241]
v_pk_fma_f32 v[22:23], v[62:63], v[94:95], v[242:243]
v_pk_fma_f32 v[24:25], v[64:65], v[96:97], v[244:245]
v_pk_fma_f32 v[26:27], v[66:67], v[98:99], v[246:247]
v_pk_fma_f32 v[28:29], v[68:69], v[100:101], v[248:249]
v_pk_fma_f32 v[30:31], v[70:71], v[102:103], v[250:251]
v_cvt_pk_bf16_f32 v220, v12, v13
v_cvt_pk_bf16_f32 v221, v14, v15
v_cvt_pk_bf16_f32 v222, v16, v17
v_cvt_pk_bf16_f32 v223, v18, v19
v_cvt_pk_bf16_f32 v224, v20, v21
v_cvt_pk_bf16_f32 v225, v22, v23
v_cvt_pk_bf16_f32 v226, v24, v25
v_cvt_pk_bf16_f32 v227, v26, v27
v_cvt_pk_bf16_f32 v228, v28, v29
v_cvt_pk_bf16_f32 v229, v30, v31
v_lshlrev_b32 v12, 16, v220
v_and_b32 v13, 0xffff0000, v220
v_lshlrev_b32 v14, 16, v221
v_and_b32 v15, 0xffff0000, v221
v_lshlrev_b32 v16, 16, v222
v_and_b32 v17, 0xffff0000, v222
v_lshlrev_b32 v18, 16, v223
v_and_b32 v19, 0xffff0000, v223
v_lshlrev_b32 v20, 16, v224
v_and_b32 v21, 0xffff0000, v224
v_lshlrev_b32 v22, 16, v225
v_and_b32 v23, 0xffff0000, v225
v_lshlrev_b32 v24, 16, v226
v_and_b32 v25, 0xffff0000, v226
v_lshlrev_b32 v26, 16, v227
v_and_b32 v27, 0xffff0000, v227
v_lshlrev_b32 v28, 16, v228
v_and_b32 v29, 0xffff0000, v228
v_lshlrev_b32 v30, 16, v229
v_and_b32 v31, 0xffff0000, v229
v_pk_mul_f32 v[52:53], v[12:13], v[104:105]
v_pk_mul_f32 v[54:55], v[14:15], v[106:107]
v_pk_mul_f32 v[56:57], v[16:17], v[108:109]
v_pk_mul_f32 v[58:59], v[18:19], v[110:111]
v_pk_mul_f32 v[60:61], v[20:21], v[112:113]
v_pk_mul_f32 v[62:63], v[22:23], v[114:115]
v_pk_mul_f32 v[64:65], v[24:25], v[116:117]
v_pk_mul_f32 v[66:67], v[26:27], v[118:119]
v_pk_mul_f32 v[68:69], v[28:29], v[120:121]
v_pk_mul_f32 v[70:71], v[30:31], v[122:123]
v_cvt_pk_bf16_f32 v84, v52, v53
v_cvt_pk_bf16_f32 v85, v54, v55
v_cvt_pk_bf16_f32 v86, v56, v57
v_cvt_pk_bf16_f32 v87, v58, v59
v_cvt_pk_bf16_f32 v88, v60, v61
v_cvt_pk_bf16_f32 v89, v62, v63
v_cvt_pk_bf16_f32 v90, v64, v65
v_cvt_pk_bf16_f32 v91, v66, v67
v_cvt_pk_bf16_f32 v92, v68, v69
v_cvt_pk_bf16_f32 v93, v70, v71
buffer_store_dwordx2 v[84:85], v6, s[8:11], s26 offen offset:0
buffer_store_dwordx2 v[86:87], v6, s[8:11], s26 offen offset:1024
buffer_store_dwordx2 v[88:89], v6, s[8:11], s26 offen offset:2048
buffer_store_dwordx2 v[90:91], v6, s[8:11], s26 offen offset:3072
buffer_store_dwordx2 v[92:93], v6, s[8:11], s27 offen offset:0
v_pk_add_f32 v[104:105], v[12:13], v[14:15]
v_pk_mul_f32 v[106:107], v[12:13], v[12:13]
v_pk_fma_f32 v[106:107], v[14:15], v[14:15], v[106:107]
v_pk_add_f32 v[104:105], v[104:105], v[16:17]
v_pk_fma_f32 v[106:107], v[16:17], v[16:17], v[106:107]
v_pk_add_f32 v[104:105], v[104:105], v[18:19]
v_pk_fma_f32 v[106:107], v[18:19], v[18:19], v[106:107]
v_pk_add_f32 v[104:105], v[104:105], v[20:21]
v_pk_fma_f32 v[106:107], v[20:21], v[20:21], v[106:107]
v_pk_add_f32 v[104:105], v[104:105], v[22:23]
v_pk_fma_f32 v[106:107], v[22:23], v[22:23], v[106:107]
v_pk_add_f32 v[104:105], v[104:105], v[24:25]
v_pk_fma_f32 v[106:107], v[24:25], v[24:25], v[106:107]
v_pk_add_f32 v[104:105], v[104:105], v[26:27]
v_pk_fma_f32 v[106:107], v[26:27], v[26:27], v[106:107]
v_pk_add_f32 v[104:105], v[104:105], v[28:29]
v_pk_fma_f32 v[106:107], v[28:29], v[28:29], v[106:107]
v_pk_add_f32 v[104:105], v[104:105], v[30:31]
v_pk_fma_f32 v[106:107], v[30:31], v[30:31], v[106:107]
v_add_f32 v104, v104, v105
v_add_f32 v105, v106, v107
v_mov_b32 v108, v104
s_nop 1
v_permlane16_swap_b32 v104, v108
v_add_f32 v104, v104, v108
v_mov_b32 v109, v105
s_nop 1
v_permlane16_swap_b32 v105, v109
v_add_f32 v105, v105, v109
v_mov_b32 v108, v104
s_nop 1
v_permlane32_swap_b32 v104, v108
v_add_f32 v104, v104, v108
v_mov_b32 v109, v105
s_nop 1
v_permlane32_swap_b32 v105, v109
v_add_f32 v105, v105, v109
s_mov_b64 exec, 0xffff
buffer_store_dwordx2 v[104:105], v5, s[8:11], s28 offen
s_mov_b64 exec, -1
s_mul_i32 s29, s3, 2560
s_add_u32 s29, s29, 149504
v_lshl_add_u32 v6, v1, 3, s29
ds_write_b64 v6, v[220:221] offset:0
ds_write_b64 v6, v[222:223] offset:512
ds_write_b64 v6, v[224:225] offset:1024
ds_write_b64 v6, v[226:227] offset:1536
ds_write_b64 v6, v[228:229] offset:2048
s_lshr_b32 s29, s24, 1
s_lshl_b32 s29, s29, 5
s_lshl_b32 s30, s21, 1
s_add_u32 s29, s29, s30
s_and_b32 s30, s24, 1
s_add_u32 s29, s29, s30
s_lshl_b32 s29, s29, 2
s_add_u32 s29, s29, 24817664
s_waitcnt vmcnt(0)
s_mov_b64 exec, 1
v_mov_b32 v7, 0
v_mov_b32 v8, s23
s_cmp_eq_u32 s41, 0
s_cbranch_scc1 Lflsafe_128
buffer_store_dword v8, v7, s[8:11], s29 offen
s_branch Lfldone_129
Lflsafe_128:
buffer_wbl2 sc1
s_waitcnt vmcnt(0)
buffer_store_dword v8, v7, s[8:11], s29 offen sc1
Lfldone_129:
s_mov_b64 exec, -1
s_lshr_b32 s25, s20, 1
s_lshl_b32 s25, s25, 2
s_add_u32 s25, s25, s3
v_and_b32 v12, 31, v1
v_lshrrev_b32 v13, 4, v12
v_lshlrev_b32 v15, 10, v13
v_and_b32 v14, 15, v12
v_lshl_add_u32 v15, v14, 3, v15
v_mul_u32_u24 v13, 49152, v13
v_lshl_add_u32 v13, v14, 4, v13
v_lshrrev_b32 v12, 5, v1
v_lshl_add_u32 v0, v12, 8, v13
s_lshl_b32 s31, s25, 11
s_add_u32 s31, s31, 32768
s_mul_i32 s26, s25, 40960
s_add_u32 s26, s26, 15892480
s_mul_i32 s27, s25, 98304
s_lshl_b32 s28, s22, 10
s_add_u32 s27, s27, s28
s_add_u32 s27, s27, 18513920
s_lshl_b32 s28, s25, 8
s_lshl_b32 s29, s22, 2
s_add_u32 s28, s28, s29
s_add_u32 s28, s28, 24825856
s_lshl_b32 s29, s25, 7
s_add_u32 s29, s29, 24817664
v_lshlrev_b32 v12, 2, v1
v_cmp_gt_u32 s[32:33], 32, v1
s_barrier
ds_read_b128 v[16:19], v2 offset:40960
ds_read_b128 v[20:23], v2 offset:41984
s_mov_b32 exec_lo, 0xffff
s_mov_b32 exec_hi, 0x0
s_mov_b32 s30, 524288
Lpoll_130:
buffer_load_dword v13, v12, s[8:11], s29 offen sc1
Lpollchk_132:
s_waitcnt vmcnt(0)
v_cmp_ne_u32 vcc, s23, v13
s_nop 1
s_cbranch_vccz Lpolled_131
s_sleep 1
s_sub_u32 s30, s30, 1
s_cmp_lg_u32 s30, 0
s_cbranch_scc1 Lpoll_130
Lpolled_131:
s_mov_b64 exec, -1
buffer_load_dwordx4 v[96:99], v2, s[8:11], s26 offen offset:0 sc1
buffer_load_dwordx4 v[100:103], v2, s[8:11], s26 offen offset:1024 sc1
buffer_load_dwordx4 v[104:107], v2, s[8:11], s26 offen offset:2048 sc1
buffer_load_dwordx4 v[108:111], v2, s[8:11], s26 offen offset:3072 sc1
s_add_u32 s26, s26, 4096
buffer_load_dwordx4 v[112:115], v2, s[8:11], s26 offen offset:0 sc1
buffer_load_dwordx4 v[116:119], v2, s[8:11], s26 offen offset:1024 sc1
buffer_load_dwordx4 v[120:123], v2, s[8:11], s26 offen offset:2048 sc1
buffer_load_dwordx4 v[124:127], v2, s[8:11], s26 offen offset:3072 sc1
s_waitcnt vmcnt(7) lgkmcnt(1)
v_mfma_f32_32x32x16_bf16 v[32:47], v[16:19], v[96:99], 0
ds_read_b128 v[24:27], v2 offset:43008
s_add_u32 s26, s26, 4096
buffer_load_dwordx4 v[128:131], v2, s[8:11], s26 offen offset:0 sc1
s_waitcnt lgkmcnt(1)
v_mfma_f32_32x32x16_bf16 v[48:63], v[20:23], v[96:99], 0
ds_read_b128 v[28:31], v2 offset:44032
buffer_load_dwordx4 v[132:135], v2, s[8:11], s26 offen offset:1024 sc1
s_waitcnt vmcnt(8) lgkmcnt(1)
v_mfma_f32_32x32x16_bf16 v[32:47], v[24:27], v[100:103], v[32:47]
ds_read_b128 v[16:19], v2 offset:45056
buffer_load_dwordx4 v[136:139], v2, s[8:11], s26 offen offset:2048 sc1
s_waitcnt lgkmcnt(1)
v_mfma_f32_32x32x16_bf16 v[48:63], v[28:31], v[100:103], v[48:63]
ds_read_b128 v[20:23], v2 offset:46080
buffer_load_dwordx4 v[140:143], v2, s[8:11], s26 offen offset:3072 sc1
s_waitcnt vmcnt(9) lgkmcnt(1)
v_mfma_f32_32x32x16_bf16 v[32:47], v[16:19], v[104:107], v[32:47]
ds_read_b128 v[24:27], v2 offset:47104
s_add_u32 s26, s26, 4096
buffer_load_dwordx4 v[144:147], v2, s[8:11], s26 offen offset:0 sc1
s_waitcnt lgkmcnt(1)
v_mfma_f32_32x32x16_bf16 v[48:63], v[20:23], v[104:107], v[48:63]
ds_read_b128 v[28:31], v2 offset:48128
buffer_load_dwordx4 v[148:151], v2, s[8:11], s26 offen offset:1024 sc1
s_waitcnt vmcnt(10) lgkmcnt(1)
v_mfma_f32_32x32x16_bf16 v[32:47], v[24:27], v[108:111], v[32:47]
ds_read_b128 v[16:19], v2 offset:49152
buffer_load_dwordx4 v[152:155], v2, s[8:11], s26 offen offset:2048 sc1
s_waitcnt lgkmcnt(1)
v_mfma_f32_32x32x16_bf16 v[48:63], v[28:31], v[108:111], v[48:63]
ds_read_b128 v[20:23], v2 offset:50176
buffer_load_dwordx4 v[156:159], v2, s[8:11], s26 offen offset:3072 sc1
s_waitcnt vmcnt(11) lgkmcnt(1)
v_mfma_f32_32x32x16_bf16 v[32:47], v[16:19], v[112:115], v[32:47]
ds_read_b128 v[24:27], v2 offset:51200
buffer_load_dwordx2 v[64:65], v15, s[8:11], s31 offen offset:0 sc1
buffer_load_dwordx2 v[66:67], v15, s[8:11], s31 offen offset:128 sc1
buffer_load_dwordx2 v[68:69], v15, s[8:11], s31 offen offset:256 sc1
buffer_load_dwordx2 v[70:71], v15, s[8:11], s31 offen offset:384 sc1
buffer_load_dwordx2 v[72:73], v15, s[8:11], s31 offen offset:512 sc1
buffer_load_dwordx2 v[74:75], v15, s[8:11], s31 offen offset:640 sc1
buffer_load_dwordx2 v[76:77], v15, s[8:11], s31 offen offset:768 sc1
buffer_load_dwordx2 v[78:79], v15, s[8:11], s31 offen offset:896 sc1
s_add_u32 s26, s26, 4096
buffer_load_dwordx4 v[160:163], v2, s[8:11], s26 offen offset:0 sc1
s_waitcnt lgkmcnt(1)
v_mfma_f32_32x32x16_bf16 v[48:63], v[20:23], v[112:115], v[48:63]
ds_read_b128 v[28:31], v2 offset:52224
buffer_load_dwordx4 v[164:167], v2, s[8:11], s26 offen offset:1024 sc1
s_waitcnt vmcnt(20) lgkmcnt(1)
v_mfma_f32_32x32x16_bf16 v[32:47], v[24:27], v[116:119], v[32:47]
ds_read_b128 v[16:19], v2 offset:53248
buffer_load_dwordx4 v[168:171], v2, s[8:11], s26 offen offset:2048 sc1
s_waitcnt lgkmcnt(1)
v_mfma_f32_32x32x16_bf16 v[48:63], v[28:31], v[116:119], v[48:63]
ds_read_b128 v[20:23], v2 offset:54272
buffer_load_dwordx4 v[172:175], v2, s[8:11], s26 offen offset:3072 sc1
s_waitcnt vmcnt(21) lgkmcnt(1)
v_mfma_f32_32x32x16_bf16 v[32:47], v[16:19], v[120:123], v[32:47]
ds_read_b128 v[24:27], v2 offset:55296
s_add_u32 s26, s26, 4096
buffer_load_dwordx4 v[176:179], v2, s[8:11], s26 offen offset:0 sc1
s_waitcnt lgkmcnt(1)
v_mfma_f32_32x32x16_bf16 v[48:63], v[20:23], v[120:123], v[48:63]
ds_read_b128 v[28:31], v2 offset:56320
buffer_load_dwordx4 v[180:183], v2, s[8:11], s26 offen offset:1024 sc1
s_waitcnt vmcnt(22) lgkmcnt(1)
v_mfma_f32_32x32x16_bf16 v[32:47], v[24:27], v[124:127], v[32:47]
ds_read_b128 v[16:19], v2 offset:57344
buffer_load_dwordx4 v[184:187], v2, s[8:11], s26 offen offset:2048 sc1
s_waitcnt lgkmcnt(1)
v_mfma_f32_32x32x16_bf16 v[48:63], v[28:31], v[124:127], v[48:63]
ds_read_b128 v[20:23], v2 offset:58368
buffer_load_dwordx4 v[188:191], v2, s[8:11], s26 offen offset:3072 sc1
s_waitcnt vmcnt(23) lgkmcnt(1)
v_mfma_f32_32x32x16_bf16 v[32:47], v[16:19], v[128:131], v[32:47]
ds_read_b128 v[24:27], v2 offset:59392
s_add_u32 s26, s26, 4096
buffer_load_dwordx4 v[192:195], v2, s[8:11], s26 offen offset:0 sc1
s_waitcnt lgkmcnt(1)
v_mfma_f32_32x32x16_bf16 v[48:63], v[20:23], v[128:131], v[48:63]
ds_read_b128 v[28:31], v2 offset:60416
buffer_load_dwordx4 v[196:199], v2, s[8:11], s26 offen offset:1024 sc1
s_barrier
s_waitcnt vmcnt(24) lgkmcnt(1)
v_mfma_f32_32x32x16_bf16 v[32:47], v[24:27], v[132:135], v[32:47]
ds_read_b128 v[16:19], v3 offset:0
buffer_load_dwordx4 v[200:203], v2, s[8:11], s26 offen offset:2048 sc1
s_waitcnt lgkmcnt(1)
v_mfma_f32_32x32x16_bf16 v[48:63], v[28:31], v[132:135], v[48:63]
ds_read_b128 v[20:23], v3 offset:1024
buffer_load_dwordx4 v[204:207], v2, s[8:11], s26 offen offset:3072 sc1
s_waitcnt vmcnt(25) lgkmcnt(1)
v_mfma_f32_32x32x16_bf16 v[32:47], v[16:19], v[136:139], v[32:47]
ds_read_b128 v[24:27], v3 offset:2048
s_add_u32 s26, s26, 4096
buffer_load_dwordx4 v[208:211], v2, s[8:11], s26 offen offset:0 sc1
s_waitcnt lgkmcnt(1)
v_mfma_f32_32x32x16_bf16 v[48:63], v[20:23], v[136:139], v[48:63]
ds_read_b128 v[28:31], v3 offset:3072
buffer_load_dwordx4 v[212:215], v2, s[8:11], s26 offen offset:1024 sc1
s_waitcnt vmcnt(26) lgkmcnt(1)
v_mfma_f32_32x32x16_bf16 v[32:47], v[24:27], v[140:143], v[32:47]
ds_read_b128 v[16:19], v3 offset:4096
buffer_load_dwordx4 v[216:219], v2, s[8:11], s26 offen offset:2048 sc1
s_waitcnt lgkmcnt(1)
v_mfma_f32_32x32x16_bf16 v[48:63], v[28:31], v[140:143], v[48:63]
ds_read_b128 v[20:23], v3 offset:5120
buffer_load_dwordx4 v[220:223], v2, s[8:11], s26 offen offset:3072 sc1
s_waitcnt vmcnt(27) lgkmcnt(1)
v_mfma_f32_32x32x16_bf16 v[32:47], v[16:19], v[144:147], v[32:47]
ds_read_b128 v[24:27], v3 offset:6144
s_add_u32 s26, s26, 4096
buffer_load_dwordx4 v[224:227], v2, s[8:11], s26 offen offset:0 sc1
s_waitcnt lgkmcnt(1)
v_mfma_f32_32x32x16_bf16 v[48:63], v[20:23], v[144:147], v[48:63]
ds_read_b128 v[28:31], v3 offset:7168
buffer_load_dwordx4 v[228:231], v2, s[8:11], s26 offen offset:1024 sc1
s_waitcnt vmcnt(28) lgkmcnt(1)
v_mfma_f32_32x32x16_bf16 v[32:47], v[24:27], v[148:151], v[32:47]
ds_read_b128 v[16:19], v3 offset:8192
buffer_load_dwordx4 v[232:235], v2, s[8:11], s26 offen offset:2048 sc1
s_waitcnt lgkmcnt(1)
v_mfma_f32_32x32x16_bf16 v[48:63], v[28:31], v[148:151], v[48:63]
ds_read_b128 v[20:23], v3 offset:9216
buffer_load_dwordx4 v[236:239], v2, s[8:11], s26 offen offset:3072 sc1
s_waitcnt vmcnt(29) lgkmcnt(1)
v_mfma_f32_32x32x16_bf16 v[32:47], v[16:19], v[152:155], v[32:47]
ds_read_b128 v[24:27], v3 offset:10240
s_add_u32 s26, s26, 4096
buffer_load_dwordx4 v[240:243], v2, s[8:11], s26 offen offset:0 sc1
s_waitcnt lgkmcnt(1)
v_mfma_f32_32x32x16_bf16 v[48:63], v[20:23], v[152:155], v[48:63]
ds_read_b128 v[28:31], v3 offset:11264
buffer_load_dwordx4 v[244:247], v2, s[8:11], s26 offen offset:1024 sc1
s_waitcnt vmcnt(30) lgkmcnt(1)
v_mfma_f32_32x32x16_bf16 v[32:47], v[24:27], v[156:159], v[32:47]
ds_read_b128 v[16:19], v3 offset:12288
buffer_load_dwordx4 v[248:251], v2, s[8:11], s26 offen offset:2048 sc1
s_waitcnt lgkmcnt(1)
v_mfma_f32_32x32x16_bf16 v[48:63], v[28:31], v[156:159], v[48:63]
ds_read_b128 v[20:23], v3 offset:13312
buffer_load_dwordx4 v[252:255], v2, s[8:11], s26 offen offset:3072 sc1
s_waitcnt vmcnt(23) lgkmcnt(1)
v_mfma_f32_32x32x16_bf16 v[32:47], v[16:19], v[160:163], v[32:47]
ds_read_b128 v[24:27], v3 offset:14336
s_waitcnt lgkmcnt(1)
v_mfma_f32_32x32x16_bf16 v[48:63], v[20:23], v[160:163], v[48:63]
ds_read_b128 v[28:31], v3 offset:15360
s_waitcnt vmcnt(22) lgkmcnt(1)
v_mfma_f32_32x32x16_bf16 v[32:47], v[24:27], v[164:167], v[32:47]
ds_read_b128 v[16:19], v3 offset:16384
s_waitcnt lgkmcnt(1)
v_mfma_f32_32x32x16_bf16 v[48:63], v[28:31], v[164:167], v[48:63]
ds_read_b128 v[20:23], v3 offset:17408
s_waitcnt vmcnt(21) lgkmcnt(1)
v_mfma_f32_32x32x16_bf16 v[32:47], v[16:19], v[168:171], v[32:47]
ds_read_b128 v[24:27], v3 offset:18432
s_waitcnt lgkmcnt(1)
v_mfma_f32_32x32x16_bf16 v[48:63], v[20:23], v[168:171], v[48:63]
ds_read_b128 v[28:31], v3 offset:19456
s_barrier
s_waitcnt vmcnt(20) lgkmcnt(1)
v_mfma_f32_32x32x16_bf16 v[32:47], v[24:27], v[172:175], v[32:47]
ds_read_b128 v[16:19], v3 offset:20480
s_waitcnt lgkmcnt(1)
v_mfma_f32_32x32x16_bf16 v[48:63], v[28:31], v[172:175], v[48:63]
ds_read_b128 v[20:23], v3 offset:21504
s_waitcnt vmcnt(19) lgkmcnt(1)
v_mfma_f32_32x32x16_bf16 v[32:47], v[16:19], v[176:179], v[32:47]
ds_read_b128 v[24:27], v3 offset:22528
s_waitcnt lgkmcnt(1)
v_mfma_f32_32x32x16_bf16 v[48:63], v[20:23], v[176:179], v[48:63]
ds_read_b128 v[28:31], v3 offset:23552
s_waitcnt vmcnt(18) lgkmcnt(1)
v_mfma_f32_32x32x16_bf16 v[32:47], v[24:27], v[180:183], v[32:47]
ds_read_b128 v[16:19], v3 offset:24576
s_waitcnt lgkmcnt(1)
v_mfma_f32_32x32x16_bf16 v[48:63], v[28:31], v[180:183], v[48:63]
ds_read_b128 v[20:23], v3 offset:25600
s_waitcnt vmcnt(17) lgkmcnt(1)
v_mfma_f32_32x32x16_bf16 v[32:47], v[16:19], v[184:187], v[32:47]
ds_read_b128 v[24:27], v3 offset:26624
s_waitcnt lgkmcnt(1)
v_mfma_f32_32x32x16_bf16 v[48:63], v[20:23], v[184:187], v[48:63]
ds_read_b128 v[28:31], v3 offset:27648
s_waitcnt vmcnt(16) lgkmcnt(1)
v_mfma_f32_32x32x16_bf16 v[32:47], v[24:27], v[188:191], v[32:47]
ds_read_b128 v[16:19], v3 offset:28672
s_waitcnt lgkmcnt(1)
v_mfma_f32_32x32x16_bf16 v[48:63], v[28:31], v[188:191], v[48:63]
ds_read_b128 v[20:23], v3 offset:29696
s_waitcnt vmcnt(15) lgkmcnt(1)
v_mfma_f32_32x32x16_bf16 v[32:47], v[16:19], v[192:195], v[32:47]
ds_read_b128 v[24:27], v3 offset:30720
v_add_f32 v64, v64, v66
v_add_f32 v68, v68, v70
s_waitcnt lgkmcnt(1)
v_mfma_f32_32x32x16_bf16 v[48:63], v[20:23], v[192:195], v[48:63]
ds_read_b128 v[28:31], v3 offset:31744
v_add_f32 v72, v72, v74
v_add_f32 v76, v76, v78
s_waitcnt vmcnt(14) lgkmcnt(1)
v_mfma_f32_32x32x16_bf16 v[32:47], v[24:27], v[196:199], v[32:47]
ds_read_b128 v[16:19], v3 offset:32768
v_add_f32 v64, v64, v68
v_add_f32 v72, v72, v76
s_waitcnt lgkmcnt(1)
v_mfma_f32_32x32x16_bf16 v[48:63], v[28:31], v[196:199], v[48:63]
ds_read_b128 v[20:23], v3 offset:33792
v_add_f32 v64, v64, v72
v_add_f32 v65, v65, v67
s_waitcnt vmcnt(13) lgkmcnt(1)
v_mfma_f32_32x32x16_bf16 v[32:47], v[16:19], v[200:203], v[32:47]
ds_read_b128 v[24:27], v3 offset:34816
v_add_f32 v69, v69, v71
v_add_f32 v73, v73, v75
s_waitcnt lgkmcnt(1)
v_mfma_f32_32x32x16_bf16 v[48:63], v[20:23], v[200:203], v[48:63]
ds_read_b128 v[28:31], v3 offset:35840
v_add_f32 v77, v77, v79
v_add_f32 v65, v65, v69
s_waitcnt vmcnt(12) lgkmcnt(1)
v_mfma_f32_32x32x16_bf16 v[32:47], v[24:27], v[204:207], v[32:47]
ds_read_b128 v[16:19], v3 offset:36864
v_add_f32 v73, v73, v77
v_add_f32 v65, v65, v73
s_waitcnt lgkmcnt(1)
v_mfma_f32_32x32x16_bf16 v[48:63], v[28:31], v[204:207], v[48:63]
ds_read_b128 v[20:23], v3 offset:37888
v_mul_f32 v64, 0xbacccccd, v64
v_mul_f32 v65, 0x3acccccd, v65
s_waitcnt vmcnt(11) lgkmcnt(1)
v_mfma_f32_32x32x16_bf16 v[32:47], v[16:19], v[208:211], v[32:47]
ds_read_b128 v[24:27], v3 offset:38912
v_fma_f32 v65, -v64, v64, v65
v_max_f32 v65, 0, v65
s_waitcnt lgkmcnt(1)
v_mfma_f32_32x32x16_bf16 v[48:63], v[20:23], v[208:211], v[48:63]
ds_read_b128 v[28:31], v3 offset:39936
v_add_f32 v11, 0x3727c5ac, v65
v_rsq_f32 v66, v11
s_barrier
s_waitcnt vmcnt(10) lgkmcnt(1)
v_mfma_f32_32x32x16_bf16 v[32:47], v[24:27], v[212:215], v[32:47]
ds_read_b128 v[16:19], v3 offset:40960
v_sqrt_f32 v67, v11
v_mul_f32 v5, 0xc0135761, v66
s_waitcnt lgkmcnt(1)
v_mfma_f32_32x32x16_bf16 v[48:63], v[28:31], v[212:215], v[48:63]
ds_read_b128 v[20:23], v3 offset:41984
v_mul_f32 v10, v66, v66
v_mul_f32 v10, v10, v66
s_waitcnt vmcnt(9) lgkmcnt(1)
v_mfma_f32_32x32x16_bf16 v[32:47], v[16:19], v[216:219], v[32:47]
ds_read_b128 v[24:27], v3 offset:43008
v_mul_f32 v10, 0xbdd2d3e8, v10
v_cvt_pk_bf16_f32 v68, v64, v67
s_waitcnt lgkmcnt(1)
v_mfma_f32_32x32x16_bf16 v[48:63], v[20:23], v[216:219], v[48:63]
ds_read_b128 v[28:31], v3 offset:44032
v_lshlrev_b32 v69, 16, v68
v_and_b32 v70, 0xffff0000, v68
s_waitcnt vmcnt(8) lgkmcnt(1)
v_mfma_f32_32x32x16_bf16 v[32:47], v[24:27], v[220:223], v[32:47]
ds_read_b128 v[16:19], v3 offset:45056
v_sub_f32 v69, v64, v69
v_sub_f32 v70, v67, v70
s_waitcnt lgkmcnt(1)
v_mfma_f32_32x32x16_bf16 v[48:63], v[28:31], v[220:223], v[48:63]
ds_read_b128 v[20:23], v3 offset:46080
v_cvt_pk_bf16_f32 v6, v64, v69
v_cvt_pk_bf16_f32 v8, v70, v67
s_waitcnt vmcnt(7) lgkmcnt(1)
v_mfma_f32_32x32x16_bf16 v[32:47], v[16:19], v[224:227], v[32:47]
ds_read_b128 v[24:27], v3 offset:47104
v_cndmask_b32 v6, 0, v6, s[32:33]
v_cndmask_b32 v7, 0, v68, s[32:33]
s_waitcnt lgkmcnt(1)
v_mfma_f32_32x32x16_bf16 v[48:63], v[20:23], v[224:227], v[48:63]
ds_read_b128 v[28:31], v3 offset:48128
v_cndmask_b32 v8, 0, v8, s[32:33]
v_mov_b32 v9, 0
s_waitcnt vmcnt(6) lgkmcnt(1)
v_mfma_f32_32x32x16_bf16 v[32:47], v[24:27], v[228:231], v[32:47]
ds_read_b128 v[16:19], v3 offset:49152
s_waitcnt lgkmcnt(1)
v_mfma_f32_32x32x16_bf16 v[48:63], v[28:31], v[228:231], v[48:63]
ds_read_b128 v[20:23], v3 offset:50176
s_waitcnt vmcnt(5) lgkmcnt(1)
v_mfma_f32_32x32x16_bf16 v[32:47], v[16:19], v[232:235], v[32:47]
ds_read_b128 v[24:27], v3 offset:51200
s_waitcnt lgkmcnt(1)
v_mfma_f32_32x32x16_bf16 v[48:63], v[20:23], v[232:235], v[48:63]
ds_read_b128 v[28:31], v3 offset:52224
s_waitcnt vmcnt(4) lgkmcnt(1)
v_mfma_f32_32x32x16_bf16 v[32:47], v[24:27], v[236:239], v[32:47]
ds_read_b128 v[16:19], v3 offset:53248
s_waitcnt lgkmcnt(1)
v_mfma_f32_32x32x16_bf16 v[48:63], v[28:31], v[236:239], v[48:63]
ds_read_b128 v[20:23], v3 offset:54272
s_waitcnt vmcnt(3) lgkmcnt(1)
v_mfma_f32_32x32x16_bf16 v[32:47], v[16:19], v[240:243], v[32:47]
ds_read_b128 v[24:27], v3 offset:55296
s_waitcnt lgkmcnt(1)
v_mfma_f32_32x32x16_bf16 v[48:63], v[20:23], v[240:243], v[48:63]
ds_read_b128 v[28:31], v3 offset:56320
s_waitcnt vmcnt(2) lgkmcnt(1)
v_mfma_f32_32x32x16_bf16 v[32:47], v[24:27], v[244:247], v[32:47]
ds_read_b128 v[16:19], v3 offset:57344
s_waitcnt lgkmcnt(1)
v_mfma_f32_32x32x16_bf16 v[48:63], v[28:31], v[244:247], v[48:63]
ds_read_b128 v[20:23], v3 offset:58368
s_waitcnt vmcnt(1) lgkmcnt(1)
v_mfma_f32_32x32x16_bf16 v[32:47], v[16:19], v[248:251], v[32:47]
ds_read_b128 v[24:27], v3 offset:59392
s_waitcnt lgkmcnt(1)
v_mfma_f32_32x32x16_bf16 v[48:63], v[20:23], v[248:251], v[48:63]
ds_read_b128 v[28:31], v3 offset:60416
s_waitcnt vmcnt(0) lgkmcnt(1)
v_mfma_f32_32x32x16_bf16 v[32:47], v[24:27], v[252:255], v[32:47]
ds_read_b128 v[16:19], v4 offset:20480
s_waitcnt lgkmcnt(1)
v_mfma_f32_32x32x16_bf16 v[48:63], v[28:31], v[252:255], v[48:63]
ds_read_b128 v[20:23], v4 offset:21504
s_barrier
s_waitcnt lgkmcnt(1)
v_mfma_f32_32x32x16_bf16 v[32:47], v[16:19], v[6:9], v[32:47]
ds_read_b128 v[24:27], v4 offset:0
s_waitcnt lgkmcnt(1)
v_mfma_f32_32x32x16_bf16 v[48:63], v[20:23], v[6:9], v[48:63]
ds_read_b128 v[28:31], v4 offset:1024
s_waitcnt lgkmcnt(1)
v_mfma_f32_32x32x16_bf16 v[64:79], v[24:27], v[96:99], 0
ds_read_b128 v[16:19], v4 offset:2048
s_waitcnt lgkmcnt(1)
v_mfma_f32_32x32x16_bf16 v[80:95], v[28:31], v[96:99], 0
ds_read_b128 v[20:23], v4 offset:3072
s_waitcnt lgkmcnt(1)
v_mfma_f32_32x32x16_bf16 v[64:79], v[16:19], v[100:103], v[64:79]
ds_read_b128 v[24:27], v4 offset:4096
s_waitcnt lgkmcnt(1)
v_mfma_f32_32x32x16_bf16 v[80:95], v[20:23], v[100:103], v[80:95]
ds_read_b128 v[28:31], v4 offset:5120
s_waitcnt lgkmcnt(1)
v_mfma_f32_32x32x16_bf16 v[64:79], v[24:27], v[104:107], v[64:79]
ds_read_b128 v[16:19], v4 offset:6144
s_waitcnt lgkmcnt(1)
v_mfma_f32_32x32x16_bf16 v[80:95], v[28:31], v[104:107], v[80:95]
ds_read_b128 v[20:23], v4 offset:7168
s_waitcnt lgkmcnt(1)
v_mfma_f32_32x32x16_bf16 v[64:79], v[16:19], v[108:111], v[64:79]
ds_read_b128 v[24:27], v4 offset:8192
v_mul_f32 v12, v32, v32
v_mul_f32 v13, v33, v33
s_waitcnt lgkmcnt(1)
v_mfma_f32_32x32x16_bf16 v[80:95], v[20:23], v[108:111], v[80:95]
ds_read_b128 v[28:31], v4 offset:9216
v_fma_f32 v12, v12, v10, v5
v_fma_f32 v13, v13, v10, v5
s_waitcnt lgkmcnt(1)
v_mfma_f32_32x32x16_bf16 v[64:79], v[24:27], v[112:115], v[64:79]
ds_read_b128 v[16:19], v4 offset:10240
v_mul_f32 v12, v12, v32
v_mul_f32 v13, v13, v33
s_waitcnt lgkmcnt(1)
v_mfma_f32_32x32x16_bf16 v[80:95], v[28:31], v[112:115], v[80:95]
ds_read_b128 v[20:23], v4 offset:11264
v_exp_f32 v12, v12
v_exp_f32 v13, v13
s_waitcnt lgkmcnt(1)
v_mfma_f32_32x32x16_bf16 v[64:79], v[16:19], v[116:119], v[64:79]
ds_read_b128 v[24:27], v4 offset:12288
v_mul_f32 v40, v40, v32
v_fma_f32 v12, v12, v11, v11
s_waitcnt lgkmcnt(1)
v_mfma_f32_32x32x16_bf16 v[80:95], v[20:23], v[116:119], v[80:95]
ds_read_b128 v[28:31], v4 offset:13312
v_fma_f32 v13, v13, v11, v11
v_rcp_f32 v12, v12
s_waitcnt lgkmcnt(1)
v_mfma_f32_32x32x16_bf16 v[64:79], v[24:27], v[120:123], v[64:79]
ds_read_b128 v[16:19], v4 offset:14336
v_rcp_f32 v13, v13
v_mul_f32 v41, v41, v33
s_waitcnt lgkmcnt(1)
v_mfma_f32_32x32x16_bf16 v[80:95], v[28:31], v[120:123], v[80:95]
ds_read_b128 v[20:23], v4 offset:15360
v_mul_f32 v40, v40, v12
v_mul_f32 v41, v41, v13
s_waitcnt lgkmcnt(1)
v_mfma_f32_32x32x16_bf16 v[64:79], v[16:19], v[124:127], v[64:79]
ds_read_b128 v[24:27], v4 offset:16384
v_cvt_pk_bf16_f32 v32, v40, v41
v_mul_f32 v12, v34, v34
s_waitcnt lgkmcnt(1)
v_mfma_f32_32x32x16_bf16 v[80:95], v[20:23], v[124:127], v[80:95]
ds_read_b128 v[28:31], v4 offset:17408
v_mul_f32 v13, v35, v35
v_fma_f32 v12, v12, v10, v5
s_waitcnt lgkmcnt(1)
v_mfma_f32_32x32x16_bf16 v[64:79], v[24:27], v[128:131], v[64:79]
ds_read_b128 v[16:19], v4 offset:18432
v_fma_f32 v13, v13, v10, v5
v_mul_f32 v12, v12, v34
s_waitcnt lgkmcnt(1)
v_mfma_f32_32x32x16_bf16 v[80:95], v[28:31], v[128:131], v[80:95]
ds_read_b128 v[20:23], v4 offset:19456
v_mul_f32 v13, v13, v35
v_exp_f32 v12, v12
s_barrier
s_waitcnt lgkmcnt(1)
v_mfma_f32_32x32x16_bf16 v[64:79], v[16:19], v[132:135], v[64:79]
ds_read_b128 v[24:27], v2 offset:0
v_exp_f32 v13, v13
v_mul_f32 v42, v42, v34
s_waitcnt lgkmcnt(1)
v_mfma_f32_32x32x16_bf16 v[80:95], v[20:23], v[132:135], v[80:95]
ds_read_b128 v[28:31], v2 offset:1024
v_fma_f32 v12, v12, v11, v11
v_fma_f32 v13, v13, v11, v11
s_waitcnt lgkmcnt(1)
v_mfma_f32_32x32x16_bf16 v[64:79], v[24:27], v[136:139], v[64:79]
ds_read_b128 v[16:19], v2 offset:2048
v_rcp_f32 v12, v12
v_rcp_f32 v13, v13
s_waitcnt lgkmcnt(1)
v_mfma_f32_32x32x16_bf16 v[80:95], v[28:31], v[136:139], v[80:95]
ds_read_b128 v[20:23], v2 offset:3072
v_mul_f32 v43, v43, v35
v_mul_f32 v42, v42, v12
s_waitcnt lgkmcnt(1)
v_mfma_f32_32x32x16_bf16 v[64:79], v[16:19], v[140:143], v[64:79]
ds_read_b128 v[24:27], v2 offset:4096
v_mul_f32 v43, v43, v13
v_cvt_pk_bf16_f32 v33, v42, v43
s_waitcnt lgkmcnt(1)
v_mfma_f32_32x32x16_bf16 v[80:95], v[20:23], v[140:143], v[80:95]
ds_read_b128 v[28:31], v2 offset:5120
v_mul_f32 v12, v36, v36
v_mul_f32 v13, v37, v37
s_waitcnt lgkmcnt(1)
v_mfma_f32_32x32x16_bf16 v[64:79], v[24:27], v[144:147], v[64:79]
ds_read_b128 v[16:19], v2 offset:6144
v_fma_f32 v12, v12, v10, v5
v_fma_f32 v13, v13, v10, v5
s_waitcnt lgkmcnt(1)
v_mfma_f32_32x32x16_bf16 v[80:95], v[28:31], v[144:147], v[80:95]
ds_read_b128 v[20:23], v2 offset:7168
v_mul_f32 v12, v12, v36
v_mul_f32 v13, v13, v37
s_waitcnt lgkmcnt(1)
v_mfma_f32_32x32x16_bf16 v[64:79], v[16:19], v[148:151], v[64:79]
ds_read_b128 v[24:27], v2 offset:8192
v_exp_f32 v12, v12
v_exp_f32 v13, v13
s_waitcnt lgkmcnt(1)
v_mfma_f32_32x32x16_bf16 v[80:95], v[20:23], v[148:151], v[80:95]
ds_read_b128 v[28:31], v2 offset:9216
v_mul_f32 v44, v44, v36
v_fma_f32 v12, v12, v11, v11
s_waitcnt lgkmcnt(1)
v_mfma_f32_32x32x16_bf16 v[64:79], v[24:27], v[152:155], v[64:79]
ds_read_b128 v[16:19], v2 offset:10240
v_fma_f32 v13, v13, v11, v11
v_rcp_f32 v12, v12
s_waitcnt lgkmcnt(1)
v_mfma_f32_32x32x16_bf16 v[80:95], v[28:31], v[152:155], v[80:95]
ds_read_b128 v[20:23], v2 offset:11264
v_rcp_f32 v13, v13
v_mul_f32 v45, v45, v37
s_waitcnt lgkmcnt(1)
v_mfma_f32_32x32x16_bf16 v[64:79], v[16:19], v[156:159], v[64:79]
ds_read_b128 v[24:27], v2 offset:12288
v_mul_f32 v44, v44, v12
v_mul_f32 v45, v45, v13
s_waitcnt lgkmcnt(1)
v_mfma_f32_32x32x16_bf16 v[80:95], v[20:23], v[156:159], v[80:95]
ds_read_b128 v[28:31], v2 offset:13312
v_cvt_pk_bf16_f32 v34, v44, v45
v_mul_f32 v12, v38, v38
s_waitcnt lgkmcnt(1)
v_mfma_f32_32x32x16_bf16 v[64:79], v[24:27], v[160:163], v[64:79]
ds_read_b128 v[16:19], v2 offset:14336
v_mul_f32 v13, v39, v39
v_fma_f32 v12, v12, v10, v5
s_waitcnt lgkmcnt(1)
v_mfma_f32_32x32x16_bf16 v[80:95], v[28:31], v[160:163], v[80:95]
ds_read_b128 v[20:23], v2 offset:15360
v_fma_f32 v13, v13, v10, v5
v_mul_f32 v12, v12, v38
s_waitcnt lgkmcnt(1)
v_mfma_f32_32x32x16_bf16 v[64:79], v[16:19], v[164:167], v[64:79]
ds_read_b128 v[24:27], v2 offset:16384
v_mul_f32 v13, v13, v39
v_exp_f32 v12, v12
s_waitcnt lgkmcnt(1)
v_mfma_f32_32x32x16_bf16 v[80:95], v[20:23], v[164:167], v[80:95]
ds_read_b128 v[28:31], v2 offset:17408
v_exp_f32 v13, v13
v_mul_f32 v46, v46, v38
s_waitcnt lgkmcnt(1)
v_mfma_f32_32x32x16_bf16 v[64:79], v[24:27], v[168:171], v[64:79]
ds_read_b128 v[16:19], v2 offset:18432
v_fma_f32 v12, v12, v11, v11
v_fma_f32 v13, v13, v11, v11
s_waitcnt lgkmcnt(1)
v_mfma_f32_32x32x16_bf16 v[80:95], v[28:31], v[168:171], v[80:95]
ds_read_b128 v[20:23], v2 offset:19456
v_rcp_f32 v12, v12
v_rcp_f32 v13, v13
s_barrier
s_waitcnt lgkmcnt(1)
v_mfma_f32_32x32x16_bf16 v[64:79], v[16:19], v[172:175], v[64:79]
ds_read_b128 v[24:27], v2 offset:20480
v_mul_f32 v47, v47, v39
v_mul_f32 v46, v46, v12
s_waitcnt lgkmcnt(1)
v_mfma_f32_32x32x16_bf16 v[80:95], v[20:23], v[172:175], v[80:95]
ds_read_b128 v[28:31], v2 offset:21504
v_mul_f32 v47, v47, v13
v_cvt_pk_bf16_f32 v35, v46, v47
s_waitcnt lgkmcnt(1)
v_mfma_f32_32x32x16_bf16 v[64:79], v[24:27], v[176:179], v[64:79]
ds_read_b128 v[16:19], v2 offset:22528
buffer_store_dwordx4 v[32:35], v0, s[8:11], s27 offen offset:0 sc1
v_mul_f32 v12, v48, v48
s_waitcnt lgkmcnt(1)
v_mfma_f32_32x32x16_bf16 v[80:95], v[28:31], v[176:179], v[80:95]
ds_read_b128 v[20:23], v2 offset:23552
v_mul_f32 v13, v49, v49
v_fma_f32 v12, v12, v10, v5
s_waitcnt lgkmcnt(1)
v_mfma_f32_32x32x16_bf16 v[64:79], v[16:19], v[180:183], v[64:79]
ds_read_b128 v[24:27], v2 offset:24576
v_fma_f32 v13, v13, v10, v5
v_mul_f32 v12, v12, v48
s_waitcnt lgkmcnt(1)
v_mfma_f32_32x32x16_bf16 v[80:95], v[20:23], v[180:183], v[80:95]
ds_read_b128 v[28:31], v2 offset:25600
v_mul_f32 v13, v13, v49
v_exp_f32 v12, v12
s_waitcnt lgkmcnt(1)
v_mfma_f32_32x32x16_bf16 v[64:79], v[24:27], v[184:187], v[64:79]
ds_read_b128 v[16:19], v2 offset:26624
v_exp_f32 v13, v13
v_mul_f32 v56, v56, v48
s_waitcnt lgkmcnt(1)
v_mfma_f32_32x32x16_bf16 v[80:95], v[28:31], v[184:187], v[80:95]
ds_read_b128 v[20:23], v2 offset:27648
v_fma_f32 v12, v12, v11, v11
v_fma_f32 v13, v13, v11, v11
s_waitcnt lgkmcnt(1)
v_mfma_f32_32x32x16_bf16 v[64:79], v[16:19], v[188:191], v[64:79]
ds_read_b128 v[24:27], v2 offset:28672
v_rcp_f32 v12, v12
v_rcp_f32 v13, v13
s_waitcnt lgkmcnt(1)
v_mfma_f32_32x32x16_bf16 v[80:95], v[20:23], v[188:191], v[80:95]
ds_read_b128 v[28:31], v2 offset:29696
v_mul_f32 v57, v57, v49
v_mul_f32 v56, v56, v12
s_waitcnt lgkmcnt(1)
v_mfma_f32_32x32x16_bf16 v[64:79], v[24:27], v[192:195], v[64:79]
ds_read_b128 v[16:19], v2 offset:30720
v_mul_f32 v57, v57, v13
v_cvt_pk_bf16_f32 v48, v56, v57
s_waitcnt lgkmcnt(1)
v_mfma_f32_32x32x16_bf16 v[80:95], v[28:31], v[192:195], v[80:95]
ds_read_b128 v[20:23], v2 offset:31744
v_mul_f32 v12, v50, v50
v_mul_f32 v13, v51, v51
s_waitcnt lgkmcnt(1)
v_mfma_f32_32x32x16_bf16 v[64:79], v[16:19], v[196:199], v[64:79]
ds_read_b128 v[24:27], v2 offset:32768
v_fma_f32 v12, v12, v10, v5
v_fma_f32 v13, v13, v10, v5
s_waitcnt lgkmcnt(1)
v_mfma_f32_32x32x16_bf16 v[80:95], v[20:23], v[196:199], v[80:95]
ds_read_b128 v[28:31], v2 offset:33792
v_mul_f32 v12, v12, v50
v_mul_f32 v13, v13, v51
s_waitcnt lgkmcnt(1)
v_mfma_f32_32x32x16_bf16 v[64:79], v[24:27], v[200:203], v[64:79]
ds_read_b128 v[16:19], v2 offset:34816
v_exp_f32 v12, v12
v_exp_f32 v13, v13
s_waitcnt lgkmcnt(1)
v_mfma_f32_32x32x16_bf16 v[80:95], v[28:31], v[200:203], v[80:95]
ds_read_b128 v[20:23], v2 offset:35840
v_mul_f32 v58, v58, v50
v_fma_f32 v12, v12, v11, v11
s_waitcnt lgkmcnt(1)
v_mfma_f32_32x32x16_bf16 v[64:79], v[16:19], v[204:207], v[64:79]
ds_read_b128 v[24:27], v2 offset:36864
v_fma_f32 v13, v13, v11, v11
v_rcp_f32 v12, v12
s_waitcnt lgkmcnt(1)
v_mfma_f32_32x32x16_bf16 v[80:95], v[20:23], v[204:207], v[80:95]
ds_read_b128 v[28:31], v2 offset:37888
v_rcp_f32 v13, v13
v_mul_f32 v59, v59, v51
s_waitcnt lgkmcnt(1)
v_mfma_f32_32x32x16_bf16 v[64:79], v[24:27], v[208:211], v[64:79]
ds_read_b128 v[16:19], v2 offset:38912
v_mul_f32 v58, v58, v12
v_mul_f32 v59, v59, v13
s_waitcnt lgkmcnt(1)
v_mfma_f32_32x32x16_bf16 v[80:95], v[28:31], v[208:211], v[80:95]
ds_read_b128 v[20:23], v2 offset:39936
v_cvt_pk_bf16_f32 v49, v58, v59
v_mul_f32 v12, v52, v52
s_barrier
s_waitcnt lgkmcnt(1)
v_mfma_f32_32x32x16_bf16 v[64:79], v[16:19], v[212:215], v[64:79]
ds_read_b128 v[24:27], v2 offset:40960
v_mul_f32 v13, v53, v53
v_fma_f32 v12, v12, v10, v5
s_waitcnt lgkmcnt(1)
v_mfma_f32_32x32x16_bf16 v[80:95], v[20:23], v[212:215], v[80:95]
ds_read_b128 v[28:31], v2 offset:41984
v_fma_f32 v13, v13, v10, v5
v_mul_f32 v12, v12, v52
s_waitcnt lgkmcnt(1)
v_mfma_f32_32x32x16_bf16 v[64:79], v[24:27], v[216:219], v[64:79]
ds_read_b128 v[16:19], v2 offset:43008
v_mul_f32 v13, v13, v53
v_exp_f32 v12, v12
s_waitcnt lgkmcnt(1)
v_mfma_f32_32x32x16_bf16 v[80:95], v[28:31], v[216:219], v[80:95]
ds_read_b128 v[20:23], v2 offset:44032
v_exp_f32 v13, v13
v_mul_f32 v60, v60, v52
s_waitcnt lgkmcnt(1)
v_mfma_f32_32x32x16_bf16 v[64:79], v[16:19], v[220:223], v[64:79]
ds_read_b128 v[24:27], v2 offset:45056
v_fma_f32 v12, v12, v11, v11
v_fma_f32 v13, v13, v11, v11
s_waitcnt lgkmcnt(1)
v_mfma_f32_32x32x16_bf16 v[80:95], v[20:23], v[220:223], v[80:95]
ds_read_b128 v[28:31], v2 offset:46080
v_rcp_f32 v12, v12
v_rcp_f32 v13, v13
s_waitcnt lgkmcnt(1)
v_mfma_f32_32x32x16_bf16 v[64:79], v[24:27], v[224:227], v[64:79]
ds_read_b128 v[16:19], v2 offset:47104
v_mul_f32 v61, v61, v53
v_mul_f32 v60, v60, v12
s_waitcnt lgkmcnt(1)
v_mfma_f32_32x32x16_bf16 v[80:95], v[28:31], v[224:227], v[80:95]
ds_read_b128 v[20:23], v2 offset:48128
v_mul_f32 v61, v61, v13
v_cvt_pk_bf16_f32 v50, v60, v61
s_waitcnt lgkmcnt(1)
v_mfma_f32_32x32x16_bf16 v[64:79], v[16:19], v[228:231], v[64:79]
ds_read_b128 v[24:27], v2 offset:49152
v_mul_f32 v12, v54, v54
v_mul_f32 v13, v55, v55
s_waitcnt lgkmcnt(1)
v_mfma_f32_32x32x16_bf16 v[80:95], v[20:23], v[228:231], v[80:95]
ds_read_b128 v[28:31], v2 offset:50176
v_fma_f32 v12, v12, v10, v5
v_fma_f32 v13, v13, v10, v5
s_waitcnt lgkmcnt(1)
v_mfma_f32_32x32x16_bf16 v[64:79], v[24:27], v[232:235], v[64:79]
ds_read_b128 v[16:19], v2 offset:51200
v_mul_f32 v12, v12, v54
v_mul_f32 v13, v13, v55
s_waitcnt lgkmcnt(1)
v_mfma_f32_32x32x16_bf16 v[80:95], v[28:31], v[232:235], v[80:95]
ds_read_b128 v[20:23], v2 offset:52224
v_exp_f32 v12, v12
v_exp_f32 v13, v13
s_waitcnt lgkmcnt(1)
v_mfma_f32_32x32x16_bf16 v[64:79], v[16:19], v[236:239], v[64:79]
ds_read_b128 v[24:27], v2 offset:53248
v_mul_f32 v62, v62, v54
v_fma_f32 v12, v12, v11, v11
s_waitcnt lgkmcnt(1)
v_mfma_f32_32x32x16_bf16 v[80:95], v[20:23], v[236:239], v[80:95]
ds_read_b128 v[28:31], v2 offset:54272
v_fma_f32 v13, v13, v11, v11
v_rcp_f32 v12, v12
s_waitcnt lgkmcnt(1)
v_mfma_f32_32x32x16_bf16 v[64:79], v[24:27], v[240:243], v[64:79]
ds_read_b128 v[16:19], v2 offset:55296
v_rcp_f32 v13, v13
v_mul_f32 v63, v63, v55
s_waitcnt lgkmcnt(1)
v_mfma_f32_32x32x16_bf16 v[80:95], v[28:31], v[240:243], v[80:95]
ds_read_b128 v[20:23], v2 offset:56320
v_mul_f32 v62, v62, v12
v_mul_f32 v63, v63, v13
s_waitcnt lgkmcnt(1)
v_mfma_f32_32x32x16_bf16 v[64:79], v[16:19], v[244:247], v[64:79]
ds_read_b128 v[24:27], v2 offset:57344
v_cvt_pk_bf16_f32 v51, v62, v63
buffer_store_dwordx4 v[48:51], v0, s[8:11], s27 offen offset:512 sc1
s_waitcnt lgkmcnt(1)
v_mfma_f32_32x32x16_bf16 v[80:95], v[20:23], v[244:247], v[80:95]
ds_read_b128 v[28:31], v2 offset:58368
s_add_u32 s27, s27, 16384
s_waitcnt lgkmcnt(1)
v_mfma_f32_32x32x16_bf16 v[64:79], v[24:27], v[248:251], v[64:79]
ds_read_b128 v[16:19], v2 offset:59392
s_waitcnt lgkmcnt(1)
v_mfma_f32_32x32x16_bf16 v[80:95], v[28:31], v[248:251], v[80:95]
ds_read_b128 v[20:23], v2 offset:60416
s_waitcnt lgkmcnt(1)
v_mfma_f32_32x32x16_bf16 v[64:79], v[16:19], v[252:255], v[64:79]
ds_read_b128 v[24:27], v4 offset:22528
s_waitcnt lgkmcnt(1)
v_mfma_f32_32x32x16_bf16 v[80:95], v[20:23], v[252:255], v[80:95]
ds_read_b128 v[28:31], v4 offset:23552
s_barrier
s_waitcnt lgkmcnt(1)
v_mfma_f32_32x32x16_bf16 v[64:79], v[24:27], v[6:9], v[64:79]
ds_read_b128 v[16:19], v3 offset:0
s_waitcnt lgkmcnt(1)
v_mfma_f32_32x32x16_bf16 v[80:95], v[28:31], v[6:9], v[80:95]
ds_read_b128 v[20:23], v3 offset:1024
s_waitcnt lgkmcnt(1)
v_mfma_f32_32x32x16_bf16 v[32:47], v[16:19], v[96:99], 0
ds_read_b128 v[24:27], v3 offset:2048
s_waitcnt lgkmcnt(1)
v_mfma_f32_32x32x16_bf16 v[48:63], v[20:23], v[96:99], 0
ds_read_b128 v[28:31], v3 offset:3072
s_waitcnt lgkmcnt(1)
v_mfma_f32_32x32x16_bf16 v[32:47], v[24:27], v[100:103], v[32:47]
ds_read_b128 v[16:19], v3 offset:4096
s_waitcnt lgkmcnt(1)
v_mfma_f32_32x32x16_bf16 v[48:63], v[28:31], v[100:103], v[48:63]
ds_read_b128 v[20:23], v3 offset:5120
s_waitcnt lgkmcnt(1)
v_mfma_f32_32x32x16_bf16 v[32:47], v[16:19], v[104:107], v[32:47]
ds_read_b128 v[24:27], v3 offset:6144
s_waitcnt lgkmcnt(1)
v_mfma_f32_32x32x16_bf16 v[48:63], v[20:23], v[104:107], v[48:63]
ds_read_b128 v[28:31], v3 offset:7168
s_waitcnt lgkmcnt(1)
v_mfma_f32_32x32x16_bf16 v[32:47], v[24:27], v[108:111], v[32:47]
ds_read_b128 v[16:19], v3 offset:8192
v_mul_f32 v12, v64, v64
v_mul_f32 v13, v65, v65
s_waitcnt lgkmcnt(1)
v_mfma_f32_32x32x16_bf16 v[48:63], v[28:31], v[108:111], v[48:63]
ds_read_b128 v[20:23], v3 offset:9216
v_fma_f32 v12, v12, v10, v5
v_fma_f32 v13, v13, v10, v5
s_waitcnt lgkmcnt(1)
v_mfma_f32_32x32x16_bf16 v[32:47], v[16:19], v[112:115], v[32:47]
ds_read_b128 v[24:27], v3 offset:10240
v_mul_f32 v12, v12, v64
v_mul_f32 v13, v13, v65
s_waitcnt lgkmcnt(1)
v_mfma_f32_32x32x16_bf16 v[48:63], v[20:23], v[112:115], v[48:63]
ds_read_b128 v[28:31], v3 offset:11264
v_exp_f32 v12, v12
v_exp_f32 v13, v13
s_waitcnt lgkmcnt(1)
v_mfma_f32_32x32x16_bf16 v[32:47], v[24:27], v[116:119], v[32:47]
ds_read_b128 v[16:19], v3 offset:12288
v_mul_f32 v72, v72, v64
v_fma_f32 v12, v12, v11, v11
s_waitcnt lgkmcnt(1)
v_mfma_f32_32x32x16_bf16 v[48:63], v[28:31], v[116:119], v[48:63]
ds_read_b128 v[20:23], v3 offset:13312
v_fma_f32 v13, v13, v11, v11
v_rcp_f32 v12, v12
s_waitcnt lgkmcnt(1)
v_mfma_f32_32x32x16_bf16 v[32:47], v[16:19], v[120:123], v[32:47]
ds_read_b128 v[24:27], v3 offset:14336
v_rcp_f32 v13, v13
v_mul_f32 v73, v73, v65
s_waitcnt lgkmcnt(1)
v_mfma_f32_32x32x16_bf16 v[48:63], v[20:23], v[120:123], v[48:63]
ds_read_b128 v[28:31], v3 offset:15360
v_mul_f32 v72, v72, v12
v_mul_f32 v73, v73, v13
s_waitcnt lgkmcnt(1)
v_mfma_f32_32x32x16_bf16 v[32:47], v[24:27], v[124:127], v[32:47]
ds_read_b128 v[16:19], v3 offset:16384
v_cvt_pk_bf16_f32 v64, v72, v73
v_mul_f32 v12, v66, v66
s_waitcnt lgkmcnt(1)
v_mfma_f32_32x32x16_bf16 v[48:63], v[28:31], v[124:127], v[48:63]
ds_read_b128 v[20:23], v3 offset:17408
v_mul_f32 v13, v67, v67
v_fma_f32 v12, v12, v10, v5
s_waitcnt vmcnt(0)
s_mov_b64 exec, 1
v_mov_b32 v14, 0
v_mov_b32 v15, s23
s_cmp_eq_u32 s41, 0
s_cbranch_scc1 Lflsafe_133
buffer_store_dword v15, v14, s[8:11], s28 offen
s_branch Lfldone_134
Lflsafe_133:
buffer_wbl2 sc1
s_waitcnt vmcnt(0)
buffer_store_dword v15, v14, s[8:11], s28 offen sc1
Lfldone_134:
s_mov_b64 exec, -1
s_add_u32 s28, s28, 64
s_waitcnt lgkmcnt(1)
v_mfma_f32_32x32x16_bf16 v[32:47], v[16:19], v[128:131], v[32:47]
ds_read_b128 v[24:27], v3 offset:18432
v_fma_f32 v13, v13, v10, v5
v_mul_f32 v12, v12, v66
s_waitcnt lgkmcnt(1)
v_mfma_f32_32x32x16_bf16 v[48:63], v[20:23], v[128:131], v[48:63]
ds_read_b128 v[28:31], v3 offset:19456
v_mul_f32 v13, v13, v67
v_exp_f32 v12, v12
s_barrier
s_waitcnt lgkmcnt(1)
v_mfma_f32_32x32x16_bf16 v[32:47], v[24:27], v[132:135], v[32:47]
ds_read_b128 v[16:19], v3 offset:20480
v_exp_f32 v13, v13
v_mul_f32 v74, v74, v66
s_waitcnt lgkmcnt(1)
v_mfma_f32_32x32x16_bf16 v[48:63], v[28:31], v[132:135], v[48:63]
ds_read_b128 v[20:23], v3 offset:21504
v_fma_f32 v12, v12, v11, v11
v_fma_f32 v13, v13, v11, v11
s_waitcnt lgkmcnt(1)
v_mfma_f32_32x32x16_bf16 v[32:47], v[16:19], v[136:139], v[32:47]
ds_read_b128 v[24:27], v3 offset:22528
v_rcp_f32 v12, v12
v_rcp_f32 v13, v13
s_waitcnt lgkmcnt(1)
v_mfma_f32_32x32x16_bf16 v[48:63], v[20:23], v[136:139], v[48:63]
ds_read_b128 v[28:31], v3 offset:23552
v_mul_f32 v75, v75, v67
v_mul_f32 v74, v74, v12
s_waitcnt lgkmcnt(1)
v_mfma_f32_32x32x16_bf16 v[32:47], v[24:27], v[140:143], v[32:47]
ds_read_b128 v[16:19], v3 offset:24576
v_mul_f32 v75, v75, v13
v_cvt_pk_bf16_f32 v65, v74, v75
s_waitcnt lgkmcnt(1)
v_mfma_f32_32x32x16_bf16 v[48:63], v[28:31], v[140:143], v[48:63]
ds_read_b128 v[20:23], v3 offset:25600
v_mul_f32 v12, v68, v68
v_mul_f32 v13, v69, v69
s_waitcnt lgkmcnt(1)
v_mfma_f32_32x32x16_bf16 v[32:47], v[16:19], v[144:147], v[32:47]
ds_read_b128 v[24:27], v3 offset:26624
v_fma_f32 v12, v12, v10, v5
v_fma_f32 v13, v13, v10, v5
s_waitcnt lgkmcnt(1)
v_mfma_f32_32x32x16_bf16 v[48:63], v[20:23], v[144:147], v[48:63]
ds_read_b128 v[28:31], v3 offset:27648
v_mul_f32 v12, v12, v68
v_mul_f32 v13, v13, v69
s_waitcnt lgkmcnt(1)
v_mfma_f32_32x32x16_bf16 v[32:47], v[24:27], v[148:151], v[32:47]
ds_read_b128 v[16:19], v3 offset:28672
v_exp_f32 v12, v12
v_exp_f32 v13, v13
s_waitcnt lgkmcnt(1)
v_mfma_f32_32x32x16_bf16 v[48:63], v[28:31], v[148:151], v[48:63]
ds_read_b128 v[20:23], v3 offset:29696
v_mul_f32 v76, v76, v68
v_fma_f32 v12, v12, v11, v11
s_waitcnt lgkmcnt(1)
v_mfma_f32_32x32x16_bf16 v[32:47], v[16:19], v[152:155], v[32:47]
ds_read_b128 v[24:27], v3 offset:30720
v_fma_f32 v13, v13, v11, v11
v_rcp_f32 v12, v12
s_waitcnt lgkmcnt(1)
v_mfma_f32_32x32x16_bf16 v[48:63], v[20:23], v[152:155], v[48:63]
ds_read_b128 v[28:31], v3 offset:31744
v_rcp_f32 v13, v13
v_mul_f32 v77, v77, v69
s_waitcnt lgkmcnt(1)
v_mfma_f32_32x32x16_bf16 v[32:47], v[24:27], v[156:159], v[32:47]
ds_read_b128 v[16:19], v3 offset:32768
v_mul_f32 v76, v76, v12
v_mul_f32 v77, v77, v13
s_waitcnt lgkmcnt(1)
v_mfma_f32_32x32x16_bf16 v[48:63], v[28:31], v[156:159], v[48:63]
ds_read_b128 v[20:23], v3 offset:33792
v_cvt_pk_bf16_f32 v66, v76, v77
v_mul_f32 v12, v70, v70
s_waitcnt lgkmcnt(1)
v_mfma_f32_32x32x16_bf16 v[32:47], v[16:19], v[160:163], v[32:47]
ds_read_b128 v[24:27], v3 offset:34816
v_mul_f32 v13, v71, v71
v_fma_f32 v12, v12, v10, v5
s_waitcnt lgkmcnt(1)
v_mfma_f32_32x32x16_bf16 v[48:63], v[20:23], v[160:163], v[48:63]
ds_read_b128 v[28:31], v3 offset:35840
v_fma_f32 v13, v13, v10, v5
v_mul_f32 v12, v12, v70
s_waitcnt lgkmcnt(1)
v_mfma_f32_32x32x16_bf16 v[32:47], v[24:27], v[164:167], v[32:47]
ds_read_b128 v[16:19], v3 offset:36864
v_mul_f32 v13, v13, v71
v_exp_f32 v12, v12
s_waitcnt lgkmcnt(1)
v_mfma_f32_32x32x16_bf16 v[48:63], v[28:31], v[164:167], v[48:63]
ds_read_b128 v[20:23], v3 offset:37888
v_exp_f32 v13, v13
v_mul_f32 v78, v78, v70
s_waitcnt lgkmcnt(1)
v_mfma_f32_32x32x16_bf16 v[32:47], v[16:19], v[168:171], v[32:47]
ds_read_b128 v[24:27], v3 offset:38912
v_fma_f32 v12, v12, v11, v11
v_fma_f32 v13, v13, v11, v11
s_waitcnt lgkmcnt(1)
v_mfma_f32_32x32x16_bf16 v[48:63], v[20:23], v[168:171], v[48:63]
ds_read_b128 v[28:31], v3 offset:39936
v_rcp_f32 v12, v12
v_rcp_f32 v13, v13
s_barrier
s_waitcnt lgkmcnt(1)
v_mfma_f32_32x32x16_bf16 v[32:47], v[24:27], v[172:175], v[32:47]
ds_read_b128 v[16:19], v3 offset:40960
v_mul_f32 v79, v79, v71
v_mul_f32 v78, v78, v12
s_waitcnt lgkmcnt(1)
v_mfma_f32_32x32x16_bf16 v[48:63], v[28:31], v[172:175], v[48:63]
ds_read_b128 v[20:23], v3 offset:41984
v_mul_f32 v79, v79, v13
v_cvt_pk_bf16_f32 v67, v78, v79
s_waitcnt lgkmcnt(1)
v_mfma_f32_32x32x16_bf16 v[32:47], v[16:19], v[176:179], v[32:47]
ds_read_b128 v[24:27], v3 offset:43008
buffer_store_dwordx4 v[64:67], v0, s[8:11], s27 offen offset:0 sc1
v_mul_f32 v12, v80, v80
s_waitcnt lgkmcnt(1)
v_mfma_f32_32x32x16_bf16 v[48:63], v[20:23], v[176:179], v[48:63]
ds_read_b128 v[28:31], v3 offset:44032
v_mul_f32 v13, v81, v81
v_fma_f32 v12, v12, v10, v5
s_waitcnt lgkmcnt(1)
v_mfma_f32_32x32x16_bf16 v[32:47], v[24:27], v[180:183], v[32:47]
ds_read_b128 v[16:19], v3 offset:45056
v_fma_f32 v13, v13, v10, v5
v_mul_f32 v12, v12, v80
s_waitcnt lgkmcnt(1)
v_mfma_f32_32x32x16_bf16 v[48:63], v[28:31], v[180:183], v[48:63]
ds_read_b128 v[20:23], v3 offset:46080
v_mul_f32 v13, v13, v81
v_exp_f32 v12, v12
s_waitcnt lgkmcnt(1)
v_mfma_f32_32x32x16_bf16 v[32:47], v[16:19], v[184:187], v[32:47]
ds_read_b128 v[24:27], v3 offset:47104
v_exp_f32 v13, v13
v_mul_f32 v88, v88, v80
s_waitcnt lgkmcnt(1)
v_mfma_f32_32x32x16_bf16 v[48:63], v[20:23], v[184:187], v[48:63]
ds_read_b128 v[28:31], v3 offset:48128
v_fma_f32 v12, v12, v11, v11
v_fma_f32 v13, v13, v11, v11
s_waitcnt lgkmcnt(1)
v_mfma_f32_32x32x16_bf16 v[32:47], v[24:27], v[188:191], v[32:47]
ds_read_b128 v[16:19], v3 offset:49152
v_rcp_f32 v12, v12
v_rcp_f32 v13, v13
s_waitcnt lgkmcnt(1)
v_mfma_f32_32x32x16_bf16 v[48:63], v[28:31], v[188:191], v[48:63]
ds_read_b128 v[20:23], v3 offset:50176
v_mul_f32 v89, v89, v81
v_mul_f32 v88, v88, v12
s_waitcnt lgkmcnt(1)
v_mfma_f32_32x32x16_bf16 v[32:47], v[16:19], v[192:195], v[32:47]
ds_read_b128 v[24:27], v3 offset:51200
v_mul_f32 v89, v89, v13
v_cvt_pk_bf16_f32 v80, v88, v89
s_waitcnt lgkmcnt(1)
v_mfma_f32_32x32x16_bf16 v[48:63], v[20:23], v[192:195], v[48:63]
ds_read_b128 v[28:31], v3 offset:52224
v_mul_f32 v12, v82, v82
v_mul_f32 v13, v83, v83
s_waitcnt lgkmcnt(1)
v_mfma_f32_32x32x16_bf16 v[32:47], v[24:27], v[196:199], v[32:47]
ds_read_b128 v[16:19], v3 offset:53248
v_fma_f32 v12, v12, v10, v5
v_fma_f32 v13, v13, v10, v5
s_waitcnt lgkmcnt(1)
v_mfma_f32_32x32x16_bf16 v[48:63], v[28:31], v[196:199], v[48:63]
ds_read_b128 v[20:23], v3 offset:54272
v_mul_f32 v12, v12, v82
v_mul_f32 v13, v13, v83
s_waitcnt lgkmcnt(1)
v_mfma_f32_32x32x16_bf16 v[32:47], v[16:19], v[200:203], v[32:47]
ds_read_b128 v[24:27], v3 offset:55296
v_exp_f32 v12, v12
v_exp_f32 v13, v13
s_waitcnt lgkmcnt(1)
v_mfma_f32_32x32x16_bf16 v[48:63], v[20:23], v[200:203], v[48:63]
ds_read_b128 v[28:31], v3 offset:56320
v_mul_f32 v90, v90, v82
v_fma_f32 v12, v12, v11, v11
s_waitcnt lgkmcnt(1)
v_mfma_f32_32x32x16_bf16 v[32:47], v[24:27], v[204:207], v[32:47]
ds_read_b128 v[16:19], v3 offset:57344
v_fma_f32 v13, v13, v11, v11
v_rcp_f32 v12, v12
s_waitcnt lgkmcnt(1)
v_mfma_f32_32x32x16_bf16 v[48:63], v[28:31], v[204:207], v[48:63]
ds_read_b128 v[20:23], v3 offset:58368
v_rcp_f32 v13, v13
v_mul_f32 v91, v91, v83
s_waitcnt lgkmcnt(1)
v_mfma_f32_32x32x16_bf16 v[32:47], v[16:19], v[208:211], v[32:47]
ds_read_b128 v[24:27], v3 offset:59392
v_mul_f32 v90, v90, v12
v_mul_f32 v91, v91, v13
s_waitcnt lgkmcnt(1)
v_mfma_f32_32x32x16_bf16 v[48:63], v[20:23], v[208:211], v[48:63]
ds_read_b128 v[28:31], v3 offset:60416
v_cvt_pk_bf16_f32 v81, v90, v91
v_mul_f32 v12, v84, v84
s_barrier
s_waitcnt lgkmcnt(1)
v_mfma_f32_32x32x16_bf16 v[32:47], v[24:27], v[212:215], v[32:47]
ds_read_b128 v[16:19], v4 offset:0
v_mul_f32 v13, v85, v85
v_fma_f32 v12, v12, v10, v5
s_waitcnt lgkmcnt(1)
v_mfma_f32_32x32x16_bf16 v[48:63], v[28:31], v[212:215], v[48:63]
ds_read_b128 v[20:23], v4 offset:1024
v_fma_f32 v13, v13, v10, v5
v_mul_f32 v12, v12, v84
s_waitcnt lgkmcnt(1)
v_mfma_f32_32x32x16_bf16 v[32:47], v[16:19], v[216:219], v[32:47]
ds_read_b128 v[24:27], v4 offset:2048
v_mul_f32 v13, v13, v85
v_exp_f32 v12, v12
s_waitcnt lgkmcnt(1)
v_mfma_f32_32x32x16_bf16 v[48:63], v[20:23], v[216:219], v[48:63]
ds_read_b128 v[28:31], v4 offset:3072
v_exp_f32 v13, v13
v_mul_f32 v92, v92, v84
s_waitcnt lgkmcnt(1)
v_mfma_f32_32x32x16_bf16 v[32:47], v[24:27], v[220:223], v[32:47]
ds_read_b128 v[16:19], v4 offset:4096
v_fma_f32 v12, v12, v11, v11
v_fma_f32 v13, v13, v11, v11
s_waitcnt lgkmcnt(1)
v_mfma_f32_32x32x16_bf16 v[48:63], v[28:31], v[220:223], v[48:63]
ds_read_b128 v[20:23], v4 offset:5120
v_rcp_f32 v12, v12
v_rcp_f32 v13, v13
s_waitcnt lgkmcnt(1)
v_mfma_f32_32x32x16_bf16 v[32:47], v[16:19], v[224:227], v[32:47]
ds_read_b128 v[24:27], v4 offset:6144
v_mul_f32 v93, v93, v85
v_mul_f32 v92, v92, v12
s_waitcnt lgkmcnt(1)
v_mfma_f32_32x32x16_bf16 v[48:63], v[20:23], v[224:227], v[48:63]
ds_read_b128 v[28:31], v4 offset:7168
v_mul_f32 v93, v93, v13
v_cvt_pk_bf16_f32 v82, v92, v93
s_waitcnt lgkmcnt(1)
v_mfma_f32_32x32x16_bf16 v[32:47], v[24:27], v[228:231], v[32:47]
ds_read_b128 v[16:19], v4 offset:8192
v_mul_f32 v12, v86, v86
v_mul_f32 v13, v87, v87
s_waitcnt lgkmcnt(1)
v_mfma_f32_32x32x16_bf16 v[48:63], v[28:31], v[228:231], v[48:63]
ds_read_b128 v[20:23], v4 offset:9216
v_fma_f32 v12, v12, v10, v5
v_fma_f32 v13, v13, v10, v5
s_waitcnt lgkmcnt(1)
v_mfma_f32_32x32x16_bf16 v[32:47], v[16:19], v[232:235], v[32:47]
ds_read_b128 v[24:27], v4 offset:10240
v_mul_f32 v12, v12, v86
v_mul_f32 v13, v13, v87
s_waitcnt lgkmcnt(1)
v_mfma_f32_32x32x16_bf16 v[48:63], v[20:23], v[232:235], v[48:63]
ds_read_b128 v[28:31], v4 offset:11264
v_exp_f32 v12, v12
v_exp_f32 v13, v13
s_waitcnt lgkmcnt(1)
v_mfma_f32_32x32x16_bf16 v[32:47], v[24:27], v[236:239], v[32:47]
ds_read_b128 v[16:19], v4 offset:12288
v_mul_f32 v94, v94, v86
v_fma_f32 v12, v12, v11, v11
s_waitcnt lgkmcnt(1)
v_mfma_f32_32x32x16_bf16 v[48:63], v[28:31], v[236:239], v[48:63]
ds_read_b128 v[20:23], v4 offset:13312
v_fma_f32 v13, v13, v11, v11
v_rcp_f32 v12, v12
s_waitcnt lgkmcnt(1)
v_mfma_f32_32x32x16_bf16 v[32:47], v[16:19], v[240:243], v[32:47]
ds_read_b128 v[24:27], v4 offset:14336
v_rcp_f32 v13, v13
v_mul_f32 v95, v95, v87
s_waitcnt lgkmcnt(1)
v_mfma_f32_32x32x16_bf16 v[48:63], v[20:23], v[240:243], v[48:63]
ds_read_b128 v[28:31], v4 offset:15360
v_mul_f32 v94, v94, v12
v_mul_f32 v95, v95, v13
s_waitcnt lgkmcnt(1)
v_mfma_f32_32x32x16_bf16 v[32:47], v[24:27], v[244:247], v[32:47]
ds_read_b128 v[16:19], v4 offset:16384
v_cvt_pk_bf16_f32 v83, v94, v95
buffer_store_dwordx4 v[80:83], v0, s[8:11], s27 offen offset:512 sc1
s_waitcnt lgkmcnt(1)
v_mfma_f32_32x32x16_bf16 v[48:63], v[28:31], v[244:247], v[48:63]
ds_read_b128 v[20:23], v4 offset:17408
s_add_u32 s27, s27, 16384
s_waitcnt lgkmcnt(1)
v_mfma_f32_32x32x16_bf16 v[32:47], v[16:19], v[248:251], v[32:47]
ds_read_b128 v[24:27], v4 offset:18432
s_waitcnt lgkmcnt(1)
v_mfma_f32_32x32x16_bf16 v[48:63], v[20:23], v[248:251], v[48:63]
ds_read_b128 v[28:31], v4 offset:19456
s_waitcnt lgkmcnt(1)
v_mfma_f32_32x32x16_bf16 v[32:47], v[24:27], v[252:255], v[32:47]
ds_read_b128 v[16:19], v4 offset:24576
s_waitcnt lgkmcnt(1)
v_mfma_f32_32x32x16_bf16 v[48:63], v[28:31], v[252:255], v[48:63]
ds_read_b128 v[20:23], v4 offset:25600
s_waitcnt lgkmcnt(1)
v_mfma_f32_32x32x16_bf16 v[32:47], v[16:19], v[6:9], v[32:47]
s_waitcnt lgkmcnt(0)
v_mfma_f32_32x32x16_bf16 v[48:63], v[20:23], v[6:9], v[48:63]
s_mul_i32 s25, s24, 49152
s_add_u32 s25, s25, 18513920
s_nop 7
v_mul_f32 v12, v32, v32
buffer_load_dwordx4 v[128:131], v2, s[8:11], s25 offen offset:0 sc1
v_mul_f32 v13, v33, v33
v_fma_f32 v12, v12, v10, v5
v_fma_f32 v13, v13, v10, v5
v_mul_f32 v12, v12, v32
v_mul_f32 v13, v13, v33
v_exp_f32 v12, v12
v_exp_f32 v13, v13
v_mul_f32 v40, v40, v32
buffer_load_dwordx4 v[132:135], v2, s[8:11], s25 offen offset:1024 sc1
v_fma_f32 v12, v12, v11, v11
v_fma_f32 v13, v13, v11, v11
v_rcp_f32 v12, v12
v_rcp_f32 v13, v13
v_mul_f32 v41, v41, v33
v_mul_f32 v40, v40, v12
v_mul_f32 v41, v41, v13
v_cvt_pk_bf16_f32 v32, v40, v41
buffer_load_dwordx4 v[136:139], v2, s[8:11], s25 offen offset:2048 sc1
v_mul_f32 v12, v34, v34
v_mul_f32 v13, v35, v35
v_fma_f32 v12, v12, v10, v5
v_fma_f32 v13, v13, v10, v5
v_mul_f32 v12, v12, v34
v_mul_f32 v13, v13, v35
v_exp_f32 v12, v12
v_exp_f32 v13, v13
buffer_load_dwordx4 v[140:143], v2, s[8:11], s25 offen offset:3072 sc1
v_mul_f32 v42, v42, v34
v_fma_f32 v12, v12, v11, v11
v_fma_f32 v13, v13, v11, v11
v_rcp_f32 v12, v12
v_rcp_f32 v13, v13
v_mul_f32 v43, v43, v35
v_mul_f32 v42, v42, v12
v_mul_f32 v43, v43, v13
s_add_u32 s25, s25, 4096
buffer_load_dwordx4 v[144:147], v2, s[8:11], s25 offen offset:0 sc1
v_cvt_pk_bf16_f32 v33, v42, v43
v_mul_f32 v12, v36, v36
v_mul_f32 v13, v37, v37
v_fma_f32 v12, v12, v10, v5
v_fma_f32 v13, v13, v10, v5
v_mul_f32 v12, v12, v36
v_mul_f32 v13, v13, v37
v_exp_f32 v12, v12
buffer_load_dwordx4 v[148:151], v2, s[8:11], s25 offen offset:1024 sc1
v_exp_f32 v13, v13
v_mul_f32 v44, v44, v36
v_fma_f32 v12, v12, v11, v11
v_fma_f32 v13, v13, v11, v11
v_rcp_f32 v12, v12
v_rcp_f32 v13, v13
v_mul_f32 v45, v45, v37
v_mul_f32 v44, v44, v12
buffer_load_dwordx4 v[152:155], v2, s[8:11], s25 offen offset:2048 sc1
v_mul_f32 v45, v45, v13
v_cvt_pk_bf16_f32 v34, v44, v45
v_mul_f32 v12, v38, v38
v_mul_f32 v13, v39, v39
v_fma_f32 v12, v12, v10, v5
v_fma_f32 v13, v13, v10, v5
v_mul_f32 v12, v12, v38
v_mul_f32 v13, v13, v39
buffer_load_dwordx4 v[156:159], v2, s[8:11], s25 offen offset:3072 sc1
v_exp_f32 v12, v12
v_exp_f32 v13, v13
v_mul_f32 v46, v46, v38
s_waitcnt vmcnt(8)
s_mov_b64 exec, 1
v_mov_b32 v14, 0
v_mov_b32 v15, s23
s_cmp_eq_u32 s41, 0
s_cbranch_scc1 Lflsafe_135
buffer_store_dword v15, v14, s[8:11], s28 offen
s_branch Lfldone_136
Lflsafe_135:
buffer_wbl2 sc1
s_waitcnt vmcnt(0)
buffer_store_dword v15, v14, s[8:11], s28 offen sc1
Lfldone_136:
s_mov_b64 exec, -1
s_add_u32 s28, s28, 64
v_fma_f32 v12, v12, v11, v11
v_fma_f32 v13, v13, v11, v11
v_rcp_f32 v12, v12
v_rcp_f32 v13, v13
v_mul_f32 v47, v47, v39
s_add_u32 s25, s25, 4096
buffer_load_dwordx4 v[160:163], v2, s[8:11], s25 offen offset:0 sc1
v_mul_f32 v46, v46, v12
v_mul_f32 v47, v47, v13
v_cvt_pk_bf16_f32 v35, v46, v47
buffer_store_dwordx4 v[32:35], v0, s[8:11], s27 offen offset:0 sc1
v_mul_f32 v12, v48, v48
v_mul_f32 v13, v49, v49
v_fma_f32 v12, v12, v10, v5
v_fma_f32 v13, v13, v10, v5
buffer_load_dwordx4 v[164:167], v2, s[8:11], s25 offen offset:1024 sc1
v_mul_f32 v12, v12, v48
v_mul_f32 v13, v13, v49
v_exp_f32 v12, v12
v_exp_f32 v13, v13
v_mul_f32 v56, v56, v48
v_fma_f32 v12, v12, v11, v11
v_fma_f32 v13, v13, v11, v11
v_rcp_f32 v12, v12
buffer_load_dwordx4 v[168:171], v2, s[8:11], s25 offen offset:2048 sc1
v_rcp_f32 v13, v13
v_mul_f32 v57, v57, v49
v_mul_f32 v56, v56, v12
v_mul_f32 v57, v57, v13
v_cvt_pk_bf16_f32 v48, v56, v57
v_mul_f32 v12, v50, v50
v_mul_f32 v13, v51, v51
v_fma_f32 v12, v12, v10, v5
buffer_load_dwordx4 v[172:175], v2, s[8:11], s25 offen offset:3072 sc1
v_fma_f32 v13, v13, v10, v5
v_mul_f32 v12, v12, v50
v_mul_f32 v13, v13, v51
v_exp_f32 v12, v12
v_exp_f32 v13, v13
v_mul_f32 v58, v58, v50
v_fma_f32 v12, v12, v11, v11
v_fma_f32 v13, v13, v11, v11
s_add_u32 s25, s25, 4096
buffer_load_dwordx4 v[176:179], v2, s[8:11], s25 offen offset:0 sc1
v_rcp_f32 v12, v12
v_rcp_f32 v13, v13
v_mul_f32 v59, v59, v51
v_mul_f32 v58, v58, v12
v_mul_f32 v59, v59, v13
v_cvt_pk_bf16_f32 v49, v58, v59
v_mul_f32 v12, v52, v52
v_mul_f32 v13, v53, v53
buffer_load_dwordx4 v[180:183], v2, s[8:11], s25 offen offset:1024 sc1
v_fma_f32 v12, v12, v10, v5
v_fma_f32 v13, v13, v10, v5
v_mul_f32 v12, v12, v52
v_mul_f32 v13, v13, v53
v_exp_f32 v12, v12
v_exp_f32 v13, v13
v_mul_f32 v60, v60, v52
v_fma_f32 v12, v12, v11, v11
buffer_load_dwordx4 v[184:187], v2, s[8:11], s25 offen offset:2048 sc1
v_fma_f32 v13, v13, v11, v11
v_rcp_f32 v12, v12
v_rcp_f32 v13, v13
v_mul_f32 v61, v61, v53
v_mul_f32 v60, v60, v12
v_mul_f32 v61, v61, v13
v_cvt_pk_bf16_f32 v50, v60, v61
v_mul_f32 v12, v54, v54
buffer_load_dwordx4 v[188:191], v2, s[8:11], s25 offen offset:3072 sc1
v_mul_f32 v13, v55, v55
v_fma_f32 v12, v12, v10, v5
v_fma_f32 v13, v13, v10, v5
v_mul_f32 v12, v12, v54
v_mul_f32 v13, v13, v55
v_exp_f32 v12, v12
v_exp_f32 v13, v13
v_mul_f32 v62, v62, v54
v_fma_f32 v12, v12, v11, v11
v_fma_f32 v13, v13, v11, v11
v_rcp_f32 v12, v12
v_rcp_f32 v13, v13
v_mul_f32 v63, v63, v55
v_mul_f32 v62, v62, v12
v_mul_f32 v63, v63, v13
v_cvt_pk_bf16_f32 v51, v62, v63
buffer_store_dwordx4 v[48:51], v0, s[8:11], s27 offen offset:512 sc1
s_add_u32 s27, s27, 16384
s_mul_i32 s26, s24, 20480
s_mul_i32 s27, s21, 160
s_add_u32 s26, s26, s27
s_mul_i32 s29, s3, 2560
s_add_u32 s29, s29, 149504
v_lshl_add_u32 v7, v1, 3, s29
ds_read_b64 v[12:13], v7 offset:0
ds_read_b64 v[14:15], v7 offset:512
ds_read_b64 v[16:17], v7 offset:1024
ds_read_b64 v[18:19], v7 offset:1536
ds_read_b64 v[20:21], v7 offset:2048
v_lshrrev_b32 v6, 4, v1
v_lshlrev_b32 v6, 3, v6
v_add_u32 v6, 160128, v6
ds_read_b64 v[44:45], v6 offset:0
ds_read_b64 v[46:47], v6 offset:32
ds_read_b64 v[48:49], v6 offset:64
ds_read_b64 v[50:51], v6 offset:96
ds_read_b64 v[52:53], v6 offset:128
s_barrier
ds_read_b128 v[64:67], v2 offset:0
ds_read_b128 v[68:71], v2 offset:1024
ds_read_b128 v[72:75], v2 offset:2048
ds_read_b128 v[76:79], v2 offset:3072
ds_read_b128 v[80:83], v2 offset:4096
s_waitcnt vmcnt(18) lgkmcnt(3)
v_mfma_f32_16x16x32_bf16 v[104:107], v[64:67], v[128:131], 0
ds_read_b128 v[84:87], v2 offset:5120
v_mfma_f32_16x16x32_bf16 v[108:111], v[68:71], v[128:131], 0
ds_read_b128 v[88:91], v2 offset:6144
s_waitcnt lgkmcnt(3)
v_mfma_f32_16x16x32_bf16 v[112:115], v[72:75], v[128:131], 0
ds_read_b128 v[92:95], v2 offset:7168
v_mfma_f32_16x16x32_bf16 v[116:119], v[76:79], v[128:131], 0
ds_read_b128 v[96:99], v2 offset:8192
s_waitcnt lgkmcnt(4)
v_mfma_f32_16x16x32_bf16 v[120:123], v[80:83], v[128:131], 0
ds_read_b128 v[100:103], v2 offset:9216
s_waitcnt vmcnt(17) lgkmcnt(3)
v_mfma_f32_16x16x32_bf16 v[104:107], v[84:87], v[132:135], v[104:107]
ds_read_b128 v[64:67], v2 offset:10240
v_mfma_f32_16x16x32_bf16 v[108:111], v[88:91], v[132:135], v[108:111]
ds_read_b128 v[68:71], v2 offset:11264
s_waitcnt lgkmcnt(3)
v_mfma_f32_16x16x32_bf16 v[112:115], v[92:95], v[132:135], v[112:115]
ds_read_b128 v[72:75], v2 offset:12288
v_mfma_f32_16x16x32_bf16 v[116:119], v[96:99], v[132:135], v[116:119]
ds_read_b128 v[76:79], v2 offset:13312
s_waitcnt lgkmcnt(4)
v_mfma_f32_16x16x32_bf16 v[120:123], v[100:103], v[132:135], v[120:123]
ds_read_b128 v[80:83], v2 offset:14336
s_waitcnt vmcnt(16) lgkmcnt(3)
v_mfma_f32_16x16x32_bf16 v[104:107], v[64:67], v[136:139], v[104:107]
ds_read_b128 v[84:87], v2 offset:15360
v_mfma_f32_16x16x32_bf16 v[108:111], v[68:71], v[136:139], v[108:111]
ds_read_b128 v[88:91], v2 offset:16384
s_waitcnt lgkmcnt(3)
v_mfma_f32_16x16x32_bf16 v[112:115], v[72:75], v[136:139], v[112:115]
ds_read_b128 v[92:95], v2 offset:17408
v_mfma_f32_16x16x32_bf16 v[116:119], v[76:79], v[136:139], v[116:119]
ds_read_b128 v[96:99], v2 offset:18432
s_waitcnt lgkmcnt(4)
v_mfma_f32_16x16x32_bf16 v[120:123], v[80:83], v[136:139], v[120:123]
ds_read_b128 v[100:103], v2 offset:19456
s_barrier
s_waitcnt vmcnt(15) lgkmcnt(3)
v_mfma_f32_16x16x32_bf16 v[104:107], v[84:87], v[140:143], v[104:107]
ds_read_b128 v[64:67], v2 offset:20480
v_mfma_f32_16x16x32_bf16 v[108:111], v[88:91], v[140:143], v[108:111]
ds_read_b128 v[68:71], v2 offset:21504
s_waitcnt lgkmcnt(3)
v_mfma_f32_16x16x32_bf16 v[112:115], v[92:95], v[140:143], v[112:115]
ds_read_b128 v[72:75], v2 offset:22528
v_mfma_f32_16x16x32_bf16 v[116:119], v[96:99], v[140:143], v[116:119]
ds_read_b128 v[76:79], v2 offset:23552
s_waitcnt lgkmcnt(4)
v_mfma_f32_16x16x32_bf16 v[120:123], v[100:103], v[140:143], v[120:123]
ds_read_b128 v[80:83], v2 offset:24576
s_waitcnt vmcnt(14) lgkmcnt(3)
v_mfma_f32_16x16x32_bf16 v[104:107], v[64:67], v[144:147], v[104:107]
ds_read_b128 v[84:87], v2 offset:25600
v_mfma_f32_16x16x32_bf16 v[108:111], v[68:71], v[144:147], v[108:111]
ds_read_b128 v[88:91], v2 offset:26624
s_waitcnt lgkmcnt(3)
v_mfma_f32_16x16x32_bf16 v[112:115], v[72:75], v[144:147], v[112:115]
ds_read_b128 v[92:95], v2 offset:27648
v_mfma_f32_16x16x32_bf16 v[116:119], v[76:79], v[144:147], v[116:119]
ds_read_b128 v[96:99], v2 offset:28672
s_waitcnt lgkmcnt(4)
v_mfma_f32_16x16x32_bf16 v[120:123], v[80:83], v[144:147], v[120:123]
ds_read_b128 v[100:103], v2 offset:29696
v_lshlrev_b32 v24, 16, v44
v_and_b32 v25, 0xffff0000, v44
v_lshlrev_b32 v26, 16, v45
v_and_b32 v27, 0xffff0000, v45
v_lshlrev_b32 v28, 16, v46
s_waitcnt vmcnt(13) lgkmcnt(3)
v_mfma_f32_16x16x32_bf16 v[104:107], v[84:87], v[148:151], v[104:107]
ds_read_b128 v[64:67], v2 offset:30720
v_mfma_f32_16x16x32_bf16 v[108:111], v[88:91], v[148:151], v[108:111]
ds_read_b128 v[68:71], v2 offset:31744
s_waitcnt lgkmcnt(3)
v_mfma_f32_16x16x32_bf16 v[112:115], v[92:95], v[148:151], v[112:115]
ds_read_b128 v[72:75], v2 offset:32768
v_mfma_f32_16x16x32_bf16 v[116:119], v[96:99], v[148:151], v[116:119]
ds_read_b128 v[76:79], v2 offset:33792
s_waitcnt lgkmcnt(4)
v_mfma_f32_16x16x32_bf16 v[120:123], v[100:103], v[148:151], v[120:123]
ds_read_b128 v[80:83], v2 offset:34816
v_and_b32 v29, 0xffff0000, v46
v_lshlrev_b32 v30, 16, v47
v_and_b32 v31, 0xffff0000, v47
v_lshlrev_b32 v32, 16, v48
v_and_b32 v33, 0xffff0000, v48
s_waitcnt vmcnt(12) lgkmcnt(3)
v_mfma_f32_16x16x32_bf16 v[104:107], v[64:67], v[152:155], v[104:107]
ds_read_b128 v[84:87], v2 offset:35840
v_mfma_f32_16x16x32_bf16 v[108:111], v[68:71], v[152:155], v[108:111]
ds_read_b128 v[88:91], v2 offset:36864
s_waitcnt lgkmcnt(3)
v_mfma_f32_16x16x32_bf16 v[112:115], v[72:75], v[152:155], v[112:115]
ds_read_b128 v[92:95], v2 offset:37888
v_mfma_f32_16x16x32_bf16 v[116:119], v[76:79], v[152:155], v[116:119]
ds_read_b128 v[96:99], v2 offset:38912
s_waitcnt lgkmcnt(4)
v_mfma_f32_16x16x32_bf16 v[120:123], v[80:83], v[152:155], v[120:123]
ds_read_b128 v[100:103], v2 offset:39936
s_waitcnt vmcnt(0)
s_mov_b64 exec, 1
v_mov_b32 v9, 0
v_mov_b32 v10, s23
s_cmp_eq_u32 s41, 0
s_cbranch_scc1 Lflsafe_137
buffer_store_dword v10, v9, s[8:11], s28 offen
s_branch Lfldone_138
Lflsafe_137:
buffer_wbl2 sc1
s_waitcnt vmcnt(0)
buffer_store_dword v10, v9, s[8:11], s28 offen sc1
Lfldone_138:
s_mov_b64 exec, -1
v_lshlrev_b32 v34, 16, v49
v_and_b32 v35, 0xffff0000, v49
v_lshlrev_b32 v36, 16, v50
v_and_b32 v37, 0xffff0000, v50
v_lshlrev_b32 v38, 16, v51
s_barrier
s_waitcnt lgkmcnt(3)
v_mfma_f32_16x16x32_bf16 v[104:107], v[84:87], v[156:159], v[104:107]
ds_read_b128 v[64:67], v2 offset:40960
v_mfma_f32_16x16x32_bf16 v[108:111], v[88:91], v[156:159], v[108:111]
ds_read_b128 v[68:71], v2 offset:41984
s_waitcnt lgkmcnt(3)
v_mfma_f32_16x16x32_bf16 v[112:115], v[92:95], v[156:159], v[112:115]
ds_read_b128 v[72:75], v2 offset:43008
v_mfma_f32_16x16x32_bf16 v[116:119], v[96:99], v[156:159], v[116:119]
ds_read_b128 v[76:79], v2 offset:44032
s_waitcnt lgkmcnt(4)
v_mfma_f32_16x16x32_bf16 v[120:123], v[100:103], v[156:159], v[120:123]
ds_read_b128 v[80:83], v2 offset:45056
v_and_b32 v39, 0xffff0000, v51
v_lshlrev_b32 v40, 16, v52
v_and_b32 v41, 0xffff0000, v52
v_lshlrev_b32 v42, 16, v53
v_and_b32 v43, 0xffff0000, v53
s_waitcnt lgkmcnt(3)
v_mfma_f32_16x16x32_bf16 v[104:107], v[64:67], v[160:163], v[104:107]
ds_read_b128 v[84:87], v2 offset:46080
v_mfma_f32_16x16x32_bf16 v[108:111], v[68:71], v[160:163], v[108:111]
ds_read_b128 v[88:91], v2 offset:47104
s_waitcnt lgkmcnt(3)
v_mfma_f32_16x16x32_bf16 v[112:115], v[72:75], v[160:163], v[112:115]
ds_read_b128 v[92:95], v2 offset:48128
v_mfma_f32_16x16x32_bf16 v[116:119], v[76:79], v[160:163], v[116:119]
ds_read_b128 v[96:99], v2 offset:49152
s_waitcnt lgkmcnt(4)
v_mfma_f32_16x16x32_bf16 v[120:123], v[80:83], v[160:163], v[120:123]
ds_read_b128 v[100:103], v2 offset:50176
s_add_u32 s25, s25, 4096
buffer_load_dwordx4 v[192:195], v2, s[8:11], s25 offen offset:0 sc1
buffer_load_dwordx4 v[196:199], v2, s[8:11], s25 offen offset:1024 sc1
v_lshlrev_b32 v44, 16, v12
v_and_b32 v45, 0xffff0000, v12
v_lshlrev_b32 v46, 16, v13
v_and_b32 v47, 0xffff0000, v13
v_lshlrev_b32 v48, 16, v14
s_waitcnt lgkmcnt(3)
v_mfma_f32_16x16x32_bf16 v[104:107], v[84:87], v[164:167], v[104:107]
ds_read_b128 v[64:67], v2 offset:51200
v_mfma_f32_16x16x32_bf16 v[108:111], v[88:91], v[164:167], v[108:111]
ds_read_b128 v[68:71], v2 offset:52224
s_waitcnt lgkmcnt(3)
v_mfma_f32_16x16x32_bf16 v[112:115], v[92:95], v[164:167], v[112:115]
ds_read_b128 v[72:75], v2 offset:53248
v_mfma_f32_16x16x32_bf16 v[116:119], v[96:99], v[164:167], v[116:119]
ds_read_b128 v[76:79], v2 offset:54272
s_waitcnt lgkmcnt(4)
v_mfma_f32_16x16x32_bf16 v[120:123], v[100:103], v[164:167], v[120:123]
ds_read_b128 v[80:83], v2 offset:55296
buffer_load_dwordx4 v[200:203], v2, s[8:11], s25 offen offset:2048 sc1
buffer_load_dwordx4 v[204:207], v2, s[8:11], s25 offen offset:3072 sc1
v_and_b32 v49, 0xffff0000, v14
v_lshlrev_b32 v50, 16, v15
v_and_b32 v51, 0xffff0000, v15
v_lshlrev_b32 v52, 16, v16
v_and_b32 v53, 0xffff0000, v16
s_waitcnt lgkmcnt(3)
v_mfma_f32_16x16x32_bf16 v[104:107], v[64:67], v[168:171], v[104:107]
ds_read_b128 v[84:87], v2 offset:56320
v_mfma_f32_16x16x32_bf16 v[108:111], v[68:71], v[168:171], v[108:111]
ds_read_b128 v[88:91], v2 offset:57344
s_waitcnt lgkmcnt(3)
v_mfma_f32_16x16x32_bf16 v[112:115], v[72:75], v[168:171], v[112:115]
ds_read_b128 v[92:95], v2 offset:58368
v_mfma_f32_16x16x32_bf16 v[116:119], v[76:79], v[168:171], v[116:119]
ds_read_b128 v[96:99], v2 offset:59392
s_waitcnt lgkmcnt(4)
v_mfma_f32_16x16x32_bf16 v[120:123], v[80:83], v[168:171], v[120:123]
ds_read_b128 v[100:103], v2 offset:60416
s_add_u32 s25, s25, 4096
buffer_load_dwordx4 v[208:211], v2, s[8:11], s25 offen offset:0 sc1
buffer_load_dwordx4 v[212:215], v2, s[8:11], s25 offen offset:1024 sc1
v_lshlrev_b32 v54, 16, v17
v_and_b32 v55, 0xffff0000, v17
v_lshlrev_b32 v56, 16, v18
v_and_b32 v57, 0xffff0000, v18
v_lshlrev_b32 v58, 16, v19
s_barrier
s_waitcnt lgkmcnt(3)
v_mfma_f32_16x16x32_bf16 v[104:107], v[84:87], v[172:175], v[104:107]
ds_read_b128 v[64:67], v3 offset:0
v_mfma_f32_16x16x32_bf16 v[108:111], v[88:91], v[172:175], v[108:111]
ds_read_b128 v[68:71], v3 offset:1024
s_waitcnt lgkmcnt(3)
v_mfma_f32_16x16x32_bf16 v[112:115], v[92:95], v[172:175], v[112:115]
ds_read_b128 v[72:75], v3 offset:2048
v_mfma_f32_16x16x32_bf16 v[116:119], v[96:99], v[172:175], v[116:119]
ds_read_b128 v[76:79], v3 offset:3072
s_waitcnt lgkmcnt(4)
v_mfma_f32_16x16x32_bf16 v[120:123], v[100:103], v[172:175], v[120:123]
ds_read_b128 v[80:83], v3 offset:4096
buffer_load_dwordx4 v[216:219], v2, s[8:11], s25 offen offset:2048 sc1
buffer_load_dwordx4 v[220:223], v2, s[8:11], s25 offen offset:3072 sc1
v_and_b32 v59, 0xffff0000, v19
v_lshlrev_b32 v60, 16, v20
v_and_b32 v61, 0xffff0000, v20
v_lshlrev_b32 v62, 16, v21
v_and_b32 v63, 0xffff0000, v21
s_waitcnt lgkmcnt(3)
v_mfma_f32_16x16x32_bf16 v[104:107], v[64:67], v[176:179], v[104:107]
ds_read_b128 v[84:87], v3 offset:5120
v_mfma_f32_16x16x32_bf16 v[108:111], v[68:71], v[176:179], v[108:111]
ds_read_b128 v[88:91], v3 offset:6144
s_waitcnt lgkmcnt(3)
v_mfma_f32_16x16x32_bf16 v[112:115], v[72:75], v[176:179], v[112:115]
ds_read_b128 v[92:95], v3 offset:7168
v_mfma_f32_16x16x32_bf16 v[116:119], v[76:79], v[176:179], v[116:119]
ds_read_b128 v[96:99], v3 offset:8192
s_waitcnt lgkmcnt(4)
v_mfma_f32_16x16x32_bf16 v[120:123], v[80:83], v[176:179], v[120:123]
ds_read_b128 v[100:103], v3 offset:9216
s_add_u32 s25, s25, 4096
buffer_load_dwordx4 v[224:227], v2, s[8:11], s25 offen offset:0 sc1
buffer_load_dwordx4 v[228:231], v2, s[8:11], s25 offen offset:1024 sc1
s_mul_i32 s29, s3, 2560
s_add_u32 s29, s29, 149504
v_and_b32 v7, 15, v1
v_mul_u32_u24 v22, 160, v7
v_lshrrev_b32 v7, 4, v1
s_waitcnt lgkmcnt(3)
v_mfma_f32_16x16x32_bf16 v[104:107], v[84:87], v[180:183], v[104:107]
ds_read_b128 v[64:67], v3 offset:10240
v_mfma_f32_16x16x32_bf16 v[108:111], v[88:91], v[180:183], v[108:111]
ds_read_b128 v[68:71], v3 offset:11264
s_waitcnt lgkmcnt(3)
v_mfma_f32_16x16x32_bf16 v[112:115], v[92:95], v[180:183], v[112:115]
ds_read_b128 v[72:75], v3 offset:12288
v_mfma_f32_16x16x32_bf16 v[116:119], v[96:99], v[180:183], v[116:119]
ds_read_b128 v[76:79], v3 offset:13312
s_waitcnt lgkmcnt(4)
v_mfma_f32_16x16x32_bf16 v[120:123], v[100:103], v[180:183], v[120:123]
ds_read_b128 v[80:83], v3 offset:14336
buffer_load_dwordx4 v[232:235], v2, s[8:11], s25 offen offset:2048 sc1
buffer_load_dwordx4 v[236:239], v2, s[8:11], s25 offen offset:3072 sc1
v_lshl_add_u32 v22, v7, 3, v22
v_add_u32 v22, s29, v22
v_add_u32 v23, s29, v2
v_add_u32 v7, 0, v1
v_mul_u32_u24 v8, 6554, v7
s_waitcnt lgkmcnt(3)
v_mfma_f32_16x16x32_bf16 v[104:107], v[64:67], v[184:187], v[104:107]
ds_read_b128 v[84:87], v3 offset:15360
v_mfma_f32_16x16x32_bf16 v[108:111], v[68:71], v[184:187], v[108:111]
ds_read_b128 v[88:91], v3 offset:16384
s_waitcnt lgkmcnt(3)
v_mfma_f32_16x16x32_bf16 v[112:115], v[72:75], v[184:187], v[112:115]
ds_read_b128 v[92:95], v3 offset:17408
v_mfma_f32_16x16x32_bf16 v[116:119], v[76:79], v[184:187], v[116:119]
ds_read_b128 v[96:99], v3 offset:18432
s_waitcnt lgkmcnt(4)
v_mfma_f32_16x16x32_bf16 v[120:123], v[80:83], v[184:187], v[120:123]
ds_read_b128 v[100:103], v3 offset:19456
s_add_u32 s25, s25, 4096
buffer_load_dwordx4 v[240:243], v2, s[8:11], s25 offen offset:0 sc1
buffer_load_dwordx4 v[244:247], v2, s[8:11], s25 offen offset:1024 sc1
v_lshrrev_b32 v8, 16, v8
v_mul_u32_u24 v124, 1120, v8
v_lshl_add_u32 v124, v7, 4, v124
v_add_u32 v7, 64, v1
v_mul_u32_u24 v8, 6554, v7
s_barrier
s_waitcnt lgkmcnt(3)
v_mfma_f32_16x16x32_bf16 v[104:107], v[84:87], v[188:191], v[104:107]
ds_read_b128 v[64:67], v3 offset:20480
v_mfma_f32_16x16x32_bf16 v[108:111], v[88:91], v[188:191], v[108:111]
ds_read_b128 v[68:71], v3 offset:21504
s_waitcnt lgkmcnt(3)
v_mfma_f32_16x16x32_bf16 v[112:115], v[92:95], v[188:191], v[112:115]
ds_read_b128 v[72:75], v3 offset:22528
v_mfma_f32_16x16x32_bf16 v[116:119], v[96:99], v[188:191], v[116:119]
ds_read_b128 v[76:79], v3 offset:23552
s_waitcnt lgkmcnt(4)
v_mfma_f32_16x16x32_bf16 v[120:123], v[100:103], v[188:191], v[120:123]
ds_read_b128 v[80:83], v3 offset:24576
buffer_load_dwordx4 v[248:251], v2, s[8:11], s25 offen offset:2048 sc1
buffer_load_dwordx4 v[252:255], v2, s[8:11], s25 offen offset:3072 sc1
v_lshrrev_b32 v8, 16, v8
v_mul_u32_u24 v125, 1120, v8
v_lshl_add_u32 v125, v7, 4, v125
v_add_u32 v7, 128, v1
v_mul_u32_u24 v8, 6554, v7
s_waitcnt vmcnt(15) lgkmcnt(3)
v_mfma_f32_16x16x32_bf16 v[104:107], v[64:67], v[192:195], v[104:107]
ds_read_b128 v[84:87], v3 offset:25600
v_mfma_f32_16x16x32_bf16 v[108:111], v[68:71], v[192:195], v[108:111]
ds_read_b128 v[88:91], v3 offset:26624
s_waitcnt lgkmcnt(3)
v_mfma_f32_16x16x32_bf16 v[112:115], v[72:75], v[192:195], v[112:115]
ds_read_b128 v[92:95], v3 offset:27648
v_mfma_f32_16x16x32_bf16 v[116:119], v[76:79], v[192:195], v[116:119]
ds_read_b128 v[96:99], v3 offset:28672
s_waitcnt lgkmcnt(4)
v_mfma_f32_16x16x32_bf16 v[120:123], v[80:83], v[192:195], v[120:123]
ds_read_b128 v[100:103], v3 offset:29696
v_lshrrev_b32 v8, 16, v8
v_mul_u32_u24 v126, 1120, v8
v_lshl_add_u32 v126, v7, 4, v126
s_waitcnt vmcnt(14) lgkmcnt(3)
v_mfma_f32_16x16x32_bf16 v[104:107], v[84:87], v[196:199], v[104:107]
ds_read_b128 v[64:67], v3 offset:30720
v_mfma_f32_16x16x32_bf16 v[108:111], v[88:91], v[196:199], v[108:111]
ds_read_b128 v[68:71], v3 offset:31744
s_waitcnt lgkmcnt(3)
v_mfma_f32_16x16x32_bf16 v[112:115], v[92:95], v[196:199], v[112:115]
ds_read_b128 v[72:75], v3 offset:32768
v_mfma_f32_16x16x32_bf16 v[116:119], v[96:99], v[196:199], v[116:119]
ds_read_b128 v[76:79], v3 offset:33792
s_waitcnt lgkmcnt(4)
v_mfma_f32_16x16x32_bf16 v[120:123], v[100:103], v[196:199], v[120:123]
ds_read_b128 v[80:83], v3 offset:34816
s_waitcnt vmcnt(13) lgkmcnt(3)
v_mfma_f32_16x16x32_bf16 v[104:107], v[64:67], v[200:203], v[104:107]
ds_read_b128 v[84:87], v3 offset:35840
v_mfma_f32_16x16x32_bf16 v[108:111], v[68:71], v[200:203], v[108:111]
ds_read_b128 v[88:91], v3 offset:36864
s_waitcnt lgkmcnt(3)
v_mfma_f32_16x16x32_bf16 v[112:115], v[72:75], v[200:203], v[112:115]
ds_read_b128 v[92:95], v3 offset:37888
v_mfma_f32_16x16x32_bf16 v[116:119], v[76:79], v[200:203], v[116:119]
ds_read_b128 v[96:99], v3 offset:38912
s_waitcnt lgkmcnt(4)
v_mfma_f32_16x16x32_bf16 v[120:123], v[80:83], v[200:203], v[120:123]
ds_read_b128 v[100:103], v3 offset:39936
s_barrier
s_waitcnt vmcnt(12) lgkmcnt(3)
v_mfma_f32_16x16x32_bf16 v[104:107], v[84:87], v[204:207], v[104:107]
ds_read_b128 v[64:67], v3 offset:40960
v_mfma_f32_16x16x32_bf16 v[108:111], v[88:91], v[204:207], v[108:111]
ds_read_b128 v[68:71], v3 offset:41984
s_waitcnt lgkmcnt(3)
v_mfma_f32_16x16x32_bf16 v[112:115], v[92:95], v[204:207], v[112:115]
ds_read_b128 v[72:75], v3 offset:43008
v_mfma_f32_16x16x32_bf16 v[116:119], v[96:99], v[204:207], v[116:119]
ds_read_b128 v[76:79], v3 offset:44032
s_waitcnt lgkmcnt(4)
v_mfma_f32_16x16x32_bf16 v[120:123], v[100:103], v[204:207], v[120:123]
ds_read_b128 v[80:83], v3 offset:45056
s_waitcnt vmcnt(11) lgkmcnt(3)
v_mfma_f32_16x16x32_bf16 v[104:107], v[64:67], v[208:211], v[104:107]
ds_read_b128 v[84:87], v3 offset:46080
v_mfma_f32_16x16x32_bf16 v[108:111], v[68:71], v[208:211], v[108:111]
ds_read_b128 v[88:91], v3 offset:47104
s_waitcnt lgkmcnt(3)
v_mfma_f32_16x16x32_bf16 v[112:115], v[72:75], v[208:211], v[112:115]
ds_read_b128 v[92:95], v3 offset:48128
v_mfma_f32_16x16x32_bf16 v[116:119], v[76:79], v[208:211], v[116:119]
ds_read_b128 v[96:99], v3 offset:49152
s_waitcnt lgkmcnt(4)
v_mfma_f32_16x16x32_bf16 v[120:123], v[80:83], v[208:211], v[120:123]
ds_read_b128 v[100:103], v3 offset:50176
s_add_u32 s25, s25, 4096
buffer_load_dwordx4 v[128:131], v2, s[8:11], s25 offen offset:0 sc1
buffer_load_dwordx4 v[132:135], v2, s[8:11], s25 offen offset:1024 sc1
s_waitcnt vmcnt(12) lgkmcnt(3)
v_mfma_f32_16x16x32_bf16 v[104:107], v[84:87], v[212:215], v[104:107]
ds_read_b128 v[64:67], v3 offset:51200
v_mfma_f32_16x16x32_bf16 v[108:111], v[88:91], v[212:215], v[108:111]
ds_read_b128 v[68:71], v3 offset:52224
s_waitcnt lgkmcnt(3)
v_mfma_f32_16x16x32_bf16 v[112:115], v[92:95], v[212:215], v[112:115]
ds_read_b128 v[72:75], v3 offset:53248
v_mfma_f32_16x16x32_bf16 v[116:119], v[96:99], v[212:215], v[116:119]
ds_read_b128 v[76:79], v3 offset:54272
s_waitcnt lgkmcnt(4)
v_mfma_f32_16x16x32_bf16 v[120:123], v[100:103], v[212:215], v[120:123]
ds_read_b128 v[80:83], v3 offset:55296
buffer_load_dwordx4 v[136:139], v2, s[8:11], s25 offen offset:2048 sc1
buffer_load_dwordx4 v[140:143], v2, s[8:11], s25 offen offset:3072 sc1
s_waitcnt vmcnt(13) lgkmcnt(3)
v_mfma_f32_16x16x32_bf16 v[104:107], v[64:67], v[216:219], v[104:107]
ds_read_b128 v[84:87], v3 offset:56320
v_mfma_f32_16x16x32_bf16 v[108:111], v[68:71], v[216:219], v[108:111]
ds_read_b128 v[88:91], v3 offset:57344
s_waitcnt lgkmcnt(3)
v_mfma_f32_16x16x32_bf16 v[112:115], v[72:75], v[216:219], v[112:115]
ds_read_b128 v[92:95], v3 offset:58368
v_mfma_f32_16x16x32_bf16 v[116:119], v[76:79], v[216:219], v[116:119]
ds_read_b128 v[96:99], v3 offset:59392
s_waitcnt lgkmcnt(4)
v_mfma_f32_16x16x32_bf16 v[120:123], v[80:83], v[216:219], v[120:123]
ds_read_b128 v[100:103], v3 offset:60416
s_add_u32 s25, s25, 4096
buffer_load_dwordx4 v[144:147], v2, s[8:11], s25 offen offset:0 sc1
buffer_load_dwordx4 v[148:151], v2, s[8:11], s25 offen offset:1024 sc1
s_barrier
s_waitcnt vmcnt(14) lgkmcnt(3)
v_mfma_f32_16x16x32_bf16 v[104:107], v[84:87], v[220:223], v[104:107]
ds_read_b128 v[64:67], v4 offset:0
v_mfma_f32_16x16x32_bf16 v[108:111], v[88:91], v[220:223], v[108:111]
ds_read_b128 v[68:71], v4 offset:1024
s_waitcnt lgkmcnt(3)
v_mfma_f32_16x16x32_bf16 v[112:115], v[92:95], v[220:223], v[112:115]
ds_read_b128 v[72:75], v4 offset:2048
v_mfma_f32_16x16x32_bf16 v[116:119], v[96:99], v[220:223], v[116:119]
ds_read_b128 v[76:79], v4 offset:3072
s_waitcnt lgkmcnt(4)
v_mfma_f32_16x16x32_bf16 v[120:123], v[100:103], v[220:223], v[120:123]
ds_read_b128 v[80:83], v4 offset:4096
buffer_load_dwordx4 v[152:155], v2, s[8:11], s25 offen offset:2048 sc1
buffer_load_dwordx4 v[156:159], v2, s[8:11], s25 offen offset:3072 sc1
s_waitcnt vmcnt(15) lgkmcnt(3)
v_mfma_f32_16x16x32_bf16 v[104:107], v[64:67], v[224:227], v[104:107]
ds_read_b128 v[84:87], v4 offset:5120
v_mfma_f32_16x16x32_bf16 v[108:111], v[68:71], v[224:227], v[108:111]
ds_read_b128 v[88:91], v4 offset:6144
s_waitcnt lgkmcnt(3)
v_mfma_f32_16x16x32_bf16 v[112:115], v[72:75], v[224:227], v[112:115]
ds_read_b128 v[92:95], v4 offset:7168
v_mfma_f32_16x16x32_bf16 v[116:119], v[76:79], v[224:227], v[116:119]
ds_read_b128 v[96:99], v4 offset:8192
s_waitcnt lgkmcnt(4)
v_mfma_f32_16x16x32_bf16 v[120:123], v[80:83], v[224:227], v[120:123]
ds_read_b128 v[100:103], v4 offset:9216
s_add_u32 s25, s25, 4096
buffer_load_dwordx4 v[160:163], v2, s[8:11], s25 offen offset:0 sc1
buffer_load_dwordx4 v[164:167], v2, s[8:11], s25 offen offset:1024 sc1
s_waitcnt vmcnt(16) lgkmcnt(3)
v_mfma_f32_16x16x32_bf16 v[104:107], v[84:87], v[228:231], v[104:107]
ds_read_b128 v[64:67], v4 offset:10240
v_mfma_f32_16x16x32_bf16 v[108:111], v[88:91], v[228:231], v[108:111]
ds_read_b128 v[68:71], v4 offset:11264
s_waitcnt lgkmcnt(3)
v_mfma_f32_16x16x32_bf16 v[112:115], v[92:95], v[228:231], v[112:115]
ds_read_b128 v[72:75], v4 offset:12288
v_mfma_f32_16x16x32_bf16 v[116:119], v[96:99], v[228:231], v[116:119]
ds_read_b128 v[76:79], v4 offset:13312
s_waitcnt lgkmcnt(4)
v_mfma_f32_16x16x32_bf16 v[120:123], v[100:103], v[228:231], v[120:123]
ds_read_b128 v[80:83], v4 offset:14336
buffer_load_dwordx4 v[168:171], v2, s[8:11], s25 offen offset:2048 sc1
buffer_load_dwordx4 v[172:175], v2, s[8:11], s25 offen offset:3072 sc1
s_waitcnt vmcnt(17) lgkmcnt(3)
v_mfma_f32_16x16x32_bf16 v[104:107], v[64:67], v[232:235], v[104:107]
ds_read_b128 v[84:87], v4 offset:15360
v_mfma_f32_16x16x32_bf16 v[108:111], v[68:71], v[232:235], v[108:111]
ds_read_b128 v[88:91], v4 offset:16384
s_waitcnt lgkmcnt(3)
v_mfma_f32_16x16x32_bf16 v[112:115], v[72:75], v[232:235], v[112:115]
ds_read_b128 v[92:95], v4 offset:17408
v_mfma_f32_16x16x32_bf16 v[116:119], v[76:79], v[232:235], v[116:119]
ds_read_b128 v[96:99], v4 offset:18432
s_waitcnt lgkmcnt(4)
v_mfma_f32_16x16x32_bf16 v[120:123], v[80:83], v[232:235], v[120:123]
ds_read_b128 v[100:103], v4 offset:19456
s_add_u32 s25, s25, 4096
buffer_load_dwordx4 v[176:179], v2, s[8:11], s25 offen offset:0 sc1
buffer_load_dwordx4 v[180:183], v2, s[8:11], s25 offen offset:1024 sc1
s_barrier
s_waitcnt vmcnt(18) lgkmcnt(3)
v_mfma_f32_16x16x32_bf16 v[104:107], v[84:87], v[236:239], v[104:107]
ds_read_b128 v[64:67], v2 offset:0
v_mfma_f32_16x16x32_bf16 v[108:111], v[88:91], v[236:239], v[108:111]
ds_read_b128 v[68:71], v2 offset:1024
s_waitcnt lgkmcnt(3)
v_mfma_f32_16x16x32_bf16 v[112:115], v[92:95], v[236:239], v[112:115]
ds_read_b128 v[72:75], v2 offset:2048
v_mfma_f32_16x16x32_bf16 v[116:119], v[96:99], v[236:239], v[116:119]
ds_read_b128 v[76:79], v2 offset:3072
s_waitcnt lgkmcnt(4)
v_mfma_f32_16x16x32_bf16 v[120:123], v[100:103], v[236:239], v[120:123]
ds_read_b128 v[80:83], v2 offset:4096
buffer_load_dwordx4 v[184:187], v2, s[8:11], s25 offen offset:2048 sc1
buffer_load_dwordx4 v[188:191], v2, s[8:11], s25 offen offset:3072 sc1
s_waitcnt vmcnt(19) lgkmcnt(3)
v_mfma_f32_16x16x32_bf16 v[104:107], v[64:67], v[240:243], v[104:107]
ds_read_b128 v[84:87], v2 offset:5120
v_mfma_f32_16x16x32_bf16 v[108:111], v[68:71], v[240:243], v[108:111]
ds_read_b128 v[88:91], v2 offset:6144
s_waitcnt lgkmcnt(3)
v_mfma_f32_16x16x32_bf16 v[112:115], v[72:75], v[240:243], v[112:115]
ds_read_b128 v[92:95], v2 offset:7168
v_mfma_f32_16x16x32_bf16 v[116:119], v[76:79], v[240:243], v[116:119]
ds_read_b128 v[96:99], v2 offset:8192
s_waitcnt lgkmcnt(4)
v_mfma_f32_16x16x32_bf16 v[120:123], v[80:83], v[240:243], v[120:123]
ds_read_b128 v[100:103], v2 offset:9216
s_waitcnt vmcnt(18) lgkmcnt(3)
v_mfma_f32_16x16x32_bf16 v[104:107], v[84:87], v[244:247], v[104:107]
ds_read_b128 v[64:67], v2 offset:10240
v_mfma_f32_16x16x32_bf16 v[108:111], v[88:91], v[244:247], v[108:111]
ds_read_b128 v[68:71], v2 offset:11264
s_waitcnt lgkmcnt(3)
v_mfma_f32_16x16x32_bf16 v[112:115], v[92:95], v[244:247], v[112:115]
ds_read_b128 v[72:75], v2 offset:12288
v_mfma_f32_16x16x32_bf16 v[116:119], v[96:99], v[244:247], v[116:119]
ds_read_b128 v[76:79], v2 offset:13312
s_waitcnt lgkmcnt(4)
v_mfma_f32_16x16x32_bf16 v[120:123], v[100:103], v[244:247], v[120:123]
ds_read_b128 v[80:83], v2 offset:14336
s_waitcnt vmcnt(17) lgkmcnt(3)
v_mfma_f32_16x16x32_bf16 v[104:107], v[64:67], v[248:251], v[104:107]
ds_read_b128 v[84:87], v2 offset:15360
v_mfma_f32_16x16x32_bf16 v[108:111], v[68:71], v[248:251], v[108:111]
ds_read_b128 v[88:91], v2 offset:16384
s_waitcnt lgkmcnt(3)
v_mfma_f32_16x16x32_bf16 v[112:115], v[72:75], v[248:251], v[112:115]
ds_read_b128 v[92:95], v2 offset:17408
v_mfma_f32_16x16x32_bf16 v[116:119], v[76:79], v[248:251], v[116:119]
ds_read_b128 v[96:99], v2 offset:18432
s_waitcnt lgkmcnt(4)
v_mfma_f32_16x16x32_bf16 v[120:123], v[80:83], v[248:251], v[120:123]
ds_read_b128 v[100:103], v2 offset:19456
s_barrier
s_waitcnt vmcnt(16) lgkmcnt(3)
v_mfma_f32_16x16x32_bf16 v[104:107], v[84:87], v[252:255], v[104:107]
ds_read_b128 v[64:67], v2 offset:20480
v_mfma_f32_16x16x32_bf16 v[108:111], v[88:91], v[252:255], v[108:111]
ds_read_b128 v[68:71], v2 offset:21504
s_waitcnt lgkmcnt(3)
v_mfma_f32_16x16x32_bf16 v[112:115], v[92:95], v[252:255], v[112:115]
ds_read_b128 v[72:75], v2 offset:22528
v_mfma_f32_16x16x32_bf16 v[116:119], v[96:99], v[252:255], v[116:119]
ds_read_b128 v[76:79], v2 offset:23552
s_waitcnt lgkmcnt(4)
v_mfma_f32_16x16x32_bf16 v[120:123], v[100:103], v[252:255], v[120:123]
ds_read_b128 v[80:83], v2 offset:24576
s_waitcnt vmcnt(15) lgkmcnt(3)
v_mfma_f32_16x16x32_bf16 v[104:107], v[64:67], v[128:131], v[104:107]
ds_read_b128 v[84:87], v2 offset:25600
v_mfma_f32_16x16x32_bf16 v[108:111], v[68:71], v[128:131], v[108:111]
ds_read_b128 v[88:91], v2 offset:26624
s_waitcnt lgkmcnt(3)
v_mfma_f32_16x16x32_bf16 v[112:115], v[72:75], v[128:131], v[112:115]
ds_read_b128 v[92:95], v2 offset:27648
v_mfma_f32_16x16x32_bf16 v[116:119], v[76:79], v[128:131], v[116:119]
ds_read_b128 v[96:99], v2 offset:28672
s_waitcnt lgkmcnt(4)
v_mfma_f32_16x16x32_bf16 v[120:123], v[80:83], v[128:131], v[120:123]
ds_read_b128 v[100:103], v2 offset:29696
s_waitcnt vmcnt(14) lgkmcnt(3)
v_mfma_f32_16x16x32_bf16 v[104:107], v[84:87], v[132:135], v[104:107]
ds_read_b128 v[64:67], v2 offset:30720
v_mfma_f32_16x16x32_bf16 v[108:111], v[88:91], v[132:135], v[108:111]
ds_read_b128 v[68:71], v2 offset:31744
s_waitcnt lgkmcnt(3)
v_mfma_f32_16x16x32_bf16 v[112:115], v[92:95], v[132:135], v[112:115]
ds_read_b128 v[72:75], v2 offset:32768
v_mfma_f32_16x16x32_bf16 v[116:119], v[96:99], v[132:135], v[116:119]
ds_read_b128 v[76:79], v2 offset:33792
s_waitcnt lgkmcnt(4)
v_mfma_f32_16x16x32_bf16 v[120:123], v[100:103], v[132:135], v[120:123]
ds_read_b128 v[80:83], v2 offset:34816
s_waitcnt vmcnt(13) lgkmcnt(3)
v_mfma_f32_16x16x32_bf16 v[104:107], v[64:67], v[136:139], v[104:107]
ds_read_b128 v[84:87], v2 offset:35840
v_mfma_f32_16x16x32_bf16 v[108:111], v[68:71], v[136:139], v[108:111]
ds_read_b128 v[88:91], v2 offset:36864
s_waitcnt lgkmcnt(3)
v_mfma_f32_16x16x32_bf16 v[112:115], v[72:75], v[136:139], v[112:115]
ds_read_b128 v[92:95], v2 offset:37888
v_mfma_f32_16x16x32_bf16 v[116:119], v[76:79], v[136:139], v[116:119]
ds_read_b128 v[96:99], v2 offset:38912
s_waitcnt lgkmcnt(4)
v_mfma_f32_16x16x32_bf16 v[120:123], v[80:83], v[136:139], v[120:123]
ds_read_b128 v[100:103], v2 offset:39936
s_barrier
s_waitcnt vmcnt(12) lgkmcnt(3)
v_mfma_f32_16x16x32_bf16 v[104:107], v[84:87], v[140:143], v[104:107]
ds_read_b128 v[64:67], v2 offset:40960
v_mfma_f32_16x16x32_bf16 v[108:111], v[88:91], v[140:143], v[108:111]
ds_read_b128 v[68:71], v2 offset:41984
s_waitcnt lgkmcnt(3)
v_mfma_f32_16x16x32_bf16 v[112:115], v[92:95], v[140:143], v[112:115]
ds_read_b128 v[72:75], v2 offset:43008
v_mfma_f32_16x16x32_bf16 v[116:119], v[96:99], v[140:143], v[116:119]
ds_read_b128 v[76:79], v2 offset:44032
s_waitcnt lgkmcnt(4)
v_mfma_f32_16x16x32_bf16 v[120:123], v[100:103], v[140:143], v[120:123]
ds_read_b128 v[80:83], v2 offset:45056
s_waitcnt vmcnt(11) lgkmcnt(3)
v_mfma_f32_16x16x32_bf16 v[104:107], v[64:67], v[144:147], v[104:107]
ds_read_b128 v[84:87], v2 offset:46080
v_mfma_f32_16x16x32_bf16 v[108:111], v[68:71], v[144:147], v[108:111]
ds_read_b128 v[88:91], v2 offset:47104
s_waitcnt lgkmcnt(3)
v_mfma_f32_16x16x32_bf16 v[112:115], v[72:75], v[144:147], v[112:115]
ds_read_b128 v[92:95], v2 offset:48128
v_mfma_f32_16x16x32_bf16 v[116:119], v[76:79], v[144:147], v[116:119]
ds_read_b128 v[96:99], v2 offset:49152
s_waitcnt lgkmcnt(4)
v_mfma_f32_16x16x32_bf16 v[120:123], v[80:83], v[144:147], v[120:123]
ds_read_b128 v[100:103], v2 offset:50176
s_waitcnt vmcnt(10) lgkmcnt(3)
v_mfma_f32_16x16x32_bf16 v[104:107], v[84:87], v[148:151], v[104:107]
ds_read_b128 v[64:67], v2 offset:51200
v_mfma_f32_16x16x32_bf16 v[108:111], v[88:91], v[148:151], v[108:111]
ds_read_b128 v[68:71], v2 offset:52224
s_waitcnt lgkmcnt(3)
v_mfma_f32_16x16x32_bf16 v[112:115], v[92:95], v[148:151], v[112:115]
ds_read_b128 v[72:75], v2 offset:53248
v_mfma_f32_16x16x32_bf16 v[116:119], v[96:99], v[148:151], v[116:119]
ds_read_b128 v[76:79], v2 offset:54272
s_waitcnt lgkmcnt(4)
v_mfma_f32_16x16x32_bf16 v[120:123], v[100:103], v[148:151], v[120:123]
ds_read_b128 v[80:83], v2 offset:55296
s_waitcnt vmcnt(9) lgkmcnt(3)
v_mfma_f32_16x16x32_bf16 v[104:107], v[64:67], v[152:155], v[104:107]
ds_read_b128 v[84:87], v2 offset:56320
v_mfma_f32_16x16x32_bf16 v[108:111], v[68:71], v[152:155], v[108:111]
ds_read_b128 v[88:91], v2 offset:57344
s_waitcnt lgkmcnt(3)
v_mfma_f32_16x16x32_bf16 v[112:115], v[72:75], v[152:155], v[112:115]
ds_read_b128 v[92:95], v2 offset:58368
v_mfma_f32_16x16x32_bf16 v[116:119], v[76:79], v[152:155], v[116:119]
ds_read_b128 v[96:99], v2 offset:59392
s_waitcnt lgkmcnt(4)
v_mfma_f32_16x16x32_bf16 v[120:123], v[80:83], v[152:155], v[120:123]
ds_read_b128 v[100:103], v2 offset:60416
s_barrier
s_waitcnt vmcnt(8) lgkmcnt(3)
v_mfma_f32_16x16x32_bf16 v[104:107], v[84:87], v[156:159], v[104:107]
ds_read_b128 v[64:67], v3 offset:0
v_mfma_f32_16x16x32_bf16 v[108:111], v[88:91], v[156:159], v[108:111]
ds_read_b128 v[68:71], v3 offset:1024
s_waitcnt lgkmcnt(3)
v_mfma_f32_16x16x32_bf16 v[112:115], v[92:95], v[156:159], v[112:115]
ds_read_b128 v[72:75], v3 offset:2048
v_mfma_f32_16x16x32_bf16 v[116:119], v[96:99], v[156:159], v[116:119]
ds_read_b128 v[76:79], v3 offset:3072
s_waitcnt lgkmcnt(4)
v_mfma_f32_16x16x32_bf16 v[120:123], v[100:103], v[156:159], v[120:123]
ds_read_b128 v[80:83], v3 offset:4096
s_waitcnt vmcnt(7) lgkmcnt(3)
v_mfma_f32_16x16x32_bf16 v[104:107], v[64:67], v[160:163], v[104:107]
ds_read_b128 v[84:87], v3 offset:5120
v_mfma_f32_16x16x32_bf16 v[108:111], v[68:71], v[160:163], v[108:111]
ds_read_b128 v[88:91], v3 offset:6144
s_waitcnt lgkmcnt(3)
v_mfma_f32_16x16x32_bf16 v[112:115], v[72:75], v[160:163], v[112:115]
ds_read_b128 v[92:95], v3 offset:7168
v_mfma_f32_16x16x32_bf16 v[116:119], v[76:79], v[160:163], v[116:119]
ds_read_b128 v[96:99], v3 offset:8192
s_waitcnt lgkmcnt(4)
v_mfma_f32_16x16x32_bf16 v[120:123], v[80:83], v[160:163], v[120:123]
ds_read_b128 v[100:103], v3 offset:9216
s_waitcnt vmcnt(6) lgkmcnt(3)
v_mfma_f32_16x16x32_bf16 v[104:107], v[84:87], v[164:167], v[104:107]
ds_read_b128 v[64:67], v3 offset:10240
v_mfma_f32_16x16x32_bf16 v[108:111], v[88:91], v[164:167], v[108:111]
ds_read_b128 v[68:71], v3 offset:11264
s_waitcnt lgkmcnt(3)
v_mfma_f32_16x16x32_bf16 v[112:115], v[92:95], v[164:167], v[112:115]
ds_read_b128 v[72:75], v3 offset:12288
v_mfma_f32_16x16x32_bf16 v[116:119], v[96:99], v[164:167], v[116:119]
ds_read_b128 v[76:79], v3 offset:13312
s_waitcnt lgkmcnt(4)
v_mfma_f32_16x16x32_bf16 v[120:123], v[100:103], v[164:167], v[120:123]
ds_read_b128 v[80:83], v3 offset:14336
s_waitcnt vmcnt(5) lgkmcnt(3)
v_mfma_f32_16x16x32_bf16 v[104:107], v[64:67], v[168:171], v[104:107]
ds_read_b128 v[84:87], v3 offset:15360
v_mfma_f32_16x16x32_bf16 v[108:111], v[68:71], v[168:171], v[108:111]
ds_read_b128 v[88:91], v3 offset:16384
s_waitcnt lgkmcnt(3)
v_mfma_f32_16x16x32_bf16 v[112:115], v[72:75], v[168:171], v[112:115]
ds_read_b128 v[92:95], v3 offset:17408
v_mfma_f32_16x16x32_bf16 v[116:119], v[76:79], v[168:171], v[116:119]
ds_read_b128 v[96:99], v3 offset:18432
s_waitcnt lgkmcnt(4)
v_mfma_f32_16x16x32_bf16 v[120:123], v[80:83], v[168:171], v[120:123]
ds_read_b128 v[100:103], v3 offset:19456
s_barrier
s_waitcnt vmcnt(4) lgkmcnt(3)
v_mfma_f32_16x16x32_bf16 v[104:107], v[84:87], v[172:175], v[104:107]
ds_read_b128 v[64:67], v3 offset:20480
v_mfma_f32_16x16x32_bf16 v[108:111], v[88:91], v[172:175], v[108:111]
ds_read_b128 v[68:71], v3 offset:21504
s_waitcnt lgkmcnt(3)
v_mfma_f32_16x16x32_bf16 v[112:115], v[92:95], v[172:175], v[112:115]
ds_read_b128 v[72:75], v3 offset:22528
v_mfma_f32_16x16x32_bf16 v[116:119], v[96:99], v[172:175], v[116:119]
ds_read_b128 v[76:79], v3 offset:23552
s_waitcnt lgkmcnt(4)
v_mfma_f32_16x16x32_bf16 v[120:123], v[100:103], v[172:175], v[120:123]
ds_read_b128 v[80:83], v3 offset:24576
s_waitcnt vmcnt(3) lgkmcnt(3)
v_mfma_f32_16x16x32_bf16 v[104:107], v[64:67], v[176:179], v[104:107]
ds_read_b128 v[84:87], v3 offset:25600
v_mfma_f32_16x16x32_bf16 v[108:111], v[68:71], v[176:179], v[108:111]
ds_read_b128 v[88:91], v3 offset:26624
s_waitcnt lgkmcnt(3)
v_mfma_f32_16x16x32_bf16 v[112:115], v[72:75], v[176:179], v[112:115]
ds_read_b128 v[92:95], v3 offset:27648
v_mfma_f32_16x16x32_bf16 v[116:119], v[76:79], v[176:179], v[116:119]
ds_read_b128 v[96:99], v3 offset:28672
s_waitcnt lgkmcnt(4)
v_mfma_f32_16x16x32_bf16 v[120:123], v[80:83], v[176:179], v[120:123]
ds_read_b128 v[100:103], v3 offset:29696
s_waitcnt vmcnt(2) lgkmcnt(3)
v_mfma_f32_16x16x32_bf16 v[104:107], v[84:87], v[180:183], v[104:107]
ds_read_b128 v[64:67], v3 offset:30720
v_mfma_f32_16x16x32_bf16 v[108:111], v[88:91], v[180:183], v[108:111]
ds_read_b128 v[68:71], v3 offset:31744
s_waitcnt lgkmcnt(3)
v_mfma_f32_16x16x32_bf16 v[112:115], v[92:95], v[180:183], v[112:115]
ds_read_b128 v[72:75], v3 offset:32768
v_mfma_f32_16x16x32_bf16 v[116:119], v[96:99], v[180:183], v[116:119]
ds_read_b128 v[76:79], v3 offset:33792
s_waitcnt lgkmcnt(4)
v_mfma_f32_16x16x32_bf16 v[120:123], v[100:103], v[180:183], v[120:123]
ds_read_b128 v[80:83], v3 offset:34816
s_waitcnt vmcnt(1) lgkmcnt(3)
v_mfma_f32_16x16x32_bf16 v[104:107], v[64:67], v[184:187], v[104:107]
ds_read_b128 v[84:87], v3 offset:35840
v_mfma_f32_16x16x32_bf16 v[108:111], v[68:71], v[184:187], v[108:111]
ds_read_b128 v[88:91], v3 offset:36864
s_waitcnt lgkmcnt(3)
v_mfma_f32_16x16x32_bf16 v[112:115], v[72:75], v[184:187], v[112:115]
ds_read_b128 v[92:95], v3 offset:37888
v_mfma_f32_16x16x32_bf16 v[116:119], v[76:79], v[184:187], v[116:119]
ds_read_b128 v[96:99], v3 offset:38912
s_waitcnt lgkmcnt(4)
v_mfma_f32_16x16x32_bf16 v[120:123], v[80:83], v[184:187], v[120:123]
ds_read_b128 v[100:103], v3 offset:39936
s_waitcnt vmcnt(0) lgkmcnt(3)
v_mfma_f32_16x16x32_bf16 v[104:107], v[84:87], v[188:191], v[104:107]
v_mfma_f32_16x16x32_bf16 v[108:111], v[88:91], v[188:191], v[108:111]
s_waitcnt lgkmcnt(1)
v_mfma_f32_16x16x32_bf16 v[112:115], v[92:95], v[188:191], v[112:115]
v_mfma_f32_16x16x32_bf16 v[116:119], v[96:99], v[188:191], v[116:119]
s_waitcnt lgkmcnt(0)
v_mfma_f32_16x16x32_bf16 v[120:123], v[100:103], v[188:191], v[120:123]
s_nop 1
v_pk_fma_f32 v[64:65], v[104:105], v[24:25], v[44:45]
v_pk_fma_f32 v[66:67], v[106:107], v[26:27], v[46:47]
v_pk_fma_f32 v[68:69], v[108:109], v[28:29], v[48:49]
v_pk_fma_f32 v[70:71], v[110:111], v[30:31], v[50:51]
v_pk_fma_f32 v[72:73], v[112:113], v[32:33], v[52:53]
v_pk_fma_f32 v[74:75], v[114:115], v[34:35], v[54:55]
v_pk_fma_f32 v[76:77], v[116:117], v[36:37], v[56:57]
v_pk_fma_f32 v[78:79], v[118:119], v[38:39], v[58:59]
v_pk_fma_f32 v[80:81], v[120:121], v[40:41], v[60:61]
v_pk_fma_f32 v[82:83], v[122:123], v[42:43], v[62:63]
v_cvt_pk_bf16_f32 v12, v64, v65
v_cvt_pk_bf16_f32 v13, v66, v67
v_cvt_pk_bf16_f32 v14, v68, v69
v_cvt_pk_bf16_f32 v15, v70, v71
v_cvt_pk_bf16_f32 v16, v72, v73
v_cvt_pk_bf16_f32 v17, v74, v75
v_cvt_pk_bf16_f32 v18, v76, v77
v_cvt_pk_bf16_f32 v19, v78, v79
v_cvt_pk_bf16_f32 v20, v80, v81
v_cvt_pk_bf16_f32 v21, v82, v83
ds_write_b64 v22, v[12:13] offset:0
ds_write_b64 v22, v[14:15] offset:32
ds_write_b64 v22, v[16:17] offset:64
ds_write_b64 v22, v[18:19] offset:96
ds_write_b64 v22, v[20:21] offset:128
s_waitcnt lgkmcnt(0)
ds_read_b128 v[64:67], v23 offset:0
ds_read_b128 v[68:71], v23 offset:1024
ds_read_b128 v[72:75], v23 offset:2048
s_waitcnt lgkmcnt(2)
buffer_store_dwordx4 v[64:67], v124, s[16:19], s26 offen
s_waitcnt lgkmcnt(1)
buffer_store_dwordx4 v[68:71], v125, s[16:19], s26 offen
s_waitcnt lgkmcnt(0)
s_mov_b32 exec_hi, 0
buffer_store_dwordx4 v[72:75], v126, s[16:19], s26 offen
s_mov_b32 exec_hi, -1
s_or_b32 s29, s2, s3
s_cmp_lg_u32 s29, 0
s_cbranch_scc1 Lnoepoch_139
s_mov_b32 s29, 24805376
s_mov_b64 exec, 1
v_mov_b32 v7, 0
v_mov_b32 v8, s23
buffer_store_dword v8, v7, s[8:11], s29 offen sc1
s_mov_b64 exec, -1
Lnoepoch_139:
Lf_end:
s_endpgm
.section .rodata,"a"
.p2align 6
.amdhsa_kernel adaLN_cond__grouped_kv_mqa__glu_gated_geglu__prompt_kernel
  .amdhsa_next_free_vgpr 256
  .amdhsa_next_free_sgpr 102
  .amdhsa_accum_offset 256
  .amdhsa_group_segment_fixed_size 0
  .amdhsa_kernarg_size 112
  .amdhsa_user_sgpr_count 2
  .amdhsa_user_sgpr_kernarg_segment_ptr 1
  .amdhsa_system_sgpr_workgroup_id_x 1
  .amdhsa_float_denorm_mode_32 3
.end_amdhsa_kernel
```
